```python
import torch

def _softmax(x, axis=-1):
    return torch.softmax(x, dim=axis)
def _gelu(x):
    return torch.nn.functional.gelu(x, approximate="tanh")
def _silu(x):
    return torch.nn.functional.silu(x)
def _sigmoid(x):
    return torch.sigmoid(x)
def _layernorm(x, axis=-1, eps=1e-5):
    m = x.mean(dim=axis, keepdim=True)
    v = x.var(dim=axis, keepdim=True, unbiased=False)
    return (x - m) / torch.sqrt(v + eps)
def _scatter_add(tgt, idx, src, axis=0):
    return tgt.clone().index_add_(axis, idx, src)
def _segment_sum(src, seg, n):
    out = torch.zeros((n,) + src.shape[1:], dtype=src.dtype)
    return out.index_add_(0, seg, src)
def _pad(x, pw):
    flat = tuple(v for pair in reversed(pw) for v in pair)
    return torch.nn.functional.pad(x, flat)

kernel_name = 'gated_mix__sliding_block__mixer_s_mlp__prompt'

def setup_inputs():

    _w = (lambda a: (lambda t: t.to(torch.bfloat16) if t.is_floating_point() else t)(torch.as_tensor(a)))
    def _A_setup():
        B, S, D = 1, 2048, 512
        return {
            "x": _w((lambda *s: torch.randn(*s, dtype=torch.bfloat16) * 0.05)(B, S, D)),
            "wqkv": _w((lambda *s: torch.randn(*s, dtype=torch.bfloat16) * 1.6)(D, 3 * D)),
            "wo": _w((lambda *s: torch.randn(*s, dtype=torch.bfloat16) * 0.4)(D, D)),
        }
    _A_in = _A_setup()

    def _B_setup():
        B, S, D, F = 1, 2048, 512, 1376
        return {
            "x":  _w((lambda *s: torch.randn(*s, dtype=torch.bfloat16) * 0.05)(B, S, D)),
            "w1": _w((lambda *s: torch.randn(*s, dtype=torch.bfloat16) * 3.2)(D, D) * (D ** -0.5)),
            "w2": _w((lambda *s: torch.randn(*s, dtype=torch.bfloat16) * 3.2)(D, D) * (D ** -0.5)),
            "w3": _w((lambda *s: torch.randn(*s, dtype=torch.bfloat16) * 3.2)(D, F) * (D ** -0.5)),
            "w4": _w((lambda *s: torch.randn(*s, dtype=torch.bfloat16) * 3.2)(F, D) * (F ** -0.5)),
        }
    _B_in = _B_setup()

    return {
        "A_x": _A_in["x"],
        "A_wqkv": _A_in["wqkv"],
        "A_wo": _A_in["wo"],
        "B_x": _B_in["x"],
        "B_w1": _B_in["w1"],
        "B_w2": _B_in["w2"],
        "B_w3": _B_in["w3"],
        "B_w4": _B_in["w4"],
        "gate_w": _w((lambda *s: torch.randn(*s, dtype=torch.bfloat16) * 0.05)(512) * 16.0),
    }

def reference(A_x, A_wqkv, A_wo, B_x, B_w1, B_w2, B_w3, B_w4, gate_w):
    def _A_ref(x, wqkv, wo):
        B, S, D = x.shape
        H = 32; Dh = D // H; W = 256
        qkv = (lambda x, *d: x.permute(*d))((x @ wqkv).reshape(B, S, 3, H, Dh), 2, 0, 3, 1, 4)
        q, k, v = qkv[0], qkv[1], qkv[2]
        scores = torch.einsum("bhqd,bhkd->bhqk", q, k) * (Dh ** -0.5)
        idx = torch.arange(S)
        mask = (idx[:, None] - idx[None, :] >= 0) & (idx[:, None] - idx[None, :] < W)
        scores = torch.where(mask[None, None], scores, -1e9)
        p = _softmax(scores, axis=-1)
        o = torch.einsum("bhqk,bhkd->bhqd", p, v)
        return (lambda x, *d: x.permute(*d))(o, 0, 2, 1, 3).reshape(B, S, D) @ wo

    def _B_ref(x, w1, w2, w3, w4):
        B, S, D = x.shape
        h = _gelu(_layernorm(x, axis=-1) @ w1)
        c = D // 4
        g0 = _pad(h[:, :, 0*c:1*c], ((0, 0), (1, 0), (0, 0)))[:, :S, :]
        g1 = _pad(h[:, :, 1*c:2*c], ((0, 0), (0, 1), (0, 0)))[:, 1:, :]
        g2 = _pad(h[:, :, 2*c:3*c], ((0, 0), (2, 0), (0, 0)))[:, :S, :]
        g3 = _pad(h[:, :, 3*c:   ], ((0, 0), (0, 2), (0, 0)))[:, 2:, :]
        hs = torch.concatenate([g0, g1, g2, g3], axis=-1) @ w2
        x1 = x + hs
        h2 = _gelu(_layernorm(x1, axis=-1) @ w3) @ w4
        return x1 + h2

    x = A_x
    g = _sigmoid((x * gate_w).sum(-1, keepdims=True))
    a = _A_ref(x, A_wqkv, A_wo)
    b = _B_ref(x, B_w1, B_w2, B_w3, B_w4)
    return g * a + (1 - g) * b
```

```asm
; @launch grid=(256,1,1) block=(512,1,1) lds=163840
.amdgcn_target "amdgcn-amd-amdhsa--gfx950"
.text
.globl gated_mix__sliding_block__mixer_s_mlp__prompt_kernel
.p2align 8
.type gated_mix__sliding_block__mixer_s_mlp__prompt_kernel,@function
gated_mix__sliding_block__mixer_s_mlp__prompt_kernel:
    s_cmp_ge_u32 s2, 256
    s_cbranch_scc1 L_end
    s_load_dwordx16 s[4:19], s[0:1], 0
    s_load_dwordx8 s[20:27], s[0:1], 64
    v_lshrrev_b32 v1, 6, v0
    v_and_b32 v0, 63, v0
    v_readfirstlane_b32 s31, v1
    s_nop 0
    s_cmp_eq_u32 s31, 6
    s_cbranch_scc0 L_noaux
    s_getpc_b64 s[56:57]
L_pc:
    s_sub_u32 s56, s56, L_pc-gated_mix__sliding_block__mixer_s_mlp__prompt_kernel
    s_subb_u32 s57, s57, 0
    s_lshr_b32 s58, s2, 3
    s_lshl_b32 s58, s58, 11
    v_lshlrev_b32 v4, 4, v0
    v_add_u32 v3, s58, v4
    v_min_u32 v5, L_last-gated_mix__sliding_block__mixer_s_mlp__prompt_kernel-16, v3
    global_load_dwordx4 v[32:35], v5, s[56:57]
    v_add_u32 v3, 1024, v3
    v_min_u32 v5, L_last-gated_mix__sliding_block__mixer_s_mlp__prompt_kernel-16, v3
    global_load_dwordx4 v[36:39], v5, s[56:57]
L_noaux:
    s_and_b32 s47, s2, 7
    s_lshr_b32 s48, s2, 3
    s_lshr_b32 s28, s47, 1
    s_lshl_b32 s28, s28, 3
    s_lshr_b32 s49, s48, 2
    s_add_u32 s28, s28, s49
    s_and_b32 s29, s47, 1
    s_lshl_b32 s29, s29, 2
    s_and_b32 s49, s48, 3
    s_add_u32 s29, s29, s49
    s_add_u32 s30, s28, s29
    s_and_b32 s30, s30, 7
    s_mov_b32 s46, s30
    s_mov_b32 s33, 4194304
    s_mov_b32 s38, 21233664
    s_mov_b32 s39, 0x20000
    s_mov_b32 s43, 0x20000
    s_cmp_lt_u32 s31, 4
    s_cbranch_scc1 L_comp
    s_cmp_eq_u32 s31, 7
    s_cbranch_scc1 L_flag
    s_cmp_eq_u32 s31, 6
    s_cbranch_scc1 L_aux
L_load:
    s_setprio 3
    s_sub_u32 s54, s31, 4
    s_lshl_b32 s47, s54, 5
    v_lshrrev_b32 v1, 3, v0
    v_add_u32 v1, s47, v1
    v_and_b32 v3, 7, v0
    v_lshrrev_b32 v2, 4, v0
    v_xor_b32 v2, v2, v3
    v_lshlrev_b32 v4, 10, v1
    v_lshl_add_u32 v10, v2, 4, v4
    v_xor_b32 v2, 4, v2
    v_lshl_add_u32 v11, v2, 4, v4
    v_add_u32 v11, 7168, v11
    v_add_u32 v12, 14336, v10
    v_add_u32 v13, 14336, v11
    v_bfe_u32 v2, v0, 4, 1
    v_lshlrev_b32 v2, 2, v2
    v_xor_b32 v2, v2, v3
    v_lshlrev_b32 v2, 4, v2
    s_lshl_b32 s47, s29, 7
    v_add_u32 v2, s47, v2
    v_add_u32 v28, v4, v2
    v_add_u32 v29, 7168, v28
    v_add_u32 v30, 7168, v29
    v_add_u32 v31, 7168, v30
    s_lshl_b32 s54, s54, 12
    s_lshl_b32 s68, s28, 16
    s_mov_b32 s82, 2097152
    s_mov_b32 s83, 0x20000
    s_lshl_b32 s47, s46, 7
    v_lshlrev_b32 v5, 4, v0
    v_add_u32 v6, s47, v5
    v_and_b32 v6, 1023, v6
    s_waitcnt lgkmcnt(0)
    s_load_dword s100, s[4:5], 0
    s_load_dword s100, s[12:13], 0
    s_load_dword s100, s[20:21], 0
    s_mov_b32 s80, s4
    s_mov_b32 s81, s5
    s_mov_b32 s40, s20
    s_mov_b32 s41, s21
    s_mov_b32 s42, 1024
    s_mov_b32 m0, 155648
    s_mov_b32 s36, s26
    s_mov_b32 s37, s27
    buffer_load_dwordx4 v6, s[40:43], 0 offen lds
    s_mov_b32 s87, 0x20000
    s_lshl_b32 s88, s2, 1
    s_add_u32 s88, s88, s31
    s_sub_u32 s88, s88, 4
    s_add_u32 m0, s54, 0
    s_add_u32 s92, s46, 0
    s_and_b32 s92, s92, 7
    s_lshl_b32 s51, s92, 7
    s_add_u32 s51, s51, s68
    buffer_load_dwordx4 v10, s[80:83], s51 offen offset:0 sc1 lds
    buffer_load_dwordx4 v11, s[80:83], s51 offen offset:1024 sc1 lds
    buffer_load_dwordx4 v12, s[80:83], s51 offen offset:2048 sc1 lds
    buffer_load_dwordx4 v13, s[80:83], s51 offen offset:3072 sc1 lds
    s_mov_b32 s40, s12
    s_mov_b32 s41, s13
    s_mov_b32 s42, 524288
    s_add_u32 m0, s54, 65536
    s_mul_i32 s51, s92, 65536
    buffer_load_dwordx4 v28, s[40:43], s51 offen offset:0  lds
    buffer_load_dwordx4 v29, s[40:43], s51 offen offset:1024  lds
    buffer_load_dwordx4 v30, s[40:43], s51 offen offset:2048  lds
    buffer_load_dwordx4 v31, s[40:43], s51 offen offset:3072  lds
    s_add_u32 m0, s54, 8192
    s_add_u32 s93, s46, 1
    s_and_b32 s93, s93, 7
    s_lshl_b32 s51, s93, 7
    s_add_u32 s51, s51, s68
    buffer_load_dwordx4 v10, s[80:83], s51 offen offset:0 sc1 lds
    buffer_load_dwordx4 v11, s[80:83], s51 offen offset:1024 sc1 lds
    buffer_load_dwordx4 v12, s[80:83], s51 offen offset:2048 sc1 lds
    buffer_load_dwordx4 v13, s[80:83], s51 offen offset:3072 sc1 lds
    s_add_u32 m0, s54, 73728
    s_mul_i32 s51, s93, 65536
    buffer_load_dwordx4 v28, s[40:43], s51 offen offset:0  lds
    buffer_load_dwordx4 v29, s[40:43], s51 offen offset:1024  lds
    buffer_load_dwordx4 v30, s[40:43], s51 offen offset:2048  lds
    buffer_load_dwordx4 v31, s[40:43], s51 offen offset:3072  lds
    s_add_u32 m0, s54, 16384
    s_add_u32 s94, s46, 2
    s_and_b32 s94, s94, 7
    s_lshl_b32 s51, s94, 7
    s_add_u32 s51, s51, s68
    buffer_load_dwordx4 v10, s[80:83], s51 offen offset:0 sc1 lds
    buffer_load_dwordx4 v11, s[80:83], s51 offen offset:1024 sc1 lds
    buffer_load_dwordx4 v12, s[80:83], s51 offen offset:2048 sc1 lds
    buffer_load_dwordx4 v13, s[80:83], s51 offen offset:3072 sc1 lds
    s_add_u32 m0, s54, 81920
    s_mul_i32 s51, s94, 65536
    buffer_load_dwordx4 v28, s[40:43], s51 offen offset:0  lds
    buffer_load_dwordx4 v29, s[40:43], s51 offen offset:1024  lds
    buffer_load_dwordx4 v30, s[40:43], s51 offen offset:2048  lds
    buffer_load_dwordx4 v31, s[40:43], s51 offen offset:3072  lds
    s_add_u32 m0, s54, 24576
    s_add_u32 s95, s46, 3
    s_and_b32 s95, s95, 7
    s_lshl_b32 s51, s95, 7
    s_add_u32 s51, s51, s68
    buffer_load_dwordx4 v10, s[80:83], s51 offen offset:0 sc1 lds
    buffer_load_dwordx4 v11, s[80:83], s51 offen offset:1024 sc1 lds
    buffer_load_dwordx4 v12, s[80:83], s51 offen offset:2048 sc1 lds
    buffer_load_dwordx4 v13, s[80:83], s51 offen offset:3072 sc1 lds
    s_waitcnt vmcnt(20)
    s_barrier
    s_add_u32 m0, s54, 90112
    s_mul_i32 s51, s95, 65536
    buffer_load_dwordx4 v28, s[40:43], s51 offen offset:0  lds
    buffer_load_dwordx4 v29, s[40:43], s51 offen offset:1024  lds
    buffer_load_dwordx4 v30, s[40:43], s51 offen offset:2048  lds
    buffer_load_dwordx4 v31, s[40:43], s51 offen offset:3072  lds
    s_add_u32 m0, s54, 32768
    s_add_u32 s96, s46, 4
    s_and_b32 s96, s96, 7
    s_lshl_b32 s51, s96, 7
    s_add_u32 s51, s51, s68
    buffer_load_dwordx4 v10, s[80:83], s51 offen offset:0 sc1 lds
    buffer_load_dwordx4 v11, s[80:83], s51 offen offset:1024 sc1 lds
    buffer_load_dwordx4 v12, s[80:83], s51 offen offset:2048 sc1 lds
    buffer_load_dwordx4 v13, s[80:83], s51 offen offset:3072 sc1 lds
    s_add_u32 m0, s54, 98304
    s_mul_i32 s51, s96, 65536
    buffer_load_dwordx4 v28, s[40:43], s51 offen offset:0  lds
    buffer_load_dwordx4 v29, s[40:43], s51 offen offset:1024  lds
    buffer_load_dwordx4 v30, s[40:43], s51 offen offset:2048  lds
    buffer_load_dwordx4 v31, s[40:43], s51 offen offset:3072  lds
    v_mul_u32_u24 v3, 3072, v1
    v_add_u32 v24, v3, v2
    v_add_u32 v25, 23552, v24
    v_add_u32 v26, 23552, v25
    v_add_u32 v27, 23552, v26
    s_waitcnt vmcnt(24)
    s_barrier
    s_add_u32 m0, s54, 40960
    s_add_u32 s97, s46, 5
    s_and_b32 s97, s97, 7
    s_lshl_b32 s51, s97, 7
    s_add_u32 s51, s51, s68
    buffer_load_dwordx4 v10, s[80:83], s51 offen offset:0 sc1 lds
    buffer_load_dwordx4 v11, s[80:83], s51 offen offset:1024 sc1 lds
    buffer_load_dwordx4 v12, s[80:83], s51 offen offset:2048 sc1 lds
    buffer_load_dwordx4 v13, s[80:83], s51 offen offset:3072 sc1 lds
    s_add_u32 m0, s54, 106496
    s_mul_i32 s51, s97, 65536
    buffer_load_dwordx4 v28, s[40:43], s51 offen offset:0  lds
    buffer_load_dwordx4 v29, s[40:43], s51 offen offset:1024  lds
    buffer_load_dwordx4 v30, s[40:43], s51 offen offset:2048  lds
    buffer_load_dwordx4 v31, s[40:43], s51 offen offset:3072  lds
    s_add_u32 m0, s54, 49152
    s_add_u32 s98, s46, 6
    s_and_b32 s98, s98, 7
    s_lshl_b32 s51, s98, 7
    s_add_u32 s51, s51, s68
    buffer_load_dwordx4 v10, s[80:83], s51 offen offset:0 sc1 lds
    buffer_load_dwordx4 v11, s[80:83], s51 offen offset:1024 sc1 lds
    buffer_load_dwordx4 v12, s[80:83], s51 offen offset:2048 sc1 lds
    buffer_load_dwordx4 v13, s[80:83], s51 offen offset:3072 sc1 lds
    s_waitcnt vmcnt(28)
    s_barrier
    s_add_u32 m0, s54, 0
    s_mul_i32 s51, s98, 65536
    buffer_load_dwordx4 v28, s[40:43], s51 offen offset:0  lds
    buffer_load_dwordx4 v29, s[40:43], s51 offen offset:1024  lds
    buffer_load_dwordx4 v30, s[40:43], s51 offen offset:2048  lds
    buffer_load_dwordx4 v31, s[40:43], s51 offen offset:3072  lds
    s_add_u32 m0, s54, 57344
    s_add_u32 s99, s46, 7
    s_and_b32 s99, s99, 7
    s_lshl_b32 s51, s99, 7
    s_add_u32 s51, s51, s68
    buffer_load_dwordx4 v10, s[80:83], s51 offen offset:0 sc1 lds
    buffer_load_dwordx4 v11, s[80:83], s51 offen offset:1024 sc1 lds
    buffer_load_dwordx4 v12, s[80:83], s51 offen offset:2048 sc1 lds
    buffer_load_dwordx4 v13, s[80:83], s51 offen offset:3072 sc1 lds
    s_add_u32 m0, s54, 65536
    s_mul_i32 s51, s99, 65536
    buffer_load_dwordx4 v28, s[40:43], s51 offen offset:0  lds
    buffer_load_dwordx4 v29, s[40:43], s51 offen offset:1024  lds
    buffer_load_dwordx4 v30, s[40:43], s51 offen offset:2048  lds
    buffer_load_dwordx4 v31, s[40:43], s51 offen offset:3072  lds
    s_mov_b32 s84, s6
    s_mov_b32 s85, s7
    s_mov_b32 s86, 1572864
    s_mul_i32 s51, s88, 3072
    buffer_load_dwordx4 v[48:51], v5, s[84:87], s51 offen offset:0
    buffer_load_dwordx4 v[48:51], v5, s[84:87], s51 offen offset:1024
    buffer_load_dwordx4 v[48:51], v5, s[84:87], s51 offen offset:2048
    s_mov_b32 s84, s14
    s_mov_b32 s85, s15
    s_mov_b32 s86, 524288
    s_mul_i32 s51, s88, 1024
    buffer_load_dwordx4 v[48:51], v5, s[84:87], s51 offen offset:0
    s_waitcnt vmcnt(36)
    s_barrier
    s_mov_b32 s40, s6
    s_mov_b32 s41, s7
    s_mov_b32 s42, 1572864
    s_add_u32 m0, s54, 8192
    s_mul_i32 s51, s92, 196608
    s_add_u32 s51, s51, 1024
    buffer_load_dwordx4 v24, s[40:43], s51 offen offset:0  lds
    buffer_load_dwordx4 v25, s[40:43], s51 offen offset:1024  lds
    buffer_load_dwordx4 v26, s[40:43], s51 offen offset:2048  lds
    buffer_load_dwordx4 v27, s[40:43], s51 offen offset:3072  lds
    s_add_u32 m0, s54, 73728
    s_mul_i32 s51, s93, 196608
    s_add_u32 s51, s51, 1024
    buffer_load_dwordx4 v24, s[40:43], s51 offen offset:0  lds
    buffer_load_dwordx4 v25, s[40:43], s51 offen offset:1024  lds
    buffer_load_dwordx4 v26, s[40:43], s51 offen offset:2048  lds
    buffer_load_dwordx4 v27, s[40:43], s51 offen offset:3072  lds
    s_add_u32 m0, s54, 114688
    s_mul_i32 s51, s94, 196608
    s_add_u32 s51, s51, 1024
    buffer_load_dwordx4 v24, s[40:43], s51 offen offset:0  lds
    buffer_load_dwordx4 v25, s[40:43], s51 offen offset:1024  lds
    buffer_load_dwordx4 v26, s[40:43], s51 offen offset:2048  lds
    buffer_load_dwordx4 v27, s[40:43], s51 offen offset:3072  lds
    s_waitcnt vmcnt(40)
    s_barrier
    s_waitcnt vmcnt(32)
    s_barrier
    s_waitcnt vmcnt(24)
    s_barrier
    s_add_u32 m0, s54, 16384
    s_mul_i32 s51, s95, 196608
    s_add_u32 s51, s51, 1024
    buffer_load_dwordx4 v24, s[40:43], s51 offen offset:0  lds
    buffer_load_dwordx4 v25, s[40:43], s51 offen offset:1024  lds
    buffer_load_dwordx4 v26, s[40:43], s51 offen offset:2048  lds
    buffer_load_dwordx4 v27, s[40:43], s51 offen offset:3072  lds
    s_add_u32 m0, s54, 24576
    s_mul_i32 s51, s96, 196608
    s_add_u32 s51, s51, 1024
    buffer_load_dwordx4 v24, s[40:43], s51 offen offset:0  lds
    buffer_load_dwordx4 v25, s[40:43], s51 offen offset:1024  lds
    buffer_load_dwordx4 v26, s[40:43], s51 offen offset:2048  lds
    buffer_load_dwordx4 v27, s[40:43], s51 offen offset:3072  lds
    s_add_u32 m0, s54, 32768
    s_mul_i32 s51, s97, 196608
    s_add_u32 s51, s51, 1024
    buffer_load_dwordx4 v24, s[40:43], s51 offen offset:0  lds
    buffer_load_dwordx4 v25, s[40:43], s51 offen offset:1024  lds
    buffer_load_dwordx4 v26, s[40:43], s51 offen offset:2048  lds
    buffer_load_dwordx4 v27, s[40:43], s51 offen offset:3072  lds
    s_add_u32 m0, s54, 81920
    s_mul_i32 s51, s98, 196608
    s_add_u32 s51, s51, 1024
    buffer_load_dwordx4 v24, s[40:43], s51 offen offset:0  lds
    buffer_load_dwordx4 v25, s[40:43], s51 offen offset:1024  lds
    buffer_load_dwordx4 v26, s[40:43], s51 offen offset:2048  lds
    buffer_load_dwordx4 v27, s[40:43], s51 offen offset:3072  lds
    v_mul_u32_u24 v3, 2752, v1
    v_add_u32 v32, v3, v2
    v_add_u32 v33, 20992, v32
    v_add_u32 v34, 20992, v33
    v_add_u32 v35, 20992, v34
    s_add_u32 s60, s30, 0
    s_and_b32 s60, s60, 7
    s_add_u32 s61, s30, 1
    s_and_b32 s61, s61, 7
    s_add_u32 s62, s30, 2
    s_and_b32 s62, s62, 7
    s_add_u32 s63, s30, 3
    s_and_b32 s63, s63, 7
    s_add_u32 s64, s30, 4
    s_and_b32 s64, s64, 7
    s_add_u32 s65, s30, 5
    s_and_b32 s65, s65, 7
    s_add_u32 s66, s30, 6
    s_and_b32 s66, s66, 7
    s_add_u32 s67, s30, 7
    s_and_b32 s67, s67, 7
    s_waitcnt vmcnt(32)
    s_barrier
    s_add_u32 m0, s54, 40960
    s_mul_i32 s51, s99, 196608
    s_add_u32 s51, s51, 1024
    buffer_load_dwordx4 v24, s[40:43], s51 offen offset:0  lds
    buffer_load_dwordx4 v25, s[40:43], s51 offen offset:1024  lds
    buffer_load_dwordx4 v26, s[40:43], s51 offen offset:2048  lds
    buffer_load_dwordx4 v27, s[40:43], s51 offen offset:3072  lds
    s_add_u32 m0, s54, 90112
    s_mul_i32 s51, s92, 196608
    s_add_u32 s51, s51, 2048
    buffer_load_dwordx4 v24, s[40:43], s51 offen offset:0  lds
    buffer_load_dwordx4 v25, s[40:43], s51 offen offset:1024  lds
    buffer_load_dwordx4 v26, s[40:43], s51 offen offset:2048  lds
    buffer_load_dwordx4 v27, s[40:43], s51 offen offset:3072  lds
    v_add_u32 v14, s54, v5
    s_cmp_ge_u32 s29, 6
    s_cselect_b32 s52, 0x200000, 0
    s_add_u32 s52, s52, 2048
    s_lshl_b32 s78, s29, 7
    s_add_u32 s79, s78, 128
    s_add_u32 s69, s68, 1048576
    s_add_u32 s71, s68, 10485760
    s_mul_i32 s70, s28, 73728
    s_add_u32 s70, s70, 7340032
    s_mul_i32 s72, s28, 180224
    s_add_u32 s72, s72, 12582912
    v_and_b32 v7, 512, v5
    v_mov_b32 v8, 0x80000000
    s_add_i32 s48, s28, -4
    s_max_i32 s48, s48, 0
    s_lshl_b32 s48, s48, 3
    s_add_u32 s48, s48, s29
    s_lshl_b32 s48, s48, 14
    s_add_u32 s73, s48, 3145728
    s_cmp_lt_u32 s28, 4
    s_cselect_b64 vcc, -1, 0
    v_cndmask_b32 v36, v14, v7, vcc
    v_cndmask_b32 v37, v14, v8, vcc
    s_add_i32 s48, s28, -3
    s_max_i32 s48, s48, 0
    s_lshl_b32 s48, s48, 3
    s_add_u32 s48, s48, s29
    s_lshl_b32 s48, s48, 14
    s_add_u32 s74, s48, 3145728
    s_cmp_lt_u32 s28, 3
    s_cselect_b64 vcc, -1, 0
    v_cndmask_b32 v38, v14, v7, vcc
    v_cndmask_b32 v39, v14, v8, vcc
    s_add_i32 s48, s28, -2
    s_max_i32 s48, s48, 0
    s_lshl_b32 s48, s48, 3
    s_add_u32 s48, s48, s29
    s_lshl_b32 s48, s48, 14
    s_add_u32 s75, s48, 3145728
    s_cmp_lt_u32 s28, 2
    s_cselect_b64 vcc, -1, 0
    v_cndmask_b32 v40, v14, v7, vcc
    v_cndmask_b32 v41, v14, v8, vcc
    s_add_i32 s48, s28, -1
    s_max_i32 s48, s48, 0
    s_lshl_b32 s48, s48, 3
    s_add_u32 s48, s48, s29
    s_lshl_b32 s48, s48, 14
    s_add_u32 s76, s48, 3145728
    s_cmp_lt_u32 s28, 1
    s_cselect_b64 vcc, -1, 0
    v_cndmask_b32 v42, v14, v7, vcc
    v_cndmask_b32 v43, v14, v8, vcc
    s_add_i32 s48, s28, 0
    s_max_i32 s48, s48, 0
    s_lshl_b32 s48, s48, 3
    s_add_u32 s48, s48, s29
    s_lshl_b32 s48, s48, 14
    s_add_u32 s77, s48, 3145728
    s_branch L_load2
    .p2align 12
L_load2:
L_pg0:
    s_cbranch_execz L_pr0
    s_barrier
    s_waitcnt vmcnt(32)
    s_barrier
    s_waitcnt vmcnt(28)
    s_barrier
    s_add_u32 m0, s54, 0
    s_mul_i32 s51, s93, 196608
    s_add_u32 s51, s51, 2048
    buffer_load_dwordx4 v24, s[40:43], s51 offen offset:0  lds
    buffer_load_dwordx4 v25, s[40:43], s51 offen offset:1024  lds
    buffer_load_dwordx4 v26, s[40:43], s51 offen offset:2048  lds
    buffer_load_dwordx4 v27, s[40:43], s51 offen offset:3072  lds
    s_add_u32 m0, s54, 49152
    s_mul_i32 s51, s94, 196608
    s_add_u32 s51, s51, 2048
    buffer_load_dwordx4 v24, s[40:43], s51 offen offset:0  lds
    buffer_load_dwordx4 v25, s[40:43], s51 offen offset:1024  lds
    buffer_load_dwordx4 v26, s[40:43], s51 offen offset:2048  lds
    buffer_load_dwordx4 v27, s[40:43], s51 offen offset:3072  lds
    s_waitcnt vmcnt(32)
    s_barrier
    s_add_u32 m0, s54, 8192
    s_mul_i32 s51, s95, 196608
    s_add_u32 s51, s51, 2048
    buffer_load_dwordx4 v24, s[40:43], s51 offen offset:0  lds
    buffer_load_dwordx4 v25, s[40:43], s51 offen offset:1024  lds
    buffer_load_dwordx4 v26, s[40:43], s51 offen offset:2048  lds
    buffer_load_dwordx4 v27, s[40:43], s51 offen offset:3072  lds
    s_waitcnt vmcnt(32)
    s_barrier
    s_add_u32 m0, s54, 57344
    s_mul_i32 s51, s96, 196608
    s_add_u32 s51, s51, 2048
    buffer_load_dwordx4 v24, s[40:43], s51 offen offset:0  lds
    buffer_load_dwordx4 v25, s[40:43], s51 offen offset:1024  lds
    buffer_load_dwordx4 v26, s[40:43], s51 offen offset:2048  lds
    buffer_load_dwordx4 v27, s[40:43], s51 offen offset:3072  lds
    s_waitcnt vmcnt(32)
    s_barrier
    s_add_u32 m0, s54, 65536
    s_mul_i32 s51, s97, 196608
    s_add_u32 s51, s51, 2048
    buffer_load_dwordx4 v24, s[40:43], s51 offen offset:0  lds
    buffer_load_dwordx4 v25, s[40:43], s51 offen offset:1024  lds
    buffer_load_dwordx4 v26, s[40:43], s51 offen offset:2048  lds
    buffer_load_dwordx4 v27, s[40:43], s51 offen offset:3072  lds
    s_waitcnt vmcnt(32)
    s_barrier
    s_add_u32 m0, s54, 16384
    s_mul_i32 s51, s98, 196608
    s_add_u32 s51, s51, 2048
    buffer_load_dwordx4 v24, s[40:43], s51 offen offset:0  lds
    buffer_load_dwordx4 v25, s[40:43], s51 offen offset:1024  lds
    buffer_load_dwordx4 v26, s[40:43], s51 offen offset:2048  lds
    buffer_load_dwordx4 v27, s[40:43], s51 offen offset:3072  lds
    s_waitcnt vmcnt(32)
    s_barrier
    s_add_u32 m0, s54, 24576
    s_mul_i32 s51, s99, 196608
    s_add_u32 s51, s51, 2048
    buffer_load_dwordx4 v24, s[40:43], s51 offen offset:0  lds
    buffer_load_dwordx4 v25, s[40:43], s51 offen offset:1024  lds
    buffer_load_dwordx4 v26, s[40:43], s51 offen offset:2048  lds
    buffer_load_dwordx4 v27, s[40:43], s51 offen offset:3072  lds
    s_waitcnt vmcnt(32)
    s_barrier
    s_add_u32 m0, s54, 32768
    s_mul_i32 s51, s92, 196608
    buffer_load_dwordx4 v24, s[40:43], s51 offen offset:0  lds
    buffer_load_dwordx4 v25, s[40:43], s51 offen offset:1024  lds
    buffer_load_dwordx4 v26, s[40:43], s51 offen offset:2048  lds
    buffer_load_dwordx4 v27, s[40:43], s51 offen offset:3072  lds
    s_waitcnt vmcnt(32)
    s_barrier
    s_add_u32 m0, s54, 73728
    s_mul_i32 s51, s93, 196608
    buffer_load_dwordx4 v24, s[40:43], s51 offen offset:0  lds
    buffer_load_dwordx4 v25, s[40:43], s51 offen offset:1024  lds
    buffer_load_dwordx4 v26, s[40:43], s51 offen offset:2048  lds
    buffer_load_dwordx4 v27, s[40:43], s51 offen offset:3072  lds
    s_waitcnt vmcnt(32)
    s_barrier
    s_add_u32 m0, s54, 40960
    s_mul_i32 s51, s94, 196608
    buffer_load_dwordx4 v24, s[40:43], s51 offen offset:0  lds
    buffer_load_dwordx4 v25, s[40:43], s51 offen offset:1024  lds
    buffer_load_dwordx4 v26, s[40:43], s51 offen offset:2048  lds
    buffer_load_dwordx4 v27, s[40:43], s51 offen offset:3072  lds
    s_waitcnt vmcnt(32)
    s_barrier
    s_add_u32 m0, s54, 81920
    s_mul_i32 s51, s95, 196608
    buffer_load_dwordx4 v24, s[40:43], s51 offen offset:0  lds
    buffer_load_dwordx4 v25, s[40:43], s51 offen offset:1024  lds
    buffer_load_dwordx4 v26, s[40:43], s51 offen offset:2048  lds
    buffer_load_dwordx4 v27, s[40:43], s51 offen offset:3072  lds
    s_waitcnt vmcnt(32)
    s_barrier
    s_add_u32 m0, s54, 0
    s_mul_i32 s51, s96, 196608
    buffer_load_dwordx4 v24, s[40:43], s51 offen offset:0  lds
    buffer_load_dwordx4 v25, s[40:43], s51 offen offset:1024  lds
    buffer_load_dwordx4 v26, s[40:43], s51 offen offset:2048  lds
    buffer_load_dwordx4 v27, s[40:43], s51 offen offset:3072  lds
    s_waitcnt vmcnt(32)
    s_barrier
    s_add_u32 m0, s54, 49152
    s_mul_i32 s51, s97, 196608
    buffer_load_dwordx4 v24, s[40:43], s51 offen offset:0  lds
    buffer_load_dwordx4 v25, s[40:43], s51 offen offset:1024  lds
    buffer_load_dwordx4 v26, s[40:43], s51 offen offset:2048  lds
    buffer_load_dwordx4 v27, s[40:43], s51 offen offset:3072  lds
    s_waitcnt vmcnt(32)
    s_barrier
    s_add_u32 m0, s54, 8192
    s_mul_i32 s51, s98, 196608
    buffer_load_dwordx4 v24, s[40:43], s51 offen offset:0  lds
    buffer_load_dwordx4 v25, s[40:43], s51 offen offset:1024  lds
    buffer_load_dwordx4 v26, s[40:43], s51 offen offset:2048  lds
    buffer_load_dwordx4 v27, s[40:43], s51 offen offset:3072  lds
    s_waitcnt vmcnt(32)
    s_barrier
    s_add_u32 m0, s54, 57344
    s_mul_i32 s51, s99, 196608
    buffer_load_dwordx4 v24, s[40:43], s51 offen offset:0  lds
    buffer_load_dwordx4 v25, s[40:43], s51 offen offset:1024  lds
    buffer_load_dwordx4 v26, s[40:43], s51 offen offset:2048  lds
    buffer_load_dwordx4 v27, s[40:43], s51 offen offset:3072  lds
    s_waitcnt vmcnt(32)
    s_barrier
    s_mov_b32 s40, s14
    s_mov_b32 s41, s15
    s_mov_b32 s42, 524288
    s_add_u32 m0, s54, 65536
    s_mul_i32 s51, s60, 65536
    buffer_load_dwordx4 v28, s[40:43], s51 offen offset:0  lds
    buffer_load_dwordx4 v29, s[40:43], s51 offen offset:1024  lds
    buffer_load_dwordx4 v30, s[40:43], s51 offen offset:2048  lds
    buffer_load_dwordx4 v31, s[40:43], s51 offen offset:3072  lds
    s_waitcnt vmcnt(32)
    s_barrier
    s_add_u32 m0, s54, 16384
    s_mul_i32 s51, s61, 65536
    buffer_load_dwordx4 v28, s[40:43], s51 offen offset:0  lds
    buffer_load_dwordx4 v29, s[40:43], s51 offen offset:1024  lds
    buffer_load_dwordx4 v30, s[40:43], s51 offen offset:2048  lds
    buffer_load_dwordx4 v31, s[40:43], s51 offen offset:3072  lds
    s_waitcnt vmcnt(32)
    s_barrier
    s_add_u32 m0, s54, 24576
    s_mul_i32 s51, s62, 65536
    buffer_load_dwordx4 v28, s[40:43], s51 offen offset:0  lds
    buffer_load_dwordx4 v29, s[40:43], s51 offen offset:1024  lds
    buffer_load_dwordx4 v30, s[40:43], s51 offen offset:2048  lds
    buffer_load_dwordx4 v31, s[40:43], s51 offen offset:3072  lds
    s_waitcnt vmcnt(32)
    s_barrier
    s_add_u32 m0, s54, 32768
    s_lshl_b32 s51, s60, 13
    s_add_u32 s51, s51, s69
    buffer_load_dwordx4 v14, s[36:39], s51 offen offset:0 sc1 lds
    buffer_load_dwordx4 v14, s[36:39], s51 offen offset:1024 sc1 lds
    buffer_load_dwordx4 v14, s[36:39], s51 offen offset:2048 sc1 lds
    buffer_load_dwordx4 v14, s[36:39], s51 offen offset:3072 sc1 lds
    s_waitcnt vmcnt(32)
    s_barrier
    s_add_u32 m0, s54, 73728
    s_lshl_b32 s51, s61, 13
    s_add_u32 s51, s51, s69
    buffer_load_dwordx4 v14, s[36:39], s51 offen offset:0 sc1 lds
    buffer_load_dwordx4 v14, s[36:39], s51 offen offset:1024 sc1 lds
    buffer_load_dwordx4 v14, s[36:39], s51 offen offset:2048 sc1 lds
    buffer_load_dwordx4 v14, s[36:39], s51 offen offset:3072 sc1 lds
    s_waitcnt vmcnt(32)
    s_barrier
    s_add_u32 m0, s54, 40960
    s_lshl_b32 s51, s62, 13
    s_add_u32 s51, s51, s69
    buffer_load_dwordx4 v14, s[36:39], s51 offen offset:0 sc1 lds
    buffer_load_dwordx4 v14, s[36:39], s51 offen offset:1024 sc1 lds
    buffer_load_dwordx4 v14, s[36:39], s51 offen offset:2048 sc1 lds
    buffer_load_dwordx4 v14, s[36:39], s51 offen offset:3072 sc1 lds
    s_waitcnt vmcnt(32)
    s_barrier
    s_add_u32 m0, s54, 81920
    s_lshl_b32 s51, s63, 13
    s_add_u32 s51, s51, s69
    buffer_load_dwordx4 v14, s[36:39], s51 offen offset:0 sc1 lds
    buffer_load_dwordx4 v14, s[36:39], s51 offen offset:1024 sc1 lds
    buffer_load_dwordx4 v14, s[36:39], s51 offen offset:2048 sc1 lds
    buffer_load_dwordx4 v14, s[36:39], s51 offen offset:3072 sc1 lds
    s_waitcnt vmcnt(32)
    s_barrier
    s_add_u32 m0, s54, 0
    s_mul_i32 s51, s63, 65536
    buffer_load_dwordx4 v28, s[40:43], s51 offen offset:0  lds
    buffer_load_dwordx4 v29, s[40:43], s51 offen offset:1024  lds
    buffer_load_dwordx4 v30, s[40:43], s51 offen offset:2048  lds
    buffer_load_dwordx4 v31, s[40:43], s51 offen offset:3072  lds
    s_add_u32 m0, s54, 90112
    s_lshl_b32 s51, s64, 13
    s_add_u32 s51, s51, s69
    buffer_load_dwordx4 v14, s[36:39], s51 offen offset:0 sc1 lds
    buffer_load_dwordx4 v14, s[36:39], s51 offen offset:1024 sc1 lds
    buffer_load_dwordx4 v14, s[36:39], s51 offen offset:2048 sc1 lds
    buffer_load_dwordx4 v14, s[36:39], s51 offen offset:3072 sc1 lds
    s_waitcnt vmcnt(36)
    s_barrier
    s_add_u32 m0, s54, 49152
    s_mul_i32 s51, s64, 65536
    buffer_load_dwordx4 v28, s[40:43], s51 offen offset:0  lds
    buffer_load_dwordx4 v29, s[40:43], s51 offen offset:1024  lds
    buffer_load_dwordx4 v30, s[40:43], s51 offen offset:2048  lds
    buffer_load_dwordx4 v31, s[40:43], s51 offen offset:3072  lds
    s_waitcnt vmcnt(24)
    s_barrier
    s_add_u32 m0, s54, 98304
    s_lshl_b32 s51, s65, 13
    s_add_u32 s51, s51, s69
    buffer_load_dwordx4 v14, s[36:39], s51 offen offset:0 sc1 lds
    buffer_load_dwordx4 v14, s[36:39], s51 offen offset:1024 sc1 lds
    buffer_load_dwordx4 v14, s[36:39], s51 offen offset:2048 sc1 lds
    buffer_load_dwordx4 v14, s[36:39], s51 offen offset:3072 sc1 lds
    s_waitcnt vmcnt(24)
    s_barrier
    s_add_u32 m0, s54, 57344
    s_mul_i32 s51, s65, 65536
    buffer_load_dwordx4 v28, s[40:43], s51 offen offset:0  lds
    buffer_load_dwordx4 v29, s[40:43], s51 offen offset:1024  lds
    buffer_load_dwordx4 v30, s[40:43], s51 offen offset:2048  lds
    buffer_load_dwordx4 v31, s[40:43], s51 offen offset:3072  lds
    s_waitcnt vmcnt(24)
    s_barrier
    s_add_u32 m0, s54, 106496
    s_lshl_b32 s51, s66, 13
    s_add_u32 s51, s51, s69
    buffer_load_dwordx4 v14, s[36:39], s51 offen offset:0 sc1 lds
    buffer_load_dwordx4 v14, s[36:39], s51 offen offset:1024 sc1 lds
    buffer_load_dwordx4 v14, s[36:39], s51 offen offset:2048 sc1 lds
    buffer_load_dwordx4 v14, s[36:39], s51 offen offset:3072 sc1 lds
    s_add_u32 m0, s54, 114688
    s_mul_i32 s51, s66, 65536
    buffer_load_dwordx4 v28, s[40:43], s51 offen offset:0  lds
    buffer_load_dwordx4 v29, s[40:43], s51 offen offset:1024  lds
    buffer_load_dwordx4 v30, s[40:43], s51 offen offset:2048  lds
    buffer_load_dwordx4 v31, s[40:43], s51 offen offset:3072  lds
    s_waitcnt vmcnt(24)
    s_barrier
    s_add_u32 m0, s54, 122880
    s_lshl_b32 s51, s67, 13
    s_add_u32 s51, s51, s69
    buffer_load_dwordx4 v14, s[36:39], s51 offen offset:0 sc1 lds
    buffer_load_dwordx4 v14, s[36:39], s51 offen offset:1024 sc1 lds
    buffer_load_dwordx4 v14, s[36:39], s51 offen offset:2048 sc1 lds
    buffer_load_dwordx4 v14, s[36:39], s51 offen offset:3072 sc1 lds
    s_add_u32 m0, s54, 131072
    s_mul_i32 s51, s67, 65536
    buffer_load_dwordx4 v28, s[40:43], s51 offen offset:0  lds
    buffer_load_dwordx4 v29, s[40:43], s51 offen offset:1024  lds
    buffer_load_dwordx4 v30, s[40:43], s51 offen offset:2048  lds
    buffer_load_dwordx4 v31, s[40:43], s51 offen offset:3072  lds
    s_waitcnt vmcnt(24)
    s_barrier
    s_waitcnt vmcnt(16)
    s_barrier
    s_add_u32 m0, s54, 0
    s_add_u32 s51, s73, 0
    buffer_load_dwordx4 v36, s[36:39], s51 offen offset:0 sc1 lds
    buffer_load_dwordx4 v36, s[36:39], s51 offen offset:1024 sc1 lds
    buffer_load_dwordx4 v37, s[36:39], s51 offen offset:2048 sc1 lds
    buffer_load_dwordx4 v37, s[36:39], s51 offen offset:3072 sc1 lds
    s_waitcnt vmcnt(12)
    s_barrier
    s_add_u32 m0, s54, 8192
    s_add_u32 s51, s74, 0
    buffer_load_dwordx4 v38, s[36:39], s51 offen offset:0 sc1 lds
    buffer_load_dwordx4 v38, s[36:39], s51 offen offset:1024 sc1 lds
    buffer_load_dwordx4 v39, s[36:39], s51 offen offset:2048 sc1 lds
    buffer_load_dwordx4 v39, s[36:39], s51 offen offset:3072 sc1 lds
    s_add_u32 m0, s54, 16384
    s_add_u32 s51, s75, 0
    buffer_load_dwordx4 v40, s[36:39], s51 offen offset:0 sc1 lds
    buffer_load_dwordx4 v40, s[36:39], s51 offen offset:1024 sc1 lds
    buffer_load_dwordx4 v41, s[36:39], s51 offen offset:2048 sc1 lds
    buffer_load_dwordx4 v41, s[36:39], s51 offen offset:3072 sc1 lds
    s_add_u32 m0, s54, 24576
    s_add_u32 s51, s76, 0
    buffer_load_dwordx4 v42, s[36:39], s51 offen offset:0 sc1 lds
    buffer_load_dwordx4 v42, s[36:39], s51 offen offset:1024 sc1 lds
    buffer_load_dwordx4 v43, s[36:39], s51 offen offset:2048 sc1 lds
    buffer_load_dwordx4 v43, s[36:39], s51 offen offset:3072 sc1 lds
    s_add_u32 m0, s54, 32768
    s_add_u32 s51, s77, 0
    buffer_load_dwordx4 v14, s[36:39], s51 offen offset:0 sc1 lds
    buffer_load_dwordx4 v14, s[36:39], s51 offen offset:1024 sc1 lds
    buffer_load_dwordx4 v14, s[36:39], s51 offen offset:2048 sc1 lds
    buffer_load_dwordx4 v14, s[36:39], s51 offen offset:3072 sc1 lds
    s_waitcnt vmcnt(20)
    s_barrier
    s_add_u32 m0, s54, 40960
    s_add_u32 s51, s73, 8192
    buffer_load_dwordx4 v36, s[36:39], s51 offen offset:0 sc1 lds
    buffer_load_dwordx4 v36, s[36:39], s51 offen offset:1024 sc1 lds
    buffer_load_dwordx4 v37, s[36:39], s51 offen offset:2048 sc1 lds
    buffer_load_dwordx4 v37, s[36:39], s51 offen offset:3072 sc1 lds
    s_barrier
    s_add_u32 m0, s54, 49152
    s_add_u32 s51, s74, 8192
    buffer_load_dwordx4 v38, s[36:39], s51 offen offset:0 sc1 lds
    buffer_load_dwordx4 v38, s[36:39], s51 offen offset:1024 sc1 lds
    buffer_load_dwordx4 v39, s[36:39], s51 offen offset:2048 sc1 lds
    buffer_load_dwordx4 v39, s[36:39], s51 offen offset:3072 sc1 lds
    s_waitcnt vmcnt(8)
    s_barrier
    s_add_u32 m0, s54, 57344
    s_add_u32 s51, s75, 8192
    buffer_load_dwordx4 v40, s[36:39], s51 offen offset:0 sc1 lds
    buffer_load_dwordx4 v40, s[36:39], s51 offen offset:1024 sc1 lds
    buffer_load_dwordx4 v41, s[36:39], s51 offen offset:2048 sc1 lds
    buffer_load_dwordx4 v41, s[36:39], s51 offen offset:3072 sc1 lds
    s_add_u32 m0, s54, 65536
    s_add_u32 s51, s76, 8192
    buffer_load_dwordx4 v42, s[36:39], s51 offen offset:0 sc1 lds
    buffer_load_dwordx4 v42, s[36:39], s51 offen offset:1024 sc1 lds
    buffer_load_dwordx4 v43, s[36:39], s51 offen offset:2048 sc1 lds
    buffer_load_dwordx4 v43, s[36:39], s51 offen offset:3072 sc1 lds
    s_add_u32 m0, s54, 73728
    s_add_u32 s51, s77, 8192
    buffer_load_dwordx4 v14, s[36:39], s51 offen offset:0 sc1 lds
    buffer_load_dwordx4 v14, s[36:39], s51 offen offset:1024 sc1 lds
    buffer_load_dwordx4 v14, s[36:39], s51 offen offset:2048 sc1 lds
    buffer_load_dwordx4 v14, s[36:39], s51 offen offset:3072 sc1 lds
    s_mov_b32 s40, s16
    s_mov_b32 s41, s17
    s_mov_b32 s42, 1409024
    s_add_u32 m0, s54, 81920
    s_mul_i32 s51, s60, 176128
    s_add_u32 s51, s51, s78
    buffer_load_dwordx4 v32, s[40:43], s51 offen offset:0  lds
    buffer_load_dwordx4 v33, s[40:43], s51 offen offset:1024  lds
    buffer_load_dwordx4 v34, s[40:43], s51 offen offset:2048  lds
    buffer_load_dwordx4 v35, s[40:43], s51 offen offset:3072  lds
    s_barrier
    s_add_u32 m0, s54, 90112
    s_mul_i32 s51, s60, 176128
    s_add_u32 s51, s51, s79
    buffer_load_dwordx4 v32, s[40:43], s51 offen offset:0  lds
    buffer_load_dwordx4 v33, s[40:43], s51 offen offset:1024  lds
    buffer_load_dwordx4 v34, s[40:43], s51 offen offset:2048  lds
    buffer_load_dwordx4 v35, s[40:43], s51 offen offset:3072  lds
    s_barrier
    s_add_u32 m0, s54, 98304
    s_mul_i32 s51, s61, 176128
    s_add_u32 s51, s51, s78
    buffer_load_dwordx4 v32, s[40:43], s51 offen offset:0  lds
    buffer_load_dwordx4 v33, s[40:43], s51 offen offset:1024  lds
    buffer_load_dwordx4 v34, s[40:43], s51 offen offset:2048  lds
    buffer_load_dwordx4 v35, s[40:43], s51 offen offset:3072  lds
    s_barrier
    s_add_u32 m0, s54, 106496
    s_mul_i32 s51, s61, 176128
    s_add_u32 s51, s51, s79
    buffer_load_dwordx4 v32, s[40:43], s51 offen offset:0  lds
    buffer_load_dwordx4 v33, s[40:43], s51 offen offset:1024  lds
    buffer_load_dwordx4 v34, s[40:43], s51 offen offset:2048  lds
    buffer_load_dwordx4 v35, s[40:43], s51 offen offset:3072  lds
    s_waitcnt vmcnt(16)
    s_barrier
    s_add_u32 m0, s54, 0
    s_mul_i32 s51, s62, 176128
    s_add_u32 s51, s51, s78
    buffer_load_dwordx4 v32, s[40:43], s51 offen offset:0  lds
    buffer_load_dwordx4 v33, s[40:43], s51 offen offset:1024  lds
    buffer_load_dwordx4 v34, s[40:43], s51 offen offset:2048  lds
    buffer_load_dwordx4 v35, s[40:43], s51 offen offset:3072  lds
    s_barrier
    s_add_u32 m0, s54, 8192
    s_mul_i32 s51, s62, 176128
    s_add_u32 s51, s51, s79
    buffer_load_dwordx4 v32, s[40:43], s51 offen offset:0  lds
    buffer_load_dwordx4 v33, s[40:43], s51 offen offset:1024  lds
    buffer_load_dwordx4 v34, s[40:43], s51 offen offset:2048  lds
    buffer_load_dwordx4 v35, s[40:43], s51 offen offset:3072  lds
    s_barrier
    s_add_u32 m0, s54, 16384
    s_mul_i32 s51, s63, 176128
    s_add_u32 s51, s51, s78
    buffer_load_dwordx4 v32, s[40:43], s51 offen offset:0  lds
    buffer_load_dwordx4 v33, s[40:43], s51 offen offset:1024  lds
    buffer_load_dwordx4 v34, s[40:43], s51 offen offset:2048  lds
    buffer_load_dwordx4 v35, s[40:43], s51 offen offset:3072  lds
    s_barrier
    s_add_u32 m0, s54, 24576
    s_mul_i32 s51, s63, 176128
    s_add_u32 s51, s51, s79
    buffer_load_dwordx4 v32, s[40:43], s51 offen offset:0  lds
    buffer_load_dwordx4 v33, s[40:43], s51 offen offset:1024  lds
    buffer_load_dwordx4 v34, s[40:43], s51 offen offset:2048  lds
    buffer_load_dwordx4 v35, s[40:43], s51 offen offset:3072  lds
    s_add_u32 m0, s54, 32768
    s_mul_i32 s51, s64, 176128
    s_add_u32 s51, s51, s78
    buffer_load_dwordx4 v32, s[40:43], s51 offen offset:0  lds
    buffer_load_dwordx4 v33, s[40:43], s51 offen offset:1024  lds
    buffer_load_dwordx4 v34, s[40:43], s51 offen offset:2048  lds
    buffer_load_dwordx4 v35, s[40:43], s51 offen offset:3072  lds
    s_add_u32 m0, s54, 114688
    s_mul_i32 s51, s64, 176128
    s_add_u32 s51, s51, s79
    buffer_load_dwordx4 v32, s[40:43], s51 offen offset:0  lds
    buffer_load_dwordx4 v33, s[40:43], s51 offen offset:1024  lds
    buffer_load_dwordx4 v34, s[40:43], s51 offen offset:2048  lds
    buffer_load_dwordx4 v35, s[40:43], s51 offen offset:3072  lds
    s_add_u32 m0, s54, 122880
    s_mul_i32 s51, s65, 176128
    s_add_u32 s51, s51, s78
    buffer_load_dwordx4 v32, s[40:43], s51 offen offset:0  lds
    buffer_load_dwordx4 v33, s[40:43], s51 offen offset:1024  lds
    buffer_load_dwordx4 v34, s[40:43], s51 offen offset:2048  lds
    buffer_load_dwordx4 v35, s[40:43], s51 offen offset:3072  lds
    s_barrier
    s_add_u32 m0, s54, 40960
    s_add_u32 s51, s70, 65536
    buffer_load_dwordx4 v14, s[36:39], s51 offen offset:0 sc1 lds
    buffer_load_dwordx4 v14, s[36:39], s51 offen offset:1024 sc1 lds
    buffer_load_dwordx4 v14, s[36:39], s51 offen offset:2048 sc1 lds
    buffer_load_dwordx4 v14, s[36:39], s51 offen offset:3072 sc1 lds
    s_lshr_b32 s47, s54, 2
    s_sub_u32 s47, s54, s47
    s_add_u32 m0, s47, 155648
    s_lshl_b32 s51, s29, 13
    s_add_u32 s51, s51, s47
    s_add_u32 s51, s51, 589824
    buffer_load_dwordx4 v5, s[36:39], s51 offen offset:0 sc1 lds
    buffer_load_dwordx4 v5, s[36:39], s51 offen offset:1024 sc1 lds
    buffer_load_dwordx4 v5, s[36:39], s51 offen offset:2048 sc1 lds
    s_barrier
    s_add_u32 m0, s54, 49152
    s_lshl_b32 s51, s60, 13
    s_add_u32 s51, s51, s70
    buffer_load_dwordx4 v14, s[36:39], s51 offen offset:0 sc1 lds
    buffer_load_dwordx4 v14, s[36:39], s51 offen offset:1024 sc1 lds
    buffer_load_dwordx4 v14, s[36:39], s51 offen offset:2048 sc1 lds
    buffer_load_dwordx4 v14, s[36:39], s51 offen offset:3072 sc1 lds
    s_barrier
    s_add_u32 m0, s54, 57344
    s_lshl_b32 s51, s61, 13
    s_add_u32 s51, s51, s70
    buffer_load_dwordx4 v14, s[36:39], s51 offen offset:0 sc1 lds
    buffer_load_dwordx4 v14, s[36:39], s51 offen offset:1024 sc1 lds
    buffer_load_dwordx4 v14, s[36:39], s51 offen offset:2048 sc1 lds
    buffer_load_dwordx4 v14, s[36:39], s51 offen offset:3072 sc1 lds
    s_add_u32 m0, s54, 65536
    s_lshl_b32 s51, s62, 13
    s_add_u32 s51, s51, s70
    buffer_load_dwordx4 v14, s[36:39], s51 offen offset:0 sc1 lds
    buffer_load_dwordx4 v14, s[36:39], s51 offen offset:1024 sc1 lds
    buffer_load_dwordx4 v14, s[36:39], s51 offen offset:2048 sc1 lds
    buffer_load_dwordx4 v14, s[36:39], s51 offen offset:3072 sc1 lds
    s_barrier
    s_add_u32 m0, s54, 73728
    s_lshl_b32 s51, s63, 13
    s_add_u32 s51, s51, s70
    buffer_load_dwordx4 v14, s[36:39], s51 offen offset:0 sc1 lds
    buffer_load_dwordx4 v14, s[36:39], s51 offen offset:1024 sc1 lds
    buffer_load_dwordx4 v14, s[36:39], s51 offen offset:2048 sc1 lds
    buffer_load_dwordx4 v14, s[36:39], s51 offen offset:3072 sc1 lds
    s_barrier
    s_add_u32 m0, s54, 131072
    s_lshl_b32 s51, s64, 13
    s_add_u32 s51, s51, s70
    buffer_load_dwordx4 v14, s[36:39], s51 offen offset:0 sc1 lds
    buffer_load_dwordx4 v14, s[36:39], s51 offen offset:1024 sc1 lds
    buffer_load_dwordx4 v14, s[36:39], s51 offen offset:2048 sc1 lds
    buffer_load_dwordx4 v14, s[36:39], s51 offen offset:3072 sc1 lds
    s_barrier
    s_add_u32 m0, s54, 139264
    s_lshl_b32 s51, s65, 13
    s_add_u32 s51, s51, s70
    buffer_load_dwordx4 v14, s[36:39], s51 offen offset:0 sc1 lds
    buffer_load_dwordx4 v14, s[36:39], s51 offen offset:1024 sc1 lds
    buffer_load_dwordx4 v14, s[36:39], s51 offen offset:2048 sc1 lds
    buffer_load_dwordx4 v14, s[36:39], s51 offen offset:3072 sc1 lds
    s_add_u32 m0, s54, 147456
    s_mul_i32 s51, s65, 176128
    s_add_u32 s51, s51, s79
    buffer_load_dwordx4 v32, s[40:43], s51 offen offset:0  lds
    buffer_load_dwordx4 v33, s[40:43], s51 offen offset:1024  lds
    buffer_load_dwordx4 v34, s[40:43], s51 offen offset:2048  lds
    buffer_load_dwordx4 v35, s[40:43], s51 offen offset:3072  lds
    s_mov_b32 s84, s8
    s_mov_b32 s85, s9
    s_mov_b32 s86, 524288
    s_mul_i32 s51, s88, 1024
    buffer_load_dwordx4 v[48:51], v5, s[84:87], s51 offen offset:0
    s_mov_b32 s84, s18
    s_mov_b32 s85, s19
    s_mov_b32 s86, 1409024
    s_mul_i32 s51, s88, 3072
    buffer_load_dwordx4 v[48:51], v5, s[84:87], s51 offen offset:0
    buffer_load_dwordx4 v[48:51], v5, s[84:87], s51 offen offset:1024
    buffer_load_dwordx4 v[48:51], v5, s[84:87], s51 offen offset:2048
    s_barrier
    s_waitcnt vmcnt(28)
    s_barrier
    s_waitcnt vmcnt(24)
    s_barrier
    s_waitcnt vmcnt(20)
    s_barrier
    s_add_u32 m0, s54, 40960
    s_lshl_b32 s51, s66, 13
    s_add_u32 s51, s51, s70
    buffer_load_dwordx4 v14, s[36:39], s51 offen offset:0 sc1 lds
    buffer_load_dwordx4 v14, s[36:39], s51 offen offset:1024 sc1 lds
    buffer_load_dwordx4 v14, s[36:39], s51 offen offset:2048 sc1 lds
    buffer_load_dwordx4 v14, s[36:39], s51 offen offset:3072 sc1 lds
    s_add_u32 m0, s54, 49152
    s_mul_i32 s51, s66, 176128
    s_add_u32 s51, s51, s78
    buffer_load_dwordx4 v32, s[40:43], s51 offen offset:0  lds
    buffer_load_dwordx4 v33, s[40:43], s51 offen offset:1024  lds
    buffer_load_dwordx4 v34, s[40:43], s51 offen offset:2048  lds
    buffer_load_dwordx4 v35, s[40:43], s51 offen offset:3072  lds
    s_add_u32 m0, s54, 81920
    s_mul_i32 s51, s66, 176128
    s_add_u32 s51, s51, s79
    buffer_load_dwordx4 v32, s[40:43], s51 offen offset:0  lds
    buffer_load_dwordx4 v33, s[40:43], s51 offen offset:1024  lds
    buffer_load_dwordx4 v34, s[40:43], s51 offen offset:2048  lds
    buffer_load_dwordx4 v35, s[40:43], s51 offen offset:3072  lds
    s_waitcnt vmcnt(28)
    s_barrier
    s_add_u32 m0, s54, 57344
    s_lshl_b32 s51, s67, 13
    s_add_u32 s51, s51, s70
    buffer_load_dwordx4 v14, s[36:39], s51 offen offset:0 sc1 lds
    buffer_load_dwordx4 v14, s[36:39], s51 offen offset:1024 sc1 lds
    buffer_load_dwordx4 v14, s[36:39], s51 offen offset:2048 sc1 lds
    buffer_load_dwordx4 v14, s[36:39], s51 offen offset:3072 sc1 lds
    s_add_u32 m0, s54, 98304
    s_mul_i32 s51, s67, 176128
    s_add_u32 s51, s51, s78
    buffer_load_dwordx4 v32, s[40:43], s51 offen offset:0  lds
    buffer_load_dwordx4 v33, s[40:43], s51 offen offset:1024  lds
    buffer_load_dwordx4 v34, s[40:43], s51 offen offset:2048  lds
    buffer_load_dwordx4 v35, s[40:43], s51 offen offset:3072  lds
    s_waitcnt vmcnt(32)
    s_barrier
    s_add_u32 m0, s54, 0
    s_mul_i32 s51, s67, 176128
    s_add_u32 s51, s51, s79
    buffer_load_dwordx4 v32, s[40:43], s51 offen offset:0  lds
    buffer_load_dwordx4 v33, s[40:43], s51 offen offset:1024  lds
    buffer_load_dwordx4 v34, s[40:43], s51 offen offset:2048  lds
    buffer_load_dwordx4 v35, s[40:43], s51 offen offset:3072  lds
    s_waitcnt vmcnt(32)
    s_barrier
    s_waitcnt vmcnt(16)
    s_barrier
    s_add_u32 m0, s54, 16384
    s_mul_i32 s51, s60, 176128
    s_add_u32 s51, s51, s52
    buffer_load_dwordx4 v32, s[40:43], s51 offen offset:0  lds
    buffer_load_dwordx4 v33, s[40:43], s51 offen offset:1024  lds
    buffer_load_dwordx4 v34, s[40:43], s51 offen offset:2048  lds
    buffer_load_dwordx4 v35, s[40:43], s51 offen offset:3072  lds
    s_waitcnt vmcnt(8)
    s_barrier
    s_add_u32 m0, s54, 32768
    s_mul_i32 s51, s61, 176128
    s_add_u32 s51, s51, s52
    buffer_load_dwordx4 v32, s[40:43], s51 offen offset:0  lds
    buffer_load_dwordx4 v33, s[40:43], s51 offen offset:1024  lds
    buffer_load_dwordx4 v34, s[40:43], s51 offen offset:2048  lds
    buffer_load_dwordx4 v35, s[40:43], s51 offen offset:3072  lds
    s_barrier
    s_add_u32 m0, s54, 40960
    s_mul_i32 s51, s62, 176128
    s_add_u32 s51, s51, s52
    buffer_load_dwordx4 v32, s[40:43], s51 offen offset:0  lds
    buffer_load_dwordx4 v33, s[40:43], s51 offen offset:1024  lds
    buffer_load_dwordx4 v34, s[40:43], s51 offen offset:2048  lds
    buffer_load_dwordx4 v35, s[40:43], s51 offen offset:3072  lds
    s_barrier
    s_add_u32 m0, s54, 49152
    s_mul_i32 s51, s63, 176128
    s_add_u32 s51, s51, s52
    buffer_load_dwordx4 v32, s[40:43], s51 offen offset:0  lds
    buffer_load_dwordx4 v33, s[40:43], s51 offen offset:1024  lds
    buffer_load_dwordx4 v34, s[40:43], s51 offen offset:2048  lds
    buffer_load_dwordx4 v35, s[40:43], s51 offen offset:3072  lds
    s_barrier
    s_add_u32 m0, s54, 57344
    s_mul_i32 s51, s64, 176128
    s_add_u32 s51, s51, s52
    buffer_load_dwordx4 v32, s[40:43], s51 offen offset:0  lds
    buffer_load_dwordx4 v33, s[40:43], s51 offen offset:1024  lds
    buffer_load_dwordx4 v34, s[40:43], s51 offen offset:2048  lds
    buffer_load_dwordx4 v35, s[40:43], s51 offen offset:3072  lds
    s_barrier
    s_add_u32 m0, s54, 65536
L_pg1:
    s_cbranch_execz L_pr1
    s_mul_i32 s51, s65, 176128
    s_add_u32 s51, s51, s52
    buffer_load_dwordx4 v32, s[40:43], s51 offen offset:0  lds
    buffer_load_dwordx4 v33, s[40:43], s51 offen offset:1024  lds
    buffer_load_dwordx4 v34, s[40:43], s51 offen offset:2048  lds
    buffer_load_dwordx4 v35, s[40:43], s51 offen offset:3072  lds
    s_barrier
    s_add_u32 m0, s54, 8192
    s_mul_i32 s51, s66, 176128
    s_add_u32 s51, s51, s52
    buffer_load_dwordx4 v32, s[40:43], s51 offen offset:0  lds
    buffer_load_dwordx4 v33, s[40:43], s51 offen offset:1024  lds
    buffer_load_dwordx4 v34, s[40:43], s51 offen offset:2048  lds
    buffer_load_dwordx4 v35, s[40:43], s51 offen offset:3072  lds
    s_barrier
    s_add_u32 m0, s54, 24576
    s_mul_i32 s51, s67, 176128
    s_add_u32 s51, s51, s52
    buffer_load_dwordx4 v32, s[40:43], s51 offen offset:0  lds
    buffer_load_dwordx4 v33, s[40:43], s51 offen offset:1024  lds
    buffer_load_dwordx4 v34, s[40:43], s51 offen offset:2048  lds
    buffer_load_dwordx4 v35, s[40:43], s51 offen offset:3072  lds
    s_barrier
    s_mov_b32 s40, s8
    s_mov_b32 s41, s9
    s_mov_b32 s42, 524288
    s_add_u32 m0, s54, 73728
    s_mul_i32 s51, s60, 65536
    buffer_load_dwordx4 v28, s[40:43], s51 offen offset:0  lds
    buffer_load_dwordx4 v29, s[40:43], s51 offen offset:1024  lds
    buffer_load_dwordx4 v30, s[40:43], s51 offen offset:2048  lds
    buffer_load_dwordx4 v31, s[40:43], s51 offen offset:3072  lds
    s_add_u32 m0, s54, 90112
    s_mul_i32 s51, s61, 65536
    buffer_load_dwordx4 v28, s[40:43], s51 offen offset:0  lds
    buffer_load_dwordx4 v29, s[40:43], s51 offen offset:1024  lds
    buffer_load_dwordx4 v30, s[40:43], s51 offen offset:2048  lds
    buffer_load_dwordx4 v31, s[40:43], s51 offen offset:3072  lds
    s_waitcnt vmcnt(40)
    s_barrier
    s_add_u32 m0, s54, 98304
    s_lshl_b32 s51, s60, 13
    s_add_u32 s51, s51, s71
    buffer_load_dwordx4 v14, s[36:39], s51 offen offset:0 sc1 lds
    buffer_load_dwordx4 v14, s[36:39], s51 offen offset:1024 sc1 lds
    buffer_load_dwordx4 v14, s[36:39], s51 offen offset:2048 sc1 lds
    buffer_load_dwordx4 v14, s[36:39], s51 offen offset:3072 sc1 lds
    s_add_u32 m0, s54, 106496
    s_lshl_b32 s51, s61, 13
    s_add_u32 s51, s51, s71
    buffer_load_dwordx4 v14, s[36:39], s51 offen offset:0 sc1 lds
    buffer_load_dwordx4 v14, s[36:39], s51 offen offset:1024 sc1 lds
    buffer_load_dwordx4 v14, s[36:39], s51 offen offset:2048 sc1 lds
    buffer_load_dwordx4 v14, s[36:39], s51 offen offset:3072 sc1 lds
    s_waitcnt vmcnt(44)
    s_barrier
    s_add_u32 m0, s54, 81920
    s_lshl_b32 s51, s62, 13
    s_add_u32 s51, s51, s71
    buffer_load_dwordx4 v14, s[36:39], s51 offen offset:0 sc1 lds
    buffer_load_dwordx4 v14, s[36:39], s51 offen offset:1024 sc1 lds
    buffer_load_dwordx4 v14, s[36:39], s51 offen offset:2048 sc1 lds
    buffer_load_dwordx4 v14, s[36:39], s51 offen offset:3072 sc1 lds
    s_waitcnt vmcnt(44)
    s_barrier
    s_add_u32 m0, s54, 0
    s_mul_i32 s51, s62, 65536
    buffer_load_dwordx4 v28, s[40:43], s51 offen offset:0  lds
    buffer_load_dwordx4 v29, s[40:43], s51 offen offset:1024  lds
    buffer_load_dwordx4 v30, s[40:43], s51 offen offset:2048  lds
    buffer_load_dwordx4 v31, s[40:43], s51 offen offset:3072  lds
    s_add_u32 m0, s54, 114688
    s_lshl_b32 s51, s63, 13
    s_add_u32 s51, s51, s71
    buffer_load_dwordx4 v14, s[36:39], s51 offen offset:0 sc1 lds
    buffer_load_dwordx4 v14, s[36:39], s51 offen offset:1024 sc1 lds
    buffer_load_dwordx4 v14, s[36:39], s51 offen offset:2048 sc1 lds
    buffer_load_dwordx4 v14, s[36:39], s51 offen offset:3072 sc1 lds
    s_waitcnt vmcnt(48)
    s_barrier
    s_add_u32 m0, s54, 16384
    s_mul_i32 s51, s63, 65536
    buffer_load_dwordx4 v28, s[40:43], s51 offen offset:0  lds
    buffer_load_dwordx4 v29, s[40:43], s51 offen offset:1024  lds
    buffer_load_dwordx4 v30, s[40:43], s51 offen offset:2048  lds
    buffer_load_dwordx4 v31, s[40:43], s51 offen offset:3072  lds
    s_add_u32 m0, s54, 122880
    s_lshl_b32 s51, s64, 13
    s_add_u32 s51, s51, s71
    buffer_load_dwordx4 v14, s[36:39], s51 offen offset:0 sc1 lds
    buffer_load_dwordx4 v14, s[36:39], s51 offen offset:1024 sc1 lds
    buffer_load_dwordx4 v14, s[36:39], s51 offen offset:2048 sc1 lds
    buffer_load_dwordx4 v14, s[36:39], s51 offen offset:3072 sc1 lds
    s_waitcnt vmcnt(52)
    s_barrier
    s_add_u32 m0, s54, 32768
    s_mul_i32 s51, s64, 65536
    buffer_load_dwordx4 v28, s[40:43], s51 offen offset:0  lds
    buffer_load_dwordx4 v29, s[40:43], s51 offen offset:1024  lds
    buffer_load_dwordx4 v30, s[40:43], s51 offen offset:2048  lds
    buffer_load_dwordx4 v31, s[40:43], s51 offen offset:3072  lds
    s_waitcnt vmcnt(52)
    s_barrier
    s_add_u32 m0, s54, 40960
    s_lshl_b32 s51, s65, 13
    s_add_u32 s51, s51, s71
    buffer_load_dwordx4 v14, s[36:39], s51 offen offset:0 sc1 lds
    buffer_load_dwordx4 v14, s[36:39], s51 offen offset:1024 sc1 lds
    buffer_load_dwordx4 v14, s[36:39], s51 offen offset:2048 sc1 lds
    buffer_load_dwordx4 v14, s[36:39], s51 offen offset:3072 sc1 lds
    s_add_u32 m0, s54, 131072
    s_mul_i32 s51, s65, 65536
    buffer_load_dwordx4 v28, s[40:43], s51 offen offset:0  lds
    buffer_load_dwordx4 v29, s[40:43], s51 offen offset:1024  lds
    buffer_load_dwordx4 v30, s[40:43], s51 offen offset:2048  lds
    buffer_load_dwordx4 v31, s[40:43], s51 offen offset:3072  lds
    s_waitcnt vmcnt(56)
    s_barrier
    s_add_u32 m0, s54, 49152
    s_lshl_b32 s51, s66, 13
    s_add_u32 s51, s51, s71
    buffer_load_dwordx4 v14, s[36:39], s51 offen offset:0 sc1 lds
    buffer_load_dwordx4 v14, s[36:39], s51 offen offset:1024 sc1 lds
    buffer_load_dwordx4 v14, s[36:39], s51 offen offset:2048 sc1 lds
    buffer_load_dwordx4 v14, s[36:39], s51 offen offset:3072 sc1 lds
    s_add_u32 m0, s54, 139264
    s_mul_i32 s51, s66, 65536
    buffer_load_dwordx4 v28, s[40:43], s51 offen offset:0  lds
    buffer_load_dwordx4 v29, s[40:43], s51 offen offset:1024  lds
    buffer_load_dwordx4 v30, s[40:43], s51 offen offset:2048  lds
    buffer_load_dwordx4 v31, s[40:43], s51 offen offset:3072  lds
    s_waitcnt vmcnt(60)
    s_barrier
    s_add_u32 m0, s54, 57344
    s_lshl_b32 s51, s67, 13
    s_add_u32 s51, s51, s71
    buffer_load_dwordx4 v14, s[36:39], s51 offen offset:0 sc1 lds
    buffer_load_dwordx4 v14, s[36:39], s51 offen offset:1024 sc1 lds
    buffer_load_dwordx4 v14, s[36:39], s51 offen offset:2048 sc1 lds
    buffer_load_dwordx4 v14, s[36:39], s51 offen offset:3072 sc1 lds
    s_waitcnt vmcnt(60)
    s_barrier
    s_add_u32 m0, s54, 65536
    s_mul_i32 s51, s67, 65536
    buffer_load_dwordx4 v28, s[40:43], s51 offen offset:0  lds
    buffer_load_dwordx4 v29, s[40:43], s51 offen offset:1024  lds
    buffer_load_dwordx4 v30, s[40:43], s51 offen offset:2048  lds
    buffer_load_dwordx4 v31, s[40:43], s51 offen offset:3072  lds
    s_mov_b32 s40, s18
    s_mov_b32 s41, s19
    s_mov_b32 s42, 1409024
    s_add_u32 m0, s54, 147456
    s_mul_i32 s51, s60, 131072
    buffer_load_dwordx4 v28, s[40:43], s51 offen offset:0  lds
    buffer_load_dwordx4 v29, s[40:43], s51 offen offset:1024  lds
    buffer_load_dwordx4 v30, s[40:43], s51 offen offset:2048  lds
    buffer_load_dwordx4 v31, s[40:43], s51 offen offset:3072  lds
    s_waitcnt vmcnt(56)
    s_barrier
    s_add_u32 m0, s54, 8192
    s_mul_i32 s51, s61, 131072
    buffer_load_dwordx4 v28, s[40:43], s51 offen offset:0  lds
    buffer_load_dwordx4 v29, s[40:43], s51 offen offset:1024  lds
    buffer_load_dwordx4 v30, s[40:43], s51 offen offset:2048  lds
    buffer_load_dwordx4 v31, s[40:43], s51 offen offset:3072  lds
    s_waitcnt vmcnt(56)
    s_barrier
    s_add_u32 m0, s54, 24576
    s_mul_i32 s51, s62, 131072
    buffer_load_dwordx4 v28, s[40:43], s51 offen offset:0  lds
    buffer_load_dwordx4 v29, s[40:43], s51 offen offset:1024  lds
    buffer_load_dwordx4 v30, s[40:43], s51 offen offset:2048  lds
    buffer_load_dwordx4 v31, s[40:43], s51 offen offset:3072  lds
    s_waitcnt vmcnt(52)
    s_barrier
    s_add_u32 m0, s54, 73728
    s_mul_i32 s51, s63, 131072
    buffer_load_dwordx4 v28, s[40:43], s51 offen offset:0  lds
    buffer_load_dwordx4 v29, s[40:43], s51 offen offset:1024  lds
    buffer_load_dwordx4 v30, s[40:43], s51 offen offset:2048  lds
    buffer_load_dwordx4 v31, s[40:43], s51 offen offset:3072  lds
    s_add_u32 m0, s54, 98304
    s_mul_i32 s51, s64, 131072
    buffer_load_dwordx4 v28, s[40:43], s51 offen offset:0  lds
    buffer_load_dwordx4 v29, s[40:43], s51 offen offset:1024  lds
    buffer_load_dwordx4 v30, s[40:43], s51 offen offset:2048  lds
    buffer_load_dwordx4 v31, s[40:43], s51 offen offset:3072  lds
    s_waitcnt vmcnt(52)
    s_barrier
    s_add_u32 m0, s54, 90112
    s_lshl_b32 s51, s60, 14
    s_add_u32 s51, s51, s72
    buffer_load_dwordx4 v14, s[36:39], s51 offen offset:0 sc1 lds
    buffer_load_dwordx4 v14, s[36:39], s51 offen offset:1024 sc1 lds
    buffer_load_dwordx4 v14, s[36:39], s51 offen offset:2048 sc1 lds
    buffer_load_dwordx4 v14, s[36:39], s51 offen offset:3072 sc1 lds
    s_add_u32 m0, s54, 106496
    s_lshl_b32 s51, s61, 14
    s_add_u32 s51, s51, s72
    buffer_load_dwordx4 v14, s[36:39], s51 offen offset:0 sc1 lds
    buffer_load_dwordx4 v14, s[36:39], s51 offen offset:1024 sc1 lds
    buffer_load_dwordx4 v14, s[36:39], s51 offen offset:2048 sc1 lds
    buffer_load_dwordx4 v14, s[36:39], s51 offen offset:3072 sc1 lds
    s_waitcnt vmcnt(52)
    s_barrier
    s_add_u32 m0, s54, 0
    s_lshl_b32 s51, s62, 14
    s_add_u32 s51, s51, s72
    buffer_load_dwordx4 v14, s[36:39], s51 offen offset:0 sc1 lds
    buffer_load_dwordx4 v14, s[36:39], s51 offen offset:1024 sc1 lds
    buffer_load_dwordx4 v14, s[36:39], s51 offen offset:2048 sc1 lds
    buffer_load_dwordx4 v14, s[36:39], s51 offen offset:3072 sc1 lds
    s_add_u32 m0, s54, 81920
    s_lshl_b32 s51, s63, 14
    s_add_u32 s51, s51, s72
    buffer_load_dwordx4 v14, s[36:39], s51 offen offset:0 sc1 lds
    buffer_load_dwordx4 v14, s[36:39], s51 offen offset:1024 sc1 lds
    buffer_load_dwordx4 v14, s[36:39], s51 offen offset:2048 sc1 lds
    buffer_load_dwordx4 v14, s[36:39], s51 offen offset:3072 sc1 lds
    s_waitcnt vmcnt(52)
    s_barrier
    s_add_u32 m0, s54, 16384
    s_lshl_b32 s51, s64, 14
    s_add_u32 s51, s51, s72
    buffer_load_dwordx4 v14, s[36:39], s51 offen offset:0 sc1 lds
    buffer_load_dwordx4 v14, s[36:39], s51 offen offset:1024 sc1 lds
    buffer_load_dwordx4 v14, s[36:39], s51 offen offset:2048 sc1 lds
    buffer_load_dwordx4 v14, s[36:39], s51 offen offset:3072 sc1 lds
    s_add_u32 m0, s54, 114688
    s_lshl_b32 s51, s65, 14
    s_add_u32 s51, s51, s72
    buffer_load_dwordx4 v14, s[36:39], s51 offen offset:0 sc1 lds
    buffer_load_dwordx4 v14, s[36:39], s51 offen offset:1024 sc1 lds
    buffer_load_dwordx4 v14, s[36:39], s51 offen offset:2048 sc1 lds
    buffer_load_dwordx4 v14, s[36:39], s51 offen offset:3072 sc1 lds
    s_waitcnt vmcnt(52)
    s_barrier
    s_add_u32 m0, s54, 32768
    s_mul_i32 s51, s65, 131072
    buffer_load_dwordx4 v28, s[40:43], s51 offen offset:0  lds
    buffer_load_dwordx4 v29, s[40:43], s51 offen offset:1024  lds
    buffer_load_dwordx4 v30, s[40:43], s51 offen offset:2048  lds
    buffer_load_dwordx4 v31, s[40:43], s51 offen offset:3072  lds
    s_add_u32 m0, s54, 122880
    s_lshl_b32 s51, s66, 14
    s_add_u32 s51, s51, s72
    buffer_load_dwordx4 v14, s[36:39], s51 offen offset:0 sc1 lds
    buffer_load_dwordx4 v14, s[36:39], s51 offen offset:1024 sc1 lds
    buffer_load_dwordx4 v14, s[36:39], s51 offen offset:2048 sc1 lds
    buffer_load_dwordx4 v14, s[36:39], s51 offen offset:3072 sc1 lds
    s_waitcnt vmcnt(52)
    s_barrier
    s_add_u32 m0, s54, 40960
    s_mul_i32 s51, s66, 131072
    buffer_load_dwordx4 v28, s[40:43], s51 offen offset:0  lds
    buffer_load_dwordx4 v29, s[40:43], s51 offen offset:1024  lds
    buffer_load_dwordx4 v30, s[40:43], s51 offen offset:2048  lds
    buffer_load_dwordx4 v31, s[40:43], s51 offen offset:3072  lds
    s_waitcnt vmcnt(32)
    s_barrier
    s_add_u32 m0, s54, 49152
    s_lshl_b32 s51, s67, 14
    s_add_u32 s51, s51, s72
    buffer_load_dwordx4 v14, s[36:39], s51 offen offset:0 sc1 lds
    buffer_load_dwordx4 v14, s[36:39], s51 offen offset:1024 sc1 lds
    buffer_load_dwordx4 v14, s[36:39], s51 offen offset:2048 sc1 lds
    buffer_load_dwordx4 v14, s[36:39], s51 offen offset:3072 sc1 lds
    s_waitcnt vmcnt(32)
    s_barrier
    s_add_u32 m0, s54, 57344
    s_mul_i32 s51, s67, 131072
    buffer_load_dwordx4 v28, s[40:43], s51 offen offset:0  lds
    buffer_load_dwordx4 v29, s[40:43], s51 offen offset:1024  lds
    buffer_load_dwordx4 v30, s[40:43], s51 offen offset:2048  lds
    buffer_load_dwordx4 v31, s[40:43], s51 offen offset:3072  lds
    s_waitcnt vmcnt(32)
    s_barrier
    s_add_u32 m0, s54, 65536
    s_mul_i32 s51, s60, 131072
    s_add_u32 s51, s51, 65536
    buffer_load_dwordx4 v28, s[40:43], s51 offen offset:0  lds
    buffer_load_dwordx4 v29, s[40:43], s51 offen offset:1024  lds
    buffer_load_dwordx4 v30, s[40:43], s51 offen offset:2048  lds
    buffer_load_dwordx4 v31, s[40:43], s51 offen offset:3072  lds
    s_waitcnt vmcnt(32)
    s_barrier
    s_add_u32 m0, s54, 8192
    s_lshl_b32 s51, s60, 14
    s_add_u32 s51, s51, s72
    s_add_u32 s51, s51, 8192
    buffer_load_dwordx4 v14, s[36:39], s51 offen offset:0 sc1 lds
    buffer_load_dwordx4 v14, s[36:39], s51 offen offset:1024 sc1 lds
    buffer_load_dwordx4 v14, s[36:39], s51 offen offset:2048 sc1 lds
    buffer_load_dwordx4 v14, s[36:39], s51 offen offset:3072 sc1 lds
    s_waitcnt vmcnt(32)
    s_barrier
    s_add_u32 m0, s54, 0
    s_lshl_b32 s51, s61, 14
    s_add_u32 s51, s51, s72
    s_add_u32 s51, s51, 8192
    buffer_load_dwordx4 v14, s[36:39], s51 offen offset:0 sc1 lds
    buffer_load_dwordx4 v14, s[36:39], s51 offen offset:1024 sc1 lds
    buffer_load_dwordx4 v14, s[36:39], s51 offen offset:2048 sc1 lds
    buffer_load_dwordx4 v14, s[36:39], s51 offen offset:3072 sc1 lds
    s_add_u32 m0, s54, 24576
    s_mul_i32 s51, s61, 131072
    s_add_u32 s51, s51, 65536
    buffer_load_dwordx4 v28, s[40:43], s51 offen offset:0  lds
    buffer_load_dwordx4 v29, s[40:43], s51 offen offset:1024  lds
    buffer_load_dwordx4 v30, s[40:43], s51 offen offset:2048  lds
    buffer_load_dwordx4 v31, s[40:43], s51 offen offset:3072  lds
    s_waitcnt vmcnt(32)
    s_barrier
    s_add_u32 m0, s54, 73728
    s_lshl_b32 s51, s62, 14
    s_add_u32 s51, s51, s72
    s_add_u32 s51, s51, 8192
    buffer_load_dwordx4 v14, s[36:39], s51 offen offset:0 sc1 lds
    buffer_load_dwordx4 v14, s[36:39], s51 offen offset:1024 sc1 lds
    buffer_load_dwordx4 v14, s[36:39], s51 offen offset:2048 sc1 lds
    buffer_load_dwordx4 v14, s[36:39], s51 offen offset:3072 sc1 lds
    s_add_u32 m0, s54, 81920
    s_mul_i32 s51, s62, 131072
    s_add_u32 s51, s51, 65536
    buffer_load_dwordx4 v28, s[40:43], s51 offen offset:0  lds
    buffer_load_dwordx4 v29, s[40:43], s51 offen offset:1024  lds
    buffer_load_dwordx4 v30, s[40:43], s51 offen offset:2048  lds
    buffer_load_dwordx4 v31, s[40:43], s51 offen offset:3072  lds
    s_waitcnt vmcnt(32)
    s_barrier
    s_add_u32 m0, s54, 16384
    s_lshl_b32 s51, s63, 14
    s_add_u32 s51, s51, s72
    s_add_u32 s51, s51, 8192
    buffer_load_dwordx4 v14, s[36:39], s51 offen offset:0 sc1 lds
    buffer_load_dwordx4 v14, s[36:39], s51 offen offset:1024 sc1 lds
    buffer_load_dwordx4 v14, s[36:39], s51 offen offset:2048 sc1 lds
    buffer_load_dwordx4 v14, s[36:39], s51 offen offset:3072 sc1 lds
    s_add_u32 m0, s54, 90112
    s_mul_i32 s51, s63, 131072
    s_add_u32 s51, s51, 65536
    buffer_load_dwordx4 v28, s[40:43], s51 offen offset:0  lds
    buffer_load_dwordx4 v29, s[40:43], s51 offen offset:1024  lds
    buffer_load_dwordx4 v30, s[40:43], s51 offen offset:2048  lds
    buffer_load_dwordx4 v31, s[40:43], s51 offen offset:3072  lds
    s_waitcnt vmcnt(32)
    s_barrier
    s_add_u32 m0, s54, 32768
    s_lshl_b32 s51, s64, 14
    s_add_u32 s51, s51, s72
    s_add_u32 s51, s51, 8192
    buffer_load_dwordx4 v14, s[36:39], s51 offen offset:0 sc1 lds
    buffer_load_dwordx4 v14, s[36:39], s51 offen offset:1024 sc1 lds
    buffer_load_dwordx4 v14, s[36:39], s51 offen offset:2048 sc1 lds
    buffer_load_dwordx4 v14, s[36:39], s51 offen offset:3072 sc1 lds
    s_add_u32 m0, s54, 98304
    s_mul_i32 s51, s64, 131072
    s_add_u32 s51, s51, 65536
    buffer_load_dwordx4 v28, s[40:43], s51 offen offset:0  lds
    buffer_load_dwordx4 v29, s[40:43], s51 offen offset:1024  lds
    buffer_load_dwordx4 v30, s[40:43], s51 offen offset:2048  lds
    buffer_load_dwordx4 v31, s[40:43], s51 offen offset:3072  lds
    s_waitcnt vmcnt(32)
    s_barrier
    s_add_u32 m0, s54, 40960
    s_lshl_b32 s51, s65, 14
    s_add_u32 s51, s51, s72
    s_add_u32 s51, s51, 8192
    buffer_load_dwordx4 v14, s[36:39], s51 offen offset:0 sc1 lds
    buffer_load_dwordx4 v14, s[36:39], s51 offen offset:1024 sc1 lds
    buffer_load_dwordx4 v14, s[36:39], s51 offen offset:2048 sc1 lds
    buffer_load_dwordx4 v14, s[36:39], s51 offen offset:3072 sc1 lds
    s_add_u32 m0, s54, 106496
    s_mul_i32 s51, s65, 131072
    s_add_u32 s51, s51, 65536
    buffer_load_dwordx4 v28, s[40:43], s51 offen offset:0  lds
    buffer_load_dwordx4 v29, s[40:43], s51 offen offset:1024  lds
    buffer_load_dwordx4 v30, s[40:43], s51 offen offset:2048  lds
    buffer_load_dwordx4 v31, s[40:43], s51 offen offset:3072  lds
    s_waitcnt vmcnt(32)
    s_barrier
    s_add_u32 m0, s54, 49152
    s_lshl_b32 s51, s66, 14
    s_add_u32 s51, s51, s72
    s_add_u32 s51, s51, 8192
    buffer_load_dwordx4 v14, s[36:39], s51 offen offset:0 sc1 lds
    buffer_load_dwordx4 v14, s[36:39], s51 offen offset:1024 sc1 lds
    buffer_load_dwordx4 v14, s[36:39], s51 offen offset:2048 sc1 lds
    buffer_load_dwordx4 v14, s[36:39], s51 offen offset:3072 sc1 lds
    s_add_u32 m0, s54, 57344
    s_mul_i32 s51, s66, 131072
    s_add_u32 s51, s51, 65536
    buffer_load_dwordx4 v28, s[40:43], s51 offen offset:0  lds
    buffer_load_dwordx4 v29, s[40:43], s51 offen offset:1024  lds
    buffer_load_dwordx4 v30, s[40:43], s51 offen offset:2048  lds
    buffer_load_dwordx4 v31, s[40:43], s51 offen offset:3072  lds
    s_waitcnt vmcnt(32)
    s_barrier
    s_add_u32 m0, s54, 8192
    s_lshl_b32 s51, s67, 14
    s_add_u32 s51, s51, s72
    s_add_u32 s51, s51, 8192
    buffer_load_dwordx4 v14, s[36:39], s51 offen offset:0 sc1 lds
    buffer_load_dwordx4 v14, s[36:39], s51 offen offset:1024 sc1 lds
    buffer_load_dwordx4 v14, s[36:39], s51 offen offset:2048 sc1 lds
    buffer_load_dwordx4 v14, s[36:39], s51 offen offset:3072 sc1 lds
    s_add_u32 m0, s54, 65536
    s_mul_i32 s51, s67, 131072
    s_add_u32 s51, s51, 65536
    buffer_load_dwordx4 v28, s[40:43], s51 offen offset:0  lds
    buffer_load_dwordx4 v29, s[40:43], s51 offen offset:1024  lds
    buffer_load_dwordx4 v30, s[40:43], s51 offen offset:2048  lds
    buffer_load_dwordx4 v31, s[40:43], s51 offen offset:3072  lds
    s_waitcnt vmcnt(32)
    s_barrier
    s_add_u32 m0, s54, 0
    s_add_u32 s51, s72, 131072
    buffer_load_dwordx4 v14, s[36:39], s51 offen offset:0 sc1 lds
    buffer_load_dwordx4 v14, s[36:39], s51 offen offset:1024 sc1 lds
    buffer_load_dwordx4 v14, s[36:39], s51 offen offset:2048 sc1 lds
    buffer_load_dwordx4 v14, s[36:39], s51 offen offset:3072 sc1 lds
    s_add_u32 m0, s54, 24576
    s_mov_b32 s51, 1048576
    buffer_load_dwordx4 v28, s[40:43], s51 offen offset:0  lds
    buffer_load_dwordx4 v29, s[40:43], s51 offen offset:1024  lds
    buffer_load_dwordx4 v30, s[40:43], s51 offen offset:2048  lds
    buffer_load_dwordx4 v31, s[40:43], s51 offen offset:3072  lds
    s_waitcnt vmcnt(32)
    s_barrier
    s_add_u32 m0, s54, 73728
    s_add_u32 s51, s72, 139264
    buffer_load_dwordx4 v14, s[36:39], s51 offen offset:0 sc1 lds
    buffer_load_dwordx4 v14, s[36:39], s51 offen offset:1024 sc1 lds
    buffer_load_dwordx4 v14, s[36:39], s51 offen offset:2048 sc1 lds
    buffer_load_dwordx4 v14, s[36:39], s51 offen offset:3072 sc1 lds
    s_add_u32 m0, s54, 81920
    s_mov_b32 s51, 1114112
    buffer_load_dwordx4 v28, s[40:43], s51 offen offset:0  lds
    buffer_load_dwordx4 v29, s[40:43], s51 offen offset:1024  lds
    buffer_load_dwordx4 v30, s[40:43], s51 offen offset:2048  lds
    buffer_load_dwordx4 v31, s[40:43], s51 offen offset:3072  lds
    s_waitcnt vmcnt(32)
    s_barrier
    s_add_u32 m0, s54, 16384
    s_add_u32 s51, s72, 147456
    buffer_load_dwordx4 v14, s[36:39], s51 offen offset:0 sc1 lds
    buffer_load_dwordx4 v14, s[36:39], s51 offen offset:1024 sc1 lds
    buffer_load_dwordx4 v14, s[36:39], s51 offen offset:2048 sc1 lds
    buffer_load_dwordx4 v14, s[36:39], s51 offen offset:3072 sc1 lds
    s_add_u32 m0, s54, 90112
    s_mov_b32 s51, 1179648
    buffer_load_dwordx4 v28, s[40:43], s51 offen offset:0  lds
    buffer_load_dwordx4 v29, s[40:43], s51 offen offset:1024  lds
    buffer_load_dwordx4 v30, s[40:43], s51 offen offset:2048  lds
    buffer_load_dwordx4 v31, s[40:43], s51 offen offset:3072  lds
    s_waitcnt vmcnt(32)
    s_barrier
    s_add_u32 m0, s54, 32768
    s_add_u32 s51, s72, 155648
    buffer_load_dwordx4 v14, s[36:39], s51 offen offset:0 sc1 lds
    buffer_load_dwordx4 v14, s[36:39], s51 offen offset:1024 sc1 lds
    buffer_load_dwordx4 v14, s[36:39], s51 offen offset:2048 sc1 lds
    buffer_load_dwordx4 v14, s[36:39], s51 offen offset:3072 sc1 lds
    s_add_u32 m0, s54, 98304
    s_mov_b32 s51, 1245184
    buffer_load_dwordx4 v28, s[40:43], s51 offen offset:0  lds
    buffer_load_dwordx4 v29, s[40:43], s51 offen offset:1024  lds
    buffer_load_dwordx4 v30, s[40:43], s51 offen offset:2048  lds
    buffer_load_dwordx4 v31, s[40:43], s51 offen offset:3072  lds
    s_waitcnt vmcnt(32)
    s_barrier
    s_add_u32 m0, s54, 40960
    s_add_u32 s51, s72, 163840
    buffer_load_dwordx4 v14, s[36:39], s51 offen offset:0 sc1 lds
    buffer_load_dwordx4 v14, s[36:39], s51 offen offset:1024 sc1 lds
    buffer_load_dwordx4 v14, s[36:39], s51 offen offset:2048 sc1 lds
    buffer_load_dwordx4 v14, s[36:39], s51 offen offset:3072 sc1 lds
    s_add_u32 m0, s54, 106496
    s_mov_b32 s51, 1310720
    buffer_load_dwordx4 v28, s[40:43], s51 offen offset:0  lds
    buffer_load_dwordx4 v29, s[40:43], s51 offen offset:1024  lds
    buffer_load_dwordx4 v30, s[40:43], s51 offen offset:2048  lds
    buffer_load_dwordx4 v31, s[40:43], s51 offen offset:3072  lds
    s_waitcnt vmcnt(32)
    s_barrier
    s_add_u32 m0, s54, 49152
    s_add_u32 s51, s72, 172032
    s_cmp_lg_u32 s54, 0
    s_cselect_b32 s51, 21233664, s51
    buffer_load_dwordx4 v14, s[36:39], s51 offen offset:0 sc1 lds
    buffer_load_dwordx4 v14, s[36:39], s51 offen offset:1024 sc1 lds
    buffer_load_dwordx4 v14, s[36:39], s51 offen offset:2048 sc1 lds
    buffer_load_dwordx4 v14, s[36:39], s51 offen offset:3072 sc1 lds
    s_add_u32 m0, s54, 57344
    s_mov_b32 s51, 1376256
    buffer_load_dwordx4 v28, s[40:43], s51 offen offset:0  lds
    buffer_load_dwordx4 v29, s[40:43], s51 offen offset:1024  lds
    buffer_load_dwordx4 v30, s[40:43], s51 offen offset:2048  lds
    buffer_load_dwordx4 v31, s[40:43], s51 offen offset:3072  lds
    s_waitcnt vmcnt(32)
    s_barrier
    s_waitcnt vmcnt(24)
    s_barrier
    s_waitcnt vmcnt(16)
    s_barrier
    s_waitcnt vmcnt(8)
    s_barrier
    s_waitcnt vmcnt(0)
    s_barrier
L_end:
    s_endpgm
L_flag:
    s_setprio 3
    s_lshl_b32 s48, s28, 13
    s_add_u32 s48, s48, 20971520
    s_lshl_b32 s49, s29, 2
    s_add_u32 s49, s49, s48
    s_lshl_b32 s47, s29, 10
    s_add_u32 s48, s48, s47
    s_add_u32 s47, s47, 655360
    v_lshrrev_b32 v8, 1, v0
    v_lshlrev_b32 v8, 13, v8
    v_and_b32 v9, 1, v0
    v_lshl_add_u32 v8, v9, 4, v8
    v_add_u32 v8, 20971520, v8
    s_waitcnt lgkmcnt(0)
    s_mov_b32 s36, s26
    s_mov_b32 s37, s27
    s_add_u32 s56, s26, s48
    s_addc_u32 s57, s27, 0
    s_add_u32 s58, s26, s49
    s_addc_u32 s59, s27, 0
    s_add_u32 s60, s26, s47
    s_addc_u32 s61, s27, 0
    s_load_dword s88, s[4:5], 0
    s_load_dword s88, s[12:13], 0
    s_load_dword s88, s[20:21], 0
    s_waitcnt lgkmcnt(0)
    s_load_dword s92, s[26:27], 524288
    s_load_dword s88, s[6:7], 0
    s_load_dword s88, s[14:15], 0
    s_load_dword s88, s[16:17], 0
    s_load_dword s88, s[8:9], 0
    s_load_dword s88, s[18:19], 0
    s_load_dword s88, s[22:23], 0
    s_lshr_b32 s47, s2, 3
    s_and_b32 s47, s47, 15
    s_lshl_b32 s47, s47, 21
    s_load_dword s88, s[26:27], s47
    s_load_dword s88, s[56:57], 0 glc
    s_load_dword s88, s[56:57], 128 glc
    s_load_dword s88, s[56:57], 256 glc
    s_barrier
    s_barrier
    s_barrier
    s_barrier
    s_barrier
    s_barrier
    s_barrier
    s_barrier
    s_waitcnt lgkmcnt(0)
    s_add_u32 s92, s92, 0x9e3779b0
    s_and_b32 s32, s92, 0xfffffff0
    s_mov_b32 s68, s32
    s_mov_b32 s69, s32
    s_mov_b32 s70, s32
    s_mov_b32 s71, s32
    s_mov_b32 s72, s32
    s_mov_b32 s73, s32
    s_mov_b32 s74, s32
    s_mov_b32 s75, s32
    s_mov_b32 s76, s32
    s_mov_b32 s77, s32
    s_mov_b32 s78, s32
    s_mov_b32 s79, s32
    s_mov_b32 s80, s32
    s_mov_b32 s81, s32
    s_mov_b32 s82, s32
    s_mov_b32 s83, s32
    s_mov_b32 s84, s32
    s_mov_b32 s85, s32
    s_mov_b32 s86, s32
    s_mov_b32 s87, s32
    s_barrier
    s_barrier
    s_barrier
    s_barrier
    s_barrier
    s_barrier
    s_barrier
    s_add_u32 s63, s32, 1
    s_barrier
    s_atomic_swap s63, s[58:59], 0
    s_atomic_swap s63, s[58:59], 1024
    s_atomic_swap s63, s[58:59], 2048
    s_atomic_swap s63, s[58:59], 3072
    s_atomic_swap s63, s[58:59], 4096
    s_atomic_swap s63, s[58:59], 5120
    s_atomic_swap s63, s[58:59], 6144
    s_atomic_swap s63, s[58:59], 7168
    s_barrier
    s_barrier
    s_barrier
    s_barrier
    s_barrier
    s_load_dwordx8 s[68:75], s[56:57], 0 glc
    s_load_dwordx8 s[76:83], s[56:57], 128 glc
    s_barrier
    s_barrier
    s_load_dwordx8 s[68:75], s[56:57], 0 glc
    s_load_dwordx8 s[76:83], s[56:57], 128 glc
    s_barrier
    s_barrier
    s_load_dwordx8 s[68:75], s[56:57], 0 glc
    s_load_dwordx8 s[76:83], s[56:57], 128 glc
    s_barrier
    s_barrier
    s_add_u32 s55, s32, 1
P_1:
    s_sub_u32 s47, s68, s55
    s_sub_u32 s48, s69, s55
    s_max_u32 s47, s47, s48
    s_sub_u32 s48, s70, s55
    s_max_u32 s47, s47, s48
    s_sub_u32 s48, s71, s55
L_pg2:
    s_cbranch_execz L_pr2
    s_max_u32 s47, s47, s48
    s_sub_u32 s48, s72, s55
    s_max_u32 s47, s47, s48
    s_sub_u32 s48, s73, s55
    s_max_u32 s47, s47, s48
    s_sub_u32 s48, s74, s55
    s_max_u32 s47, s47, s48
    s_sub_u32 s48, s75, s55
    s_max_u32 s47, s47, s48
    s_sub_u32 s48, s76, s55
    s_max_u32 s47, s47, s48
    s_sub_u32 s48, s77, s55
    s_max_u32 s47, s47, s48
    s_sub_u32 s48, s78, s55
    s_max_u32 s47, s47, s48
    s_sub_u32 s48, s79, s55
    s_max_u32 s47, s47, s48
    s_sub_u32 s48, s80, s55
    s_max_u32 s47, s47, s48
    s_sub_u32 s48, s81, s55
    s_max_u32 s47, s47, s48
    s_sub_u32 s48, s82, s55
    s_max_u32 s47, s47, s48
    s_sub_u32 s48, s83, s55
    s_max_u32 s47, s47, s48
    s_cmp_lt_u32 s47, 7
    s_cbranch_scc1 P_2
    s_load_dwordx8 s[68:75], s[56:57], 0 glc
    s_load_dwordx8 s[76:83], s[56:57], 128 glc
    s_sub_u32 s33, s33, 1
    s_cbranch_scc1 L_end
    s_sleep 1
    s_branch P_1
P_2:
    s_barrier
    s_barrier
    s_barrier
    s_barrier
    s_barrier
    s_barrier
    s_barrier
    s_load_dwordx4 s[84:87], s[56:57], 256 glc
    s_barrier
    s_barrier
    s_load_dwordx4 s[84:87], s[56:57], 256 glc
    s_barrier
    s_barrier
    s_add_u32 s55, s32, 2
P_3:
    s_sub_u32 s47, s84, s55
    s_sub_u32 s48, s85, s55
    s_max_u32 s47, s47, s48
    s_sub_u32 s48, s86, s55
    s_max_u32 s47, s47, s48
    s_sub_u32 s48, s87, s55
    s_max_u32 s47, s47, s48
    s_cmp_lt_u32 s47, 6
    s_cbranch_scc1 P_4
    s_load_dwordx4 s[84:87], s[56:57], 256 glc
    s_sub_u32 s33, s33, 1
    s_cbranch_scc1 L_end
    s_sleep 1
    s_branch P_3
P_4:
    s_barrier
    s_barrier
    s_barrier
    s_barrier
    s_barrier
    s_waitcnt lgkmcnt(0)
    s_mov_b32 s4, s32
    s_mov_b32 s5, s32
    s_mov_b32 s6, s32
    s_mov_b32 s7, s32
    s_mov_b32 s8, s32
    s_mov_b32 s9, s32
    s_mov_b32 s10, s32
    s_mov_b32 s11, s32
    s_mov_b32 s12, s32
    s_mov_b32 s13, s32
    s_mov_b32 s14, s32
    s_mov_b32 s15, s32
    s_mov_b32 s16, s32
    s_mov_b32 s17, s32
    s_mov_b32 s18, s32
    s_mov_b32 s19, s32
    s_mov_b32 s76, s32
    s_mov_b32 s77, s32
    s_mov_b32 s78, s32
    s_mov_b32 s79, s32
    s_mov_b32 s80, s32
    s_mov_b32 s81, s32
    s_mov_b32 s82, s32
    s_mov_b32 s83, s32
    s_barrier
    s_add_u32 s63, s32, 3
    s_barrier
    s_atomic_swap s63, s[58:59], 0
    s_atomic_swap s63, s[58:59], 1024
    s_atomic_swap s63, s[58:59], 2048
    s_atomic_swap s63, s[58:59], 3072
    s_atomic_swap s63, s[58:59], 4096
    s_atomic_swap s63, s[58:59], 5120
    s_atomic_swap s63, s[58:59], 6144
    s_atomic_swap s63, s[58:59], 7168
    s_barrier
    s_load_dwordx8 s[4:11], s[60:61], 0
    s_load_dwordx8 s[12:19], s[60:61], 128
    s_load_dwordx8 s[76:83], s[60:61], 256
    s_load_dwordx8 s[68:75], s[56:57], 0 glc
    s_barrier
    s_barrier
    s_load_dwordx8 s[68:75], s[56:57], 0 glc
    s_barrier
    s_barrier
    s_add_u32 s55, s32, 1
P_5:
    s_sub_u32 s47, s4, s55
    s_sub_u32 s48, s5, s55
    s_max_u32 s47, s47, s48
    s_sub_u32 s48, s6, s55
    s_max_u32 s47, s47, s48
    s_sub_u32 s48, s7, s55
    s_max_u32 s47, s47, s48
    s_sub_u32 s48, s8, s55
    s_max_u32 s47, s47, s48
    s_sub_u32 s48, s9, s55
    s_max_u32 s47, s47, s48
    s_sub_u32 s48, s10, s55
    s_max_u32 s47, s47, s48
    s_sub_u32 s48, s11, s55
    s_max_u32 s47, s47, s48
    s_sub_u32 s48, s12, s55
    s_max_u32 s47, s47, s48
    s_sub_u32 s48, s13, s55
    s_max_u32 s47, s47, s48
    s_sub_u32 s48, s14, s55
    s_max_u32 s47, s47, s48
    s_sub_u32 s48, s15, s55
    s_max_u32 s47, s47, s48
    s_sub_u32 s48, s16, s55
    s_max_u32 s47, s47, s48
    s_sub_u32 s48, s17, s55
    s_max_u32 s47, s47, s48
    s_sub_u32 s48, s18, s55
    s_max_u32 s47, s47, s48
    s_sub_u32 s48, s19, s55
    s_max_u32 s47, s47, s48
    s_sub_u32 s48, s76, s55
    s_max_u32 s47, s47, s48
    s_sub_u32 s48, s77, s55
    s_max_u32 s47, s47, s48
    s_sub_u32 s48, s78, s55
    s_max_u32 s47, s47, s48
    s_sub_u32 s48, s79, s55
    s_max_u32 s47, s47, s48
    s_sub_u32 s48, s80, s55
    s_max_u32 s47, s47, s48
    s_sub_u32 s48, s81, s55
    s_max_u32 s47, s47, s48
    s_sub_u32 s48, s82, s55
    s_max_u32 s47, s47, s48
    s_sub_u32 s48, s83, s55
    s_max_u32 s47, s47, s48
    s_cmp_lt_u32 s47, 7
    s_cbranch_scc1 P_6
    s_load_dwordx8 s[4:11], s[60:61], 0 glc
    s_load_dwordx8 s[12:19], s[60:61], 128 glc
    s_load_dwordx8 s[76:83], s[60:61], 256 glc
    s_sub_u32 s33, s33, 1
    s_cbranch_scc1 L_end
    s_waitcnt lgkmcnt(0)
    s_branch P_5
P_6:
    s_add_u32 s55, s32, 3
P_7:
    s_sub_u32 s47, s68, s55
    s_sub_u32 s48, s69, s55
    s_max_u32 s47, s47, s48
    s_sub_u32 s48, s70, s55
    s_max_u32 s47, s47, s48
    s_sub_u32 s48, s71, s55
    s_max_u32 s47, s47, s48
    s_sub_u32 s48, s72, s55
    s_max_u32 s47, s47, s48
    s_sub_u32 s48, s73, s55
    s_max_u32 s47, s47, s48
    s_sub_u32 s48, s74, s55
    s_max_u32 s47, s47, s48
    s_sub_u32 s48, s75, s55
    s_max_u32 s47, s47, s48
    s_cmp_lt_u32 s47, 5
    s_cbranch_scc1 P_8
    s_load_dwordx8 s[68:75], s[56:57], 0 glc
    s_sub_u32 s33, s33, 1
    s_cbranch_scc1 L_end
    s_sleep 1
    s_branch P_7
P_8:
    s_barrier
    s_barrier
    s_barrier
    s_barrier
    s_barrier
    s_barrier
    s_mov_b32 s89, s2
    s_cmp_lg_u32 s2, 0
    s_cbranch_scc1 L_eb1
    buffer_load_dwordx4 v[32:35], v8, s[36:39], 0 offen sc1
L_eb1:
    s_barrier
    s_barrier
    s_barrier
    s_barrier
    s_barrier
    s_barrier
    s_barrier
    s_add_u32 s62, s32, 4
    s_barrier
    s_atomic_swap s62, s[58:59], 0
    s_atomic_swap s62, s[58:59], 1024
    s_atomic_swap s62, s[58:59], 2048
    s_atomic_swap s62, s[58:59], 3072
    s_atomic_swap s62, s[58:59], 4096
    s_atomic_swap s62, s[58:59], 5120
    s_atomic_swap s62, s[58:59], 6144
    s_atomic_swap s62, s[58:59], 7168
    s_cmp_lg_u32 s2, 0
    s_cbranch_scc1 L_eb2
    s_add_u32 s48, s32, 1
    s_waitcnt vmcnt(0)
    v_subrev_u32 v32, s48, v32
    v_subrev_u32 v33, s48, v33
    v_subrev_u32 v34, s48, v34
    v_subrev_u32 v35, s48, v35
    v_max_u32 v32, v32, v33
    v_max3_u32 v32, v32, v34, v35
    v_cmp_gt_u32 vcc, 7, v32
    s_nop 0
    s_cmp_eq_u64 vcc, -1
    s_cbranch_scc0 L_eb2
    s_atomic_swap s32, s[26:27], 524288
    s_mov_b32 s89, 1
L_eb2:
    s_barrier
    s_barrier
    s_barrier
    s_barrier
    s_barrier
    s_barrier
    s_load_dwordx8 s[68:75], s[56:57], 0 glc
    s_barrier
    s_barrier
    s_add_u32 s55, s32, 4
P_9:
    s_sub_u32 s47, s68, s55
    s_sub_u32 s48, s69, s55
    s_max_u32 s47, s47, s48
    s_sub_u32 s48, s70, s55
    s_max_u32 s47, s47, s48
    s_sub_u32 s48, s71, s55
    s_max_u32 s47, s47, s48
    s_sub_u32 s48, s72, s55
    s_max_u32 s47, s47, s48
    s_sub_u32 s48, s73, s55
    s_max_u32 s47, s47, s48
    s_sub_u32 s48, s74, s55
    s_max_u32 s47, s47, s48
    s_sub_u32 s48, s75, s55
    s_max_u32 s47, s47, s48
    s_cmp_lt_u32 s47, 4
    s_cbranch_scc1 P_10
    s_load_dwordx8 s[68:75], s[56:57], 0 glc
    s_sub_u32 s33, s33, 1
    s_cbranch_scc1 L_end
    s_sleep 1
    s_branch P_9
P_10:
    s_barrier
    s_barrier
    s_barrier
    s_barrier
    s_barrier
    s_add_u32 s63, s32, 5
    s_barrier
    s_atomic_swap s63, s[58:59], 0
    s_atomic_swap s63, s[58:59], 1024
    s_atomic_swap s63, s[58:59], 2048
    s_atomic_swap s63, s[58:59], 3072
    s_atomic_swap s63, s[58:59], 4096
    s_atomic_swap s63, s[58:59], 5120
    s_atomic_swap s63, s[58:59], 6144
    s_atomic_swap s63, s[58:59], 7168
    s_barrier
    s_barrier
    s_barrier
    s_barrier
    s_load_dwordx8 s[68:75], s[56:57], 0 glc
    s_barrier
    s_barrier
    s_add_u32 s55, s32, 5
P_11:
    s_sub_u32 s47, s68, s55
    s_sub_u32 s48, s69, s55
    s_max_u32 s47, s47, s48
    s_sub_u32 s48, s70, s55
    s_max_u32 s47, s47, s48
    s_sub_u32 s48, s71, s55
    s_max_u32 s47, s47, s48
    s_sub_u32 s48, s72, s55
    s_max_u32 s47, s47, s48
    s_sub_u32 s48, s73, s55
    s_max_u32 s47, s47, s48
    s_sub_u32 s48, s74, s55
    s_max_u32 s47, s47, s48
    s_sub_u32 s48, s75, s55
    s_max_u32 s47, s47, s48
    s_cmp_lt_u32 s47, 3
    s_cbranch_scc1 P_12
    s_load_dwordx8 s[68:75], s[56:57], 0 glc
    s_sub_u32 s33, s33, 1
    s_cbranch_scc1 L_end
    s_sleep 1
    s_branch P_11
P_12:
    s_barrier
    s_add_u32 s62, s32, 6
    s_barrier
    s_atomic_swap s62, s[58:59], 0
    s_atomic_swap s62, s[58:59], 1024
    s_atomic_swap s62, s[58:59], 2048
    s_atomic_swap s62, s[58:59], 3072
    s_atomic_swap s62, s[58:59], 4096
    s_atomic_swap s62, s[58:59], 5120
    s_atomic_swap s62, s[58:59], 6144
    s_atomic_swap s62, s[58:59], 7168
    s_barrier
    s_barrier
    s_load_dwordx8 s[68:75], s[56:57], 0 glc
    s_barrier
    s_barrier
    s_load_dwordx8 s[68:75], s[56:57], 0 glc
    s_barrier
    s_barrier
    s_add_u32 s55, s32, 6
P_13:
    s_sub_u32 s47, s68, s55
    s_sub_u32 s48, s69, s55
    s_max_u32 s47, s47, s48
    s_sub_u32 s48, s70, s55
    s_max_u32 s47, s47, s48
    s_sub_u32 s48, s71, s55
    s_max_u32 s47, s47, s48
    s_sub_u32 s48, s72, s55
    s_max_u32 s47, s47, s48
    s_sub_u32 s48, s73, s55
    s_max_u32 s47, s47, s48
    s_sub_u32 s48, s74, s55
    s_max_u32 s47, s47, s48
    s_sub_u32 s48, s75, s55
    s_max_u32 s47, s47, s48
    s_cmp_lt_u32 s47, 2
    s_cbranch_scc1 P_14
    s_load_dwordx8 s[68:75], s[56:57], 0 glc
    s_sub_u32 s33, s33, 1
    s_cbranch_scc1 L_end
    s_sleep 1
    s_branch P_13
P_14:
    s_barrier
    s_add_u32 s63, s32, 7
    s_barrier
    s_atomic_swap s63, s[58:59], 0
    s_atomic_swap s63, s[58:59], 1024
    s_atomic_swap s63, s[58:59], 2048
    s_atomic_swap s63, s[58:59], 3072
    s_atomic_swap s63, s[58:59], 4096
    s_atomic_swap s63, s[58:59], 5120
    s_atomic_swap s63, s[58:59], 6144
    s_atomic_swap s63, s[58:59], 7168
    s_load_dwordx8 s[68:75], s[56:57], 0 glc
    s_barrier
    s_barrier
    s_load_dwordx8 s[68:75], s[56:57], 0 glc
    s_barrier
    s_barrier
    s_load_dwordx8 s[68:75], s[56:57], 0 glc
    s_barrier
    s_barrier
    s_add_u32 s55, s32, 7
P_15:
    s_sub_u32 s47, s68, s55
    s_sub_u32 s48, s69, s55
    s_max_u32 s47, s47, s48
    s_sub_u32 s48, s70, s55
    s_max_u32 s47, s47, s48
    s_sub_u32 s48, s71, s55
    s_max_u32 s47, s47, s48
    s_sub_u32 s48, s72, s55
    s_max_u32 s47, s47, s48
    s_sub_u32 s48, s73, s55
    s_max_u32 s47, s47, s48
    s_sub_u32 s48, s74, s55
    s_max_u32 s47, s47, s48
    s_sub_u32 s48, s75, s55
    s_max_u32 s47, s47, s48
    s_cmp_lt_u32 s47, 1
    s_cbranch_scc1 P_16
    s_load_dwordx8 s[68:75], s[56:57], 0 glc
    s_sub_u32 s33, s33, 1
    s_cbranch_scc1 L_end
    s_sleep 1
    s_branch P_15
P_16:
    s_barrier
    s_barrier
    s_barrier
    s_barrier
    s_barrier
    s_barrier
    s_barrier
    s_barrier
    s_barrier
    s_barrier
    s_barrier
    s_waitcnt lgkmcnt(0)
    s_cmp_lg_u32 s89, 0
    s_cbranch_scc1 L_fend
    s_barrier
L_ebump:
    s_sub_u32 s33, s33, 1
    s_cbranch_scc1 L_end
    buffer_load_dwordx4 v[32:35], v8, s[36:39], 0 offen sc1
    s_add_u32 s48, s32, 1
    s_waitcnt vmcnt(0)
    v_subrev_u32 v32, s48, v32
    v_subrev_u32 v33, s48, v33
    v_subrev_u32 v34, s48, v34
    v_subrev_u32 v35, s48, v35
    v_max_u32 v32, v32, v33
    v_max3_u32 v32, v32, v34, v35
    v_cmp_gt_u32 vcc, 7, v32
    s_nop 0
    s_cmp_eq_u64 vcc, -1
    s_cbranch_scc0 L_ebump
    s_atomic_swap s32, s[26:27], 524288
L_fend:
    s_endpgm
L_aux:
    s_lshl_b32 s62, s28, 16
    s_lshl_b32 s47, s29, 13
    s_add_u32 s62, s62, s47
    s_bitcmp1_b32 s29, 1
    s_cselect_b32 s47, 448, 0
    s_add_u32 s62, s62, s47
    s_add_u32 s62, s62, 1048576
    s_waitcnt lgkmcnt(0)
    s_add_u32 s62, s62, s26
    s_addc_u32 s63, s27, 0
    v_lshrrev_b32 v1, 3, v0
    v_mul_u32_u24 v1, 2752, v1
    v_and_b32 v2, 7, v0
    v_lshl_add_u32 v1, v2, 4, v1
    v_lshlrev_b32 v2, 5, v2
    v_lshrrev_b32 v3, 5, v0
    v_lshl_add_u32 v2, v3, 4, v2
    v_bfe_u32 v3, v0, 4, 1
    v_lshl_add_u32 v2, v3, 3, v2
    s_and_b32 s47, s28, 7
    s_mul_i32 s60, s47, 176128
    s_lshr_b32 s47, s28, 3
    s_add_u32 s48, s47, s29
    s_cmp_ge_u32 s47, 2
    s_cselect_b32 s47, 16, s48
    s_add_u32 s47, s47, s29
    s_lshl_b32 s47, s47, 7
    s_add_u32 s60, s60, s47
    s_lshl_b32 s61, s29, 13
    s_lshl_b32 s47, s28, 8
    s_add_u32 s61, s61, s47
    s_add_u32 s61, s61, 589824
    s_cmp_ge_u32 s28, 24
    s_cselect_b32 s60, 0x200000, s60
    s_cselect_b32 s61, 21233664, s61
    s_mov_b32 s40, s16
    s_mov_b32 s41, s17
    s_mov_b32 s42, 1409024
    s_mov_b32 s36, s26
    s_mov_b32 s37, s27
    s_bitcmp1_b32 s29, 1
    s_cselect_b32 s47, -1, 1
    s_add_u32 s47, s47, s28
    s_and_b32 s47, s47, 31
    s_lshl_b32 s47, s47, 13
    s_lshl_b32 s48, s29, 2
    s_add_u32 s47, s47, s48
    s_add_u32 s47, s47, 20971648
    s_add_u32 s80, s26, s47
    s_addc_u32 s81, s27, 0
    s_lshl_b32 s47, s28, 13
    s_lshl_b32 s48, s29, 10
    s_add_u32 s47, s47, s48
    s_add_u32 s47, s47, 20971776
    s_add_u32 s82, s26, s47
    s_addc_u32 s83, s27, 0
    s_lshr_b32 s47, s28, 3
    s_lshl_b32 s47, s47, 7
    s_and_b32 s49, s28, 7
    s_lshl_b32 s49, s49, 2
    s_add_u32 s47, s47, s49
    s_add_u32 s47, s47, s48
    s_add_u32 s84, s47, 655360
    s_cmp_lt_u32 s28, 4
    s_cselect_b32 s85, 0, 32
    s_cmp_lt_u32 s28, 3
    s_cselect_b32 s86, 4, 32
    s_cmp_lt_u32 s28, 2
    s_cselect_b32 s87, 8, 32
    s_cmp_lt_u32 s28, 1
    s_cselect_b32 s88, 12, 32
    s_barrier
    s_load_dword s90, s[26:27], 524288
    s_load_dword s64, s[62:63], 0
    s_load_dword s65, s[62:63], 512
    s_load_dword s66, s[62:63], 1024
    s_load_dword s67, s[62:63], 1536
    s_load_dword s68, s[62:63], 2048
    s_load_dword s69, s[62:63], 2560
    s_load_dword s70, s[62:63], 3072
    s_load_dword s71, s[62:63], 3584
    s_load_dword s72, s[62:63], 4096
    s_load_dword s73, s[62:63], 4608
    s_load_dword s74, s[62:63], 5120
    s_load_dword s75, s[62:63], 5632
    s_barrier
    s_barrier
    s_barrier
    s_mov_b64 exec, 0
    s_branch L_pg0
L_pr0:
    s_mov_b64 exec, -1
    s_barrier
    s_mov_b64 exec, 0
    s_branch L_pg4
L_pr4:
    s_mov_b64 exec, -1
    s_load_dword s76, s[62:63], 6144
    s_load_dword s77, s[62:63], 6656
    s_load_dword s78, s[62:63], 7168
    s_load_dword s79, s[62:63], 7680
    s_barrier
    s_mov_b64 exec, 0
    s_branch L_pg1
L_pr1:
    s_mov_b64 exec, -1
    s_barrier
    s_mov_b64 exec, 0
    s_branch L_pg5
L_pr5:
    s_mov_b64 exec, -1
    s_barrier
    s_mov_b64 exec, 0
    s_branch L_pg2
L_pr2:
    s_mov_b64 exec, -1
    s_mov_b64 exec, 0
    s_branch L_pg6
L_pr6:
    s_mov_b64 exec, -1
    s_waitcnt lgkmcnt(0)
    s_add_u32 s90, s90, 0x9e3779b0
    s_and_b32 s90, s90, 0xfffffff0
    s_add_u32 s91, s90, 2
    s_add_u32 s90, s90, 1
    buffer_load_dwordx4 v[64:67], v1, s[40:43], s60 offen
    s_add_u32 s60, s60, 22016
    buffer_load_dwordx4 v[68:71], v1, s[40:43], s60 offen
    s_add_u32 s60, s60, 22016
    buffer_load_dwordx4 v[72:75], v1, s[40:43], s60 offen
    s_add_u32 s60, s60, 22016
    buffer_load_dwordx4 v[76:79], v1, s[40:43], s60 offen
    s_add_u32 s60, s60, 22016
    buffer_load_dwordx4 v[80:83], v1, s[40:43], s60 offen
    s_add_u32 s60, s60, 22016
    buffer_load_dwordx4 v[84:87], v1, s[40:43], s60 offen
    s_add_u32 s60, s60, 22016
    buffer_load_dwordx4 v[88:91], v1, s[40:43], s60 offen
    s_add_u32 s60, s60, 22016
    buffer_load_dwordx4 v[92:95], v1, s[40:43], s60 offen
    s_add_u32 s60, s60, 22016
    s_barrier
    s_mov_b64 exec, 0
    s_branch L_pg7
L_pr7:
    s_mov_b64 exec, -1
    s_mov_b64 exec, 0
    s_branch L_pg8
L_pr8:
    s_mov_b64 exec, -1
    s_mov_b64 exec, 0
    s_branch L_pg3
L_pr3:
    s_mov_b64 exec, -1
    s_mov_b64 exec, 0
    s_nop 0
L_pr9:
    s_mov_b64 exec, -1
    s_barrier
    s_barrier
    s_barrier
    s_barrier
    s_barrier
    s_waitcnt vmcnt(0)
    v_lshlrev_b32 v20, 16, v64
    v_and_b32 v21, 0xffff0000, v64
    v_lshlrev_b32 v22, 16, v65
    v_and_b32 v23, 0xffff0000, v65
    v_lshlrev_b32 v24, 16, v66
    v_and_b32 v25, 0xffff0000, v66
    v_lshlrev_b32 v26, 16, v67
    v_and_b32 v27, 0xffff0000, v67
    v_lshlrev_b32 v28, 16, v68
    v_and_b32 v29, 0xffff0000, v68
    v_add_f32 v20, v20, v28
    v_add_f32 v21, v21, v29
    v_lshlrev_b32 v28, 16, v69
    v_and_b32 v29, 0xffff0000, v69
    v_add_f32 v22, v22, v28
    v_add_f32 v23, v23, v29
    s_barrier
    v_lshlrev_b32 v28, 16, v70
    v_and_b32 v29, 0xffff0000, v70
    v_add_f32 v24, v24, v28
    v_add_f32 v25, v25, v29
    v_lshlrev_b32 v28, 16, v71
    v_and_b32 v29, 0xffff0000, v71
    v_add_f32 v26, v26, v28
    v_add_f32 v27, v27, v29
    v_lshlrev_b32 v28, 16, v72
    v_and_b32 v29, 0xffff0000, v72
    v_add_f32 v20, v20, v28
    v_add_f32 v21, v21, v29
    v_lshlrev_b32 v28, 16, v73
    v_and_b32 v29, 0xffff0000, v73
    v_add_f32 v22, v22, v28
    v_add_f32 v23, v23, v29
    v_lshlrev_b32 v28, 16, v74
    s_barrier
    s_atomic_swap s90, s[80:81], 0
    s_atomic_swap s90, s[80:81], 1024
    s_atomic_swap s90, s[80:81], 2048
    s_atomic_swap s90, s[80:81], 3072
    s_atomic_swap s90, s[80:81], 4096
    s_atomic_swap s90, s[80:81], 5120
    s_atomic_swap s90, s[80:81], 6144
    s_atomic_swap s90, s[80:81], 7168
    v_and_b32 v29, 0xffff0000, v74
    v_add_f32 v24, v24, v28
    v_add_f32 v25, v25, v29
    v_lshlrev_b32 v28, 16, v75
    v_and_b32 v29, 0xffff0000, v75
    v_add_f32 v26, v26, v28
    v_add_f32 v27, v27, v29
    v_lshlrev_b32 v28, 16, v76
    v_and_b32 v29, 0xffff0000, v76
    v_add_f32 v20, v20, v28
    v_add_f32 v21, v21, v29
    v_lshlrev_b32 v28, 16, v77
    v_and_b32 v29, 0xffff0000, v77
    v_add_f32 v22, v22, v28
    v_add_f32 v23, v23, v29
    v_lshlrev_b32 v28, 16, v78
    v_and_b32 v29, 0xffff0000, v78
    s_barrier
    v_add_f32 v24, v24, v28
    v_add_f32 v25, v25, v29
    v_lshlrev_b32 v28, 16, v79
    v_and_b32 v29, 0xffff0000, v79
    v_add_f32 v26, v26, v28
    v_add_f32 v27, v27, v29
    v_lshlrev_b32 v28, 16, v80
    v_and_b32 v29, 0xffff0000, v80
    v_add_f32 v20, v20, v28
    v_add_f32 v21, v21, v29
    v_lshlrev_b32 v28, 16, v81
    v_and_b32 v29, 0xffff0000, v81
    v_add_f32 v22, v22, v28
    v_add_f32 v23, v23, v29
    v_lshlrev_b32 v28, 16, v82
    v_and_b32 v29, 0xffff0000, v82
    v_add_f32 v24, v24, v28
    s_barrier
    v_add_f32 v25, v25, v29
    v_lshlrev_b32 v28, 16, v83
    v_and_b32 v29, 0xffff0000, v83
    v_add_f32 v26, v26, v28
    v_add_f32 v27, v27, v29
    v_lshlrev_b32 v28, 16, v84
    v_and_b32 v29, 0xffff0000, v84
    v_add_f32 v20, v20, v28
    v_add_f32 v21, v21, v29
    v_lshlrev_b32 v28, 16, v85
    v_and_b32 v29, 0xffff0000, v85
    v_add_f32 v22, v22, v28
    v_add_f32 v23, v23, v29
    v_lshlrev_b32 v28, 16, v86
    v_and_b32 v29, 0xffff0000, v86
    v_add_f32 v24, v24, v28
    v_add_f32 v25, v25, v29
    s_barrier
    v_lshlrev_b32 v28, 16, v87
    v_and_b32 v29, 0xffff0000, v87
    v_add_f32 v26, v26, v28
    v_add_f32 v27, v27, v29
    v_lshlrev_b32 v28, 16, v88
    v_and_b32 v29, 0xffff0000, v88
    v_add_f32 v20, v20, v28
    v_add_f32 v21, v21, v29
    v_lshlrev_b32 v28, 16, v89
    v_and_b32 v29, 0xffff0000, v89
    v_add_f32 v22, v22, v28
    v_add_f32 v23, v23, v29
    v_lshlrev_b32 v28, 16, v90
    v_and_b32 v29, 0xffff0000, v90
    v_add_f32 v24, v24, v28
    v_add_f32 v25, v25, v29
    v_lshlrev_b32 v28, 16, v91
    s_barrier
    v_and_b32 v29, 0xffff0000, v91
    v_add_f32 v26, v26, v28
    v_add_f32 v27, v27, v29
    v_lshlrev_b32 v28, 16, v92
    v_and_b32 v29, 0xffff0000, v92
    v_add_f32 v20, v20, v28
    v_add_f32 v21, v21, v29
    v_lshlrev_b32 v28, 16, v93
    v_and_b32 v29, 0xffff0000, v93
    v_add_f32 v22, v22, v28
    v_add_f32 v23, v23, v29
    v_lshlrev_b32 v28, 16, v94
    v_and_b32 v29, 0xffff0000, v94
    v_add_f32 v24, v24, v28
    v_add_f32 v25, v25, v29
    v_lshlrev_b32 v28, 16, v95
    v_and_b32 v29, 0xffff0000, v95
    s_barrier
    v_add_f32 v26, v26, v28
    v_add_f32 v27, v27, v29
    v_permlane16_swap_b32 v20, v22
    v_permlane16_swap_b32 v21, v23
    v_permlane16_swap_b32 v24, v26
    v_permlane16_swap_b32 v25, v27
    v_add_f32 v20, v20, v22
    v_add_f32 v21, v21, v23
    v_add_f32 v24, v24, v26
    v_add_f32 v25, v25, v27
    s_nop 0
    v_permlane32_swap_b32 v20, v24
    v_permlane32_swap_b32 v21, v25
    v_add_f32 v20, v20, v24
    v_add_f32 v21, v21, v25
    s_nop 0
    v_add_f32_dpp v22, v20, v20 row_ror:8 row_mask:0xf bank_mask:0xf
    v_add_f32_dpp v23, v21, v21 row_ror:8 row_mask:0xf bank_mask:0xf
    buffer_store_dwordx2 v[22:23], v2, s[36:39], s61 offen sc1
    s_barrier
    s_barrier
    s_barrier
    s_barrier
    s_barrier
    s_barrier
    s_barrier
    s_barrier
    s_waitcnt vmcnt(0)
    s_barrier
    s_atomic_swap s90, s[26:27], s84
    s_barrier
    s_barrier
    s_barrier
    s_atomic_swap s91, s[82:83], 8204
    s_atomic_swap s91, s[82:83], 16392
    s_atomic_swap s91, s[82:83], 24580
    s_atomic_swap s91, s[82:83], 32768
    s_cmp_ge_u32 s28, 4
    s_cbranch_scc1 L_kvself
    s_atomic_swap s91, s[82:83], s85
    s_atomic_swap s91, s[82:83], s86
    s_atomic_swap s91, s[82:83], s87
    s_atomic_swap s91, s[82:83], s88
L_kvself:
    s_endpgm
    .p2align 12
L_comp:
L_pg3:
    s_cbranch_execz L_pr3
    s_setprio 0
    s_and_b32 s58, s31, 1
    s_lshr_b32 s59, s31, 1
    s_mov_b32 s52, 0
    s_mov_b32 s53, -1
    s_mov_b32 s54, 0xffff
    s_mov_b32 s55, 0xffff
    v_and_b32 v48, 31, v0
    v_lshrrev_b32 v49, 5, v0
    v_lshlrev_b32 v6, 4, v0
    v_bfe_u32 v50, v0, 3, 1
    v_xor_b32 v50, s59, v50
    v_lshlrev_b32_e64 v50, 6, v50
    v_bfe_u32 v51, v0, 4, 1
    v_lshl_add_u32 v50, v51, 5, v50
    v_and_b32_e64 v51, 3, v0
    v_lshl_add_u32 v50, v51, 3, v50
    v_bfe_u32 v51, v0, 2, 2
    v_lshl_add_u32 v50, v51, 7, v50
    v_lshl_add_u32 v1, v49, 10, v50
    v_add_u32 v2, 65536, v1
    v_lshl_add_u32 v3, v49, 9, v50
    v_add_u32 v4, 65536, v3
    v_add_u32 v44, 65536, v2
    v_lshlrev_b32 v50, 4, v48
    v_lshl_add_u32 v50, v49, 10, v50
    s_lshl_b32 s47, s58, 9
    v_add_u32 v5, s47, v50
    s_lshl_b32 s47, s58, 12
    s_lshl_b32 s48, s59, 10
    s_add_u32 s47, s47, s48
    v_add_u32 v7, s47, v6
    s_add_u32 s47, s47, 2048
    v_and_b32 v51, 15, v0
    v_lshlrev_b32 v51, 4, v51
    v_lshl_add_u32 v51, v49, 8, v51
    v_add_u32 v8, s47, v51
    v_bfe_u32 v52, v0, 4, 1
    v_lshl_add_u32 v9, v52, 13, v8
    s_lshl_b32 s47, s58, 4
    s_add_u32 s47, s47, 162816
    v_mov_b32 v50, s47
    v_cndmask_b32 v8, v50, v8, s[54:55]
    s_lshl_b32 s47, s28, 1
    v_lshlrev_b32 v50, 4, v48
    v_lshl_add_u32 v50, v49, 9, v50
    v_add_u32 v50, 162816, v50
    v_add_u32 v51, s47, v48
    v_cmp_le_u32 vcc, 8, v51
    v_mov_b32 v51, 0x3f803f80
    s_nop 0
    v_cndmask_b32 v104, 0, v51, vcc
    v_mov_b32 v105, v104
    v_mov_b32 v106, v104
    v_mov_b32 v107, v104
    ds_write_b128 v50, v[104:107]
    s_lshr_b32 s47, s29, 2
    s_add_u32 s47, s47, 1
    s_sub_u32 s48, 0, s47
    s_bitcmp1_b32 s29, 1
    s_cselect_b32 s47, s48, s47
    s_lshl_b32 s48, s28, 6
    s_add_u32 s47, s47, s48
    s_lshl_b32 s48, s58, 5
    s_add_u32 s47, s47, s48
    v_add_u32_e64 v50, s47, v48
    v_mov_b32 v51, 2047
    v_cmp_gt_u32 s[44:45], v50, v51
    v_and_b32 v50, v51, v50
    v_lshrrev_b32 v51, 6, v50
    v_and_b32 v50, 63, v50
    v_lshlrev_b32 v50, 4, v50
    v_lshl_add_u32 v50, v51, 16, v50
    v_lshl_add_u32 v10, v49, 10, v50
    v_bfe_u32 v50, v0, 4, 1
    v_bfe_u32 v51, v0, 2, 1
    v_cmp_eq_u32 s[56:57], v50, v51
    v_mov_b32 v52, 0x3f803f80
    s_nop 0
    v_cndmask_b32 v20, 0, v52, s[56:57]
    v_mov_b32 v21, v20
    v_mov_b32 v22, v20
    v_mov_b32 v23, v20
    v_and_b32 v50, 3, v0
    v_cmp_eq_u32 vcc, 0, v50
    v_cmp_eq_u32 s[96:97], 1, v50
    v_cmp_eq_u32 s[98:99], 2, v50
    v_cmp_eq_u32 s[100:101], 3, v50
    s_and_b64 vcc, vcc, s[56:57]
    s_and_b64 s[56:57], s[56:57], s[96:97]
    v_mov_b32 v40, 157824
    v_mov_b32 v50, 156736
    v_cndmask_b32 v40, v40, v50, vcc
    v_lshlrev_b32 v50, 4, v49
    v_add_u32 v50, 155648, v50
    v_cndmask_b32 v40, v40, v50, s[56:57]
    v_add_u32 v50, 156736, v6
    v_mov_b32 v96, v52
    v_mov_b32 v97, v52
    v_mov_b32 v98, v52
    v_mov_b32 v99, v52
    v_mov_b32 v100, 0
    v_mov_b32 v101, 0
    v_mov_b32 v102, 0
    v_mov_b32 v103, 0
    ds_write_b128 v50, v[96:99]
    ds_write_b128 v50, v[100:103] offset:1088
    s_lshl_b32 s47, s58, 5
    v_add_u32 v53, s47, v48
    v_bfe_u32 v50, v53, 1, 3
    v_lshlrev_b32 v53, 7, v53
    v_xor_b32 v51, v50, v49
    v_xor_b32 v52, 0, v51
    v_lshl_add_u32 v36, v52, 4, v53
    v_xor_b32 v52, 2, v51
    v_lshl_add_u32 v37, v52, 4, v53
    v_xor_b32 v52, 4, v51
    v_lshl_add_u32 v38, v52, 4, v53
    v_xor_b32 v52, 6, v51
    v_lshl_add_u32 v39, v52, 4, v53
    v_lshlrev_b32 v50, 2, v49
    v_sub_u32 v50, v48, v50
    v_cmp_gt_i32 s[60:61], 0, v50
    v_cmp_gt_i32 s[62:63], 1, v50
    v_cmp_gt_i32 s[64:65], 2, v50
    v_cmp_gt_i32 s[66:67], 3, v50
    v_cmp_gt_i32 s[68:69], 8, v50
    v_cmp_gt_i32 s[70:71], 9, v50
    v_cmp_gt_i32 s[72:73], 10, v50
    v_cmp_gt_i32 s[74:75], 11, v50
    v_cmp_gt_i32 s[76:77], 16, v50
    v_cmp_gt_i32 s[78:79], 17, v50
    v_cmp_gt_i32 s[80:81], 18, v50
    v_cmp_gt_i32 s[82:83], 19, v50
    v_cmp_gt_i32 s[84:85], 24, v50
    v_cmp_gt_i32 s[86:87], 25, v50
    v_cmp_gt_i32 s[88:89], 26, v50
    v_cmp_gt_i32 s[90:91], 27, v50
    v_add_u32 v0, 65536, v4
    v_add_u32 v6, 131072, v5
    s_waitcnt lgkmcnt(0)
    s_mov_b32 s40, s22
    s_mov_b32 s41, s23
    s_mov_b32 s42, 2097152
    s_mov_b32 s36, s26
    s_mov_b32 s37, s27
    s_lshl_b32 s14, s29, 13
    s_lshl_b32 s48, s59, 12
    s_add_u32 s14, s14, s48
    s_add_u32 s4, s14, 1048576
    s_lshl_b32 s5, s28, 3
    s_add_u32 s5, s5, s29
    s_lshl_b32 s5, s5, 14
    s_add_u32 s5, s5, 3145728
    s_add_u32 s6, s5, 8192
    s_mul_i32 s47, s28, 73728
    s_add_u32 s47, s47, 7340032
    s_add_u32 s7, s47, s14
    s_lshr_b32 s8, s14, 3
    s_add_u32 s8, s8, s47
    s_add_u32 s8, s8, 65536
    s_lshl_b32 s47, s28, 16
    s_add_u32 s9, s47, s14
    s_add_u32 s9, s9, 10485760
    s_lshl_b32 s48, s58, 15
    s_add_u32 s11, s47, s48
    s_lshr_b32 s48, s14, 6
    s_add_u32 s11, s11, s48
    s_mul_i32 s10, s28, 180224
    s_add_u32 s10, s10, s14
    s_add_u32 s10, s10, 12582912
    s_add_u32 s13, s10, 131072
    s_cmp_ge_u32 s29, 6
    s_cselect_b32 s13, 21233664, s13
    s_lshl_b32 s48, s29, 13
    s_add_u32 s10, s10, s48
    s_lshl_b32 s12, s28, 1
    s_add_u32 s12, s12, s58
    s_sub_i32 s12, 8, s12
    s_max_i32 s12, s12, 0
    s_barrier
    s_nop 0
    ds_read_b128 v[112:115], v40 offset:0
    ds_read_b128 v[128:131], v36 offset:0
    ds_read_b64_tr_b16 v[24:25], v2 offset:0
    ds_read_b64_tr_b16 v[26:27], v2 offset:512
    ds_read_b128 v[116:119], v40 offset:32
    ds_read_b128 v[132:135], v37 offset:0
    ds_read_b64_tr_b16 v[28:29], v2 offset:2048
    ds_read_b64_tr_b16 v[30:31], v2 offset:2560
    ds_read_b128 v[120:123], v40 offset:64
    ds_read_b128 v[136:139], v38 offset:0
    ds_read_b64_tr_b16 v[32:33], v2 offset:4096
    ds_read_b64_tr_b16 v[34:35], v2 offset:4608
    s_waitcnt lgkmcnt(8)
    s_nop 0
    v_mfma_f32_16x16x32_bf16 v[68:71], v[112:115], v[128:131], 0
    ds_read_b128 v[112:115], v40 offset:96
    v_mfma_f32_16x16x32_bf16 v[64:67], v[20:23], v[24:27], 0
    ds_read_b128 v[140:143], v39 offset:0
    v_mfma_f32_32x32x16_bf16 v[48:63], v[24:27], v[128:131], 0
    ds_read_b64_tr_b16 v[24:25], v2 offset:6144
    ds_read_b64_tr_b16 v[26:27], v2 offset:6656
    s_waitcnt lgkmcnt(8)
    v_mfma_f32_16x16x32_bf16 v[68:71], v[116:119], v[132:135], v[68:71]
    ds_read_b128 v[116:119], v40 offset:128
    s_barrier
    v_mfma_f32_16x16x32_bf16 v[64:67], v[20:23], v[28:31], v[64:67]
    ds_read_b128 v[144:147], v36 offset:8192
    v_mfma_f32_32x32x16_bf16 v[48:63], v[28:31], v[132:135], v[48:63]
    ds_read_b64_tr_b16 v[28:29], v2 offset:8192
    ds_read_b64_tr_b16 v[30:31], v2 offset:8704
    s_waitcnt lgkmcnt(8)
    s_nop 0
    v_mfma_f32_16x16x32_bf16 v[68:71], v[120:123], v[136:139], v[68:71]
    ds_read_b128 v[120:123], v40 offset:160
    v_mfma_f32_16x16x32_bf16 v[64:67], v[20:23], v[32:35], v[64:67]
    ds_read_b128 v[148:151], v37 offset:8192
    v_mfma_f32_32x32x16_bf16 v[48:63], v[32:35], v[136:139], v[48:63]
    ds_read_b64_tr_b16 v[32:33], v2 offset:10240
    ds_read_b64_tr_b16 v[34:35], v2 offset:10752
    s_waitcnt lgkmcnt(8)
    s_nop 0
    v_mfma_f32_4x4x4_16b_bf16 v[72:75], v[128:129], v[128:129], 0
    v_mfma_f32_4x4x4_16b_bf16 v[76:79], v[130:131], v[130:131], 0
    v_mfma_f32_4x4x4_16b_bf16 v[80:83], v[132:133], v[132:133], 0
    v_mfma_f32_4x4x4_16b_bf16 v[84:87], v[134:135], v[134:135], 0
    v_mfma_f32_4x4x4_16b_bf16 v[72:75], v[136:137], v[136:137], v[72:75]
    v_mfma_f32_4x4x4_16b_bf16 v[76:79], v[138:139], v[138:139], v[76:79]
    v_mfma_f32_4x4x4_16b_bf16 v[80:83], v[140:141], v[140:141], v[80:83]
    v_mfma_f32_4x4x4_16b_bf16 v[84:87], v[142:143], v[142:143], v[84:87]
    v_mfma_f32_16x16x32_bf16 v[68:71], v[112:115], v[140:143], v[68:71]
    ds_read_b128 v[112:115], v40 offset:192
    v_mfma_f32_16x16x32_bf16 v[64:67], v[20:23], v[24:27], v[64:67]
    ds_read_b128 v[152:155], v38 offset:8192
    v_mfma_f32_32x32x16_bf16 v[48:63], v[24:27], v[140:143], v[48:63]
    ds_read_b64_tr_b16 v[24:25], v2 offset:12288
    ds_read_b64_tr_b16 v[26:27], v2 offset:12800
    s_waitcnt lgkmcnt(8)
    s_nop 0
    v_mfma_f32_16x16x32_bf16 v[68:71], v[116:119], v[144:147], v[68:71]
    ds_read_b128 v[116:119], v40 offset:224
    v_mfma_f32_16x16x32_bf16 v[64:67], v[20:23], v[28:31], v[64:67]
    ds_read_b128 v[156:159], v39 offset:8192
    v_mfma_f32_32x32x16_bf16 v[48:63], v[28:31], v[144:147], v[48:63]
    ds_read_b64_tr_b16 v[28:29], v2 offset:14336
    ds_read_b64_tr_b16 v[30:31], v2 offset:14848
    v_mov_b32 v105, 0
    s_waitcnt lgkmcnt(8)
    v_mfma_f32_16x16x32_bf16 v[68:71], v[120:123], v[148:151], v[68:71]
    ds_read_b128 v[120:123], v40 offset:256
    s_barrier
    v_mfma_f32_16x16x32_bf16 v[64:67], v[20:23], v[32:35], v[64:67]
    ds_read_b128 v[160:163], v36 offset:16384
    v_mfma_f32_32x32x16_bf16 v[48:63], v[32:35], v[148:151], v[48:63]
    ds_read_b64_tr_b16 v[32:33], v2 offset:16384
    ds_read_b64_tr_b16 v[34:35], v2 offset:16896
    v_mov_b32_e64 v106, 0
    s_waitcnt lgkmcnt(8)
    v_mfma_f32_16x16x32_bf16 v[68:71], v[112:115], v[152:155], v[68:71]
    ds_read_b128 v[112:115], v40 offset:288
    v_mfma_f32_16x16x32_bf16 v[64:67], v[20:23], v[24:27], v[64:67]
    ds_read_b128 v[164:167], v37 offset:16384
    v_mfma_f32_32x32x16_bf16 v[48:63], v[24:27], v[152:155], v[48:63]
    ds_read_b64_tr_b16 v[24:25], v2 offset:18432
    ds_read_b64_tr_b16 v[26:27], v2 offset:18944
    v_mov_b32 v107, 0
    s_waitcnt lgkmcnt(8)
    v_mfma_f32_4x4x4_16b_bf16 v[72:75], v[144:145], v[144:145], v[72:75]
    v_mfma_f32_4x4x4_16b_bf16 v[76:79], v[146:147], v[146:147], v[76:79]
    v_mfma_f32_4x4x4_16b_bf16 v[80:83], v[148:149], v[148:149], v[80:83]
    v_mfma_f32_4x4x4_16b_bf16 v[84:87], v[150:151], v[150:151], v[84:87]
    v_mfma_f32_4x4x4_16b_bf16 v[72:75], v[152:153], v[152:153], v[72:75]
    v_mfma_f32_4x4x4_16b_bf16 v[76:79], v[154:155], v[154:155], v[76:79]
    v_mfma_f32_4x4x4_16b_bf16 v[80:83], v[156:157], v[156:157], v[80:83]
    v_mfma_f32_4x4x4_16b_bf16 v[84:87], v[158:159], v[158:159], v[84:87]
    v_mfma_f32_16x16x32_bf16 v[68:71], v[116:119], v[156:159], v[68:71]
    ds_read_b128 v[116:119], v40 offset:320
    v_mfma_f32_16x16x32_bf16 v[64:67], v[20:23], v[28:31], v[64:67]
    ds_read_b128 v[168:171], v38 offset:16384
    v_mfma_f32_32x32x16_bf16 v[48:63], v[28:31], v[156:159], v[48:63]
    ds_read_b64_tr_b16 v[28:29], v2 offset:20480
    ds_read_b64_tr_b16 v[30:31], v2 offset:20992
    v_mov_b32 v109, 0
    s_waitcnt lgkmcnt(8)
    v_mfma_f32_16x16x32_bf16 v[68:71], v[120:123], v[160:163], v[68:71]
    ds_read_b128 v[120:123], v40 offset:352
    v_mfma_f32_16x16x32_bf16 v[64:67], v[20:23], v[32:35], v[64:67]
    ds_read_b128 v[172:175], v39 offset:16384
    v_mfma_f32_32x32x16_bf16 v[48:63], v[32:35], v[160:163], v[48:63]
    ds_read_b64_tr_b16 v[32:33], v2 offset:22528
    ds_read_b64_tr_b16 v[34:35], v2 offset:23040
    v_mov_b32 v110, 0
    s_waitcnt lgkmcnt(8)
    v_mfma_f32_16x16x32_bf16 v[68:71], v[112:115], v[164:167], v[68:71]
    ds_read_b128 v[112:115], v40 offset:384
    s_barrier
    v_mfma_f32_16x16x32_bf16 v[64:67], v[20:23], v[24:27], v[64:67]
    ds_read_b128 v[176:179], v36 offset:24576
    v_mfma_f32_32x32x16_bf16 v[48:63], v[24:27], v[164:167], v[48:63]
    ds_read_b64_tr_b16 v[24:25], v2 offset:24576
    ds_read_b64_tr_b16 v[26:27], v2 offset:25088
    v_mov_b32_e64 v111, 0
    s_waitcnt lgkmcnt(8)
    v_mfma_f32_16x16x32_bf16 v[68:71], v[116:119], v[168:171], v[68:71]
    ds_read_b128 v[116:119], v40 offset:416
    v_mfma_f32_16x16x32_bf16 v[64:67], v[20:23], v[28:31], v[64:67]
    ds_read_b128 v[180:183], v37 offset:24576
    v_mfma_f32_32x32x16_bf16 v[48:63], v[28:31], v[168:171], v[48:63]
    ds_read_b64_tr_b16 v[28:29], v2 offset:26624
    ds_read_b64_tr_b16 v[30:31], v2 offset:27136
    s_waitcnt lgkmcnt(8)
    s_nop 0
    v_mfma_f32_4x4x4_16b_bf16 v[72:75], v[160:161], v[160:161], v[72:75]
    v_mfma_f32_4x4x4_16b_bf16 v[76:79], v[162:163], v[162:163], v[76:79]
    v_mfma_f32_4x4x4_16b_bf16 v[80:83], v[164:165], v[164:165], v[80:83]
    v_mfma_f32_4x4x4_16b_bf16 v[84:87], v[166:167], v[166:167], v[84:87]
    v_mfma_f32_4x4x4_16b_bf16 v[72:75], v[168:169], v[168:169], v[72:75]
    v_mfma_f32_4x4x4_16b_bf16 v[76:79], v[170:171], v[170:171], v[76:79]
    v_mfma_f32_4x4x4_16b_bf16 v[80:83], v[172:173], v[172:173], v[80:83]
    v_mfma_f32_4x4x4_16b_bf16 v[84:87], v[174:175], v[174:175], v[84:87]
    v_mfma_f32_16x16x32_bf16 v[68:71], v[120:123], v[172:175], v[68:71]
    ds_read_b128 v[120:123], v40 offset:448
    v_mfma_f32_16x16x32_bf16 v[64:67], v[20:23], v[32:35], v[64:67]
    ds_read_b128 v[184:187], v38 offset:24576
    v_mfma_f32_32x32x16_bf16 v[48:63], v[32:35], v[172:175], v[48:63]
    ds_read_b64_tr_b16 v[32:33], v2 offset:28672
    ds_read_b64_tr_b16 v[34:35], v2 offset:29184
    s_waitcnt lgkmcnt(8)
    s_nop 0
    v_mfma_f32_16x16x32_bf16 v[68:71], v[112:115], v[176:179], v[68:71]
    ds_read_b128 v[112:115], v40 offset:480
    v_mfma_f32_16x16x32_bf16 v[64:67], v[20:23], v[24:27], v[64:67]
    ds_read_b128 v[188:191], v39 offset:24576
    v_mfma_f32_32x32x16_bf16 v[48:63], v[24:27], v[176:179], v[48:63]
    ds_read_b64_tr_b16 v[24:25], v2 offset:30720
    ds_read_b64_tr_b16 v[26:27], v2 offset:31232
    s_waitcnt lgkmcnt(8)
    v_mfma_f32_16x16x32_bf16 v[68:71], v[116:119], v[180:183], v[68:71]
    ds_read_b128 v[116:119], v40 offset:512
    s_barrier
    v_mfma_f32_16x16x32_bf16 v[64:67], v[20:23], v[28:31], v[64:67]
    ds_read_b128 v[192:195], v36 offset:32768
    v_mfma_f32_32x32x16_bf16 v[48:63], v[28:31], v[180:183], v[48:63]
    ds_read_b64_tr_b16 v[28:29], v2 offset:32768
    ds_read_b64_tr_b16 v[30:31], v2 offset:33280
    s_waitcnt lgkmcnt(8)
    s_nop 0
    v_mfma_f32_16x16x32_bf16 v[68:71], v[120:123], v[184:187], v[68:71]
    ds_read_b128 v[120:123], v40 offset:544
    v_mfma_f32_16x16x32_bf16 v[64:67], v[20:23], v[32:35], v[64:67]
    ds_read_b128 v[196:199], v37 offset:32768
    v_mfma_f32_32x32x16_bf16 v[48:63], v[32:35], v[184:187], v[48:63]
    ds_read_b64_tr_b16 v[32:33], v2 offset:34816
    ds_read_b64_tr_b16 v[34:35], v2 offset:35328
    s_waitcnt lgkmcnt(8)
    s_nop 0
    v_mfma_f32_4x4x4_16b_bf16 v[72:75], v[176:177], v[176:177], v[72:75]
    v_mfma_f32_4x4x4_16b_bf16 v[76:79], v[178:179], v[178:179], v[76:79]
    v_mfma_f32_4x4x4_16b_bf16 v[80:83], v[180:181], v[180:181], v[80:83]
    v_mfma_f32_4x4x4_16b_bf16 v[84:87], v[182:183], v[182:183], v[84:87]
    v_mfma_f32_4x4x4_16b_bf16 v[72:75], v[184:185], v[184:185], v[72:75]
    v_mfma_f32_4x4x4_16b_bf16 v[76:79], v[186:187], v[186:187], v[76:79]
    v_mfma_f32_4x4x4_16b_bf16 v[80:83], v[188:189], v[188:189], v[80:83]
    v_mfma_f32_4x4x4_16b_bf16 v[84:87], v[190:191], v[190:191], v[84:87]
    v_mfma_f32_16x16x32_bf16 v[68:71], v[112:115], v[188:191], v[68:71]
    ds_read_b128 v[112:115], v40 offset:576
    v_mfma_f32_16x16x32_bf16 v[64:67], v[20:23], v[24:27], v[64:67]
    ds_read_b128 v[200:203], v38 offset:32768
    v_mfma_f32_32x32x16_bf16 v[48:63], v[24:27], v[188:191], v[48:63]
    ds_read_b64_tr_b16 v[24:25], v2 offset:36864
    ds_read_b64_tr_b16 v[26:27], v2 offset:37376
    s_waitcnt lgkmcnt(8)
    s_nop 0
    v_mfma_f32_16x16x32_bf16 v[68:71], v[116:119], v[192:195], v[68:71]
    ds_read_b128 v[116:119], v40 offset:608
    v_mfma_f32_16x16x32_bf16 v[64:67], v[20:23], v[28:31], v[64:67]
    ds_read_b128 v[204:207], v39 offset:32768
    v_mfma_f32_32x32x16_bf16 v[48:63], v[28:31], v[192:195], v[48:63]
    ds_read_b64_tr_b16 v[28:29], v2 offset:38912
    ds_read_b64_tr_b16 v[30:31], v2 offset:39424
    s_waitcnt lgkmcnt(8)
    v_mfma_f32_16x16x32_bf16 v[68:71], v[120:123], v[196:199], v[68:71]
    ds_read_b128 v[120:123], v40 offset:640
    s_barrier
    v_mfma_f32_16x16x32_bf16 v[64:67], v[20:23], v[32:35], v[64:67]
    ds_read_b128 v[208:211], v36 offset:40960
    v_mfma_f32_32x32x16_bf16 v[48:63], v[32:35], v[196:199], v[48:63]
    ds_read_b64_tr_b16 v[32:33], v2 offset:40960
    ds_read_b64_tr_b16 v[34:35], v2 offset:41472
    s_waitcnt lgkmcnt(8)
    s_nop 0
    v_mfma_f32_16x16x32_bf16 v[68:71], v[112:115], v[200:203], v[68:71]
    ds_read_b128 v[112:115], v40 offset:672
    v_mfma_f32_16x16x32_bf16 v[64:67], v[20:23], v[24:27], v[64:67]
    ds_read_b128 v[212:215], v37 offset:40960
    v_mfma_f32_32x32x16_bf16 v[48:63], v[24:27], v[200:203], v[48:63]
    ds_read_b64_tr_b16 v[24:25], v2 offset:43008
    ds_read_b64_tr_b16 v[26:27], v2 offset:43520
    s_waitcnt lgkmcnt(8)
    s_nop 0
    v_mfma_f32_4x4x4_16b_bf16 v[72:75], v[192:193], v[192:193], v[72:75]
    v_mfma_f32_4x4x4_16b_bf16 v[76:79], v[194:195], v[194:195], v[76:79]
    v_mfma_f32_4x4x4_16b_bf16 v[80:83], v[196:197], v[196:197], v[80:83]
    v_mfma_f32_4x4x4_16b_bf16 v[84:87], v[198:199], v[198:199], v[84:87]
    v_mfma_f32_4x4x4_16b_bf16 v[72:75], v[200:201], v[200:201], v[72:75]
    v_mfma_f32_4x4x4_16b_bf16 v[76:79], v[202:203], v[202:203], v[76:79]
    v_mfma_f32_4x4x4_16b_bf16 v[80:83], v[204:205], v[204:205], v[80:83]
    v_mfma_f32_4x4x4_16b_bf16 v[84:87], v[206:207], v[206:207], v[84:87]
    v_mfma_f32_16x16x32_bf16 v[68:71], v[116:119], v[204:207], v[68:71]
    ds_read_b128 v[116:119], v40 offset:704
    v_mfma_f32_16x16x32_bf16 v[64:67], v[20:23], v[28:31], v[64:67]
    ds_read_b128 v[216:219], v38 offset:40960
    v_mfma_f32_32x32x16_bf16 v[48:63], v[28:31], v[204:207], v[48:63]
    ds_read_b64_tr_b16 v[28:29], v2 offset:45056
    ds_read_b64_tr_b16 v[30:31], v2 offset:45568
    s_waitcnt lgkmcnt(8)
    s_nop 0
    v_mfma_f32_16x16x32_bf16 v[68:71], v[120:123], v[208:211], v[68:71]
    ds_read_b128 v[120:123], v40 offset:736
    v_mfma_f32_16x16x32_bf16 v[64:67], v[20:23], v[32:35], v[64:67]
    ds_read_b128 v[220:223], v39 offset:40960
    v_mfma_f32_32x32x16_bf16 v[48:63], v[32:35], v[208:211], v[48:63]
    ds_read_b64_tr_b16 v[32:33], v2 offset:47104
    ds_read_b64_tr_b16 v[34:35], v2 offset:47616
    s_waitcnt lgkmcnt(8)
    v_mfma_f32_16x16x32_bf16 v[68:71], v[112:115], v[212:215], v[68:71]
    ds_read_b128 v[112:115], v40 offset:768
    s_barrier
    v_mfma_f32_16x16x32_bf16 v[64:67], v[20:23], v[24:27], v[64:67]
    ds_read_b128 v[224:227], v36 offset:49152
    v_mfma_f32_32x32x16_bf16 v[48:63], v[24:27], v[212:215], v[48:63]
    ds_read_b64_tr_b16 v[24:25], v1 offset:0
    ds_read_b64_tr_b16 v[26:27], v1 offset:512
    s_waitcnt lgkmcnt(8)
    s_nop 0
    v_mfma_f32_16x16x32_bf16 v[68:71], v[116:119], v[216:219], v[68:71]
    ds_read_b128 v[116:119], v40 offset:800
    v_mfma_f32_16x16x32_bf16 v[64:67], v[20:23], v[28:31], v[64:67]
    ds_read_b128 v[228:231], v37 offset:49152
    v_mfma_f32_32x32x16_bf16 v[48:63], v[28:31], v[216:219], v[48:63]
    ds_read_b64_tr_b16 v[28:29], v1 offset:2048
    ds_read_b64_tr_b16 v[30:31], v1 offset:2560
    s_waitcnt lgkmcnt(8)
    s_nop 0
    v_mfma_f32_4x4x4_16b_bf16 v[72:75], v[208:209], v[208:209], v[72:75]
    v_mfma_f32_4x4x4_16b_bf16 v[76:79], v[210:211], v[210:211], v[76:79]
    v_mfma_f32_4x4x4_16b_bf16 v[80:83], v[212:213], v[212:213], v[80:83]
    v_mfma_f32_4x4x4_16b_bf16 v[84:87], v[214:215], v[214:215], v[84:87]
    v_mfma_f32_4x4x4_16b_bf16 v[72:75], v[216:217], v[216:217], v[72:75]
    v_mfma_f32_4x4x4_16b_bf16 v[76:79], v[218:219], v[218:219], v[76:79]
    v_mfma_f32_4x4x4_16b_bf16 v[80:83], v[220:221], v[220:221], v[80:83]
    v_mfma_f32_4x4x4_16b_bf16 v[84:87], v[222:223], v[222:223], v[84:87]
    v_mfma_f32_16x16x32_bf16 v[68:71], v[120:123], v[220:223], v[68:71]
    ds_read_b128 v[120:123], v40 offset:832
    v_mfma_f32_16x16x32_bf16 v[64:67], v[20:23], v[32:35], v[64:67]
    ds_read_b128 v[232:235], v38 offset:49152
    v_mfma_f32_32x32x16_bf16 v[48:63], v[32:35], v[220:223], v[48:63]
    ds_read_b64_tr_b16 v[32:33], v1 offset:4096
    ds_read_b64_tr_b16 v[34:35], v1 offset:4608
    s_waitcnt lgkmcnt(8)
    s_nop 0
    v_mfma_f32_16x16x32_bf16 v[68:71], v[112:115], v[224:227], v[68:71]
    ds_read_b128 v[112:115], v40 offset:864
    v_mfma_f32_16x16x32_bf16 v[64:67], v[20:23], v[24:27], v[64:67]
    ds_read_b128 v[236:239], v39 offset:49152
    v_mfma_f32_32x32x16_bf16 v[48:63], v[24:27], v[224:227], v[48:63]
    ds_read_b64_tr_b16 v[24:25], v1 offset:6144
    ds_read_b64_tr_b16 v[26:27], v1 offset:6656
    s_waitcnt lgkmcnt(8)
    v_mfma_f32_16x16x32_bf16 v[68:71], v[116:119], v[228:231], v[68:71]
    ds_read_b128 v[116:119], v40 offset:896
    s_barrier
    v_mfma_f32_16x16x32_bf16 v[64:67], v[20:23], v[28:31], v[64:67]
    ds_read_b128 v[240:243], v36 offset:57344
    v_mfma_f32_32x32x16_bf16 v[48:63], v[28:31], v[228:231], v[48:63]
    ds_read_b64_tr_b16 v[28:29], v2 offset:0
    ds_read_b64_tr_b16 v[30:31], v2 offset:512
    s_waitcnt lgkmcnt(8)
    s_nop 0
    v_mfma_f32_16x16x32_bf16 v[68:71], v[120:123], v[232:235], v[68:71]
    ds_read_b128 v[120:123], v40 offset:928
    v_mfma_f32_16x16x32_bf16 v[64:67], v[20:23], v[32:35], v[64:67]
    ds_read_b128 v[244:247], v37 offset:57344
    v_mfma_f32_32x32x16_bf16 v[48:63], v[32:35], v[232:235], v[48:63]
    ds_read_b64_tr_b16 v[32:33], v2 offset:2048
    ds_read_b64_tr_b16 v[34:35], v2 offset:2560
    s_waitcnt lgkmcnt(8)
    s_nop 0
    v_mfma_f32_4x4x4_16b_bf16 v[72:75], v[224:225], v[224:225], v[72:75]
    v_mfma_f32_4x4x4_16b_bf16 v[76:79], v[226:227], v[226:227], v[76:79]
    v_mfma_f32_4x4x4_16b_bf16 v[80:83], v[228:229], v[228:229], v[80:83]
    v_mfma_f32_4x4x4_16b_bf16 v[84:87], v[230:231], v[230:231], v[84:87]
    v_mfma_f32_4x4x4_16b_bf16 v[72:75], v[232:233], v[232:233], v[72:75]
    v_mfma_f32_4x4x4_16b_bf16 v[76:79], v[234:235], v[234:235], v[76:79]
    v_mfma_f32_4x4x4_16b_bf16 v[80:83], v[236:237], v[236:237], v[80:83]
    v_mfma_f32_4x4x4_16b_bf16 v[84:87], v[238:239], v[238:239], v[84:87]
    v_mfma_f32_16x16x32_bf16 v[68:71], v[112:115], v[236:239], v[68:71]
    ds_read_b128 v[112:115], v40 offset:960
    v_mfma_f32_16x16x32_bf16 v[64:67], v[20:23], v[24:27], v[64:67]
    ds_read_b128 v[248:251], v38 offset:57344
    v_mfma_f32_32x32x16_bf16 v[48:63], v[24:27], v[236:239], v[48:63]
    ds_read_b64_tr_b16 v[24:25], v2 offset:4096
    ds_read_b64_tr_b16 v[26:27], v2 offset:4608
    s_waitcnt lgkmcnt(8)
    s_nop 0
    v_mfma_f32_16x16x32_bf16 v[68:71], v[116:119], v[240:243], v[68:71]
    ds_read_b128 v[116:119], v40 offset:992
    v_mfma_f32_16x16x32_bf16 v[64:67], v[20:23], v[28:31], v[64:67]
    ds_read_b128 v[252:255], v39 offset:57344
    v_mfma_f32_32x32x16_bf16 v[48:63], v[28:31], v[240:243], v[48:63]
    ds_read_b64_tr_b16 v[28:29], v2 offset:6144
    ds_read_b64_tr_b16 v[30:31], v2 offset:6656
    s_waitcnt lgkmcnt(8)
    v_mfma_f32_16x16x32_bf16 v[68:71], v[120:123], v[244:247], v[68:71]
    v_mfma_f32_16x16x32_bf16 v[64:67], v[20:23], v[32:35], v[64:67]
    v_mfma_f32_32x32x16_bf16 v[48:63], v[32:35], v[244:247], v[48:63]
    s_waitcnt lgkmcnt(4)
    v_mfma_f32_16x16x32_bf16 v[68:71], v[112:115], v[248:251], v[68:71]
    v_mfma_f32_16x16x32_bf16 v[64:67], v[20:23], v[24:27], v[64:67]
    v_mfma_f32_32x32x16_bf16 v[48:63], v[24:27], v[248:251], v[48:63]
    s_waitcnt lgkmcnt(0)
    s_nop 0
    v_mfma_f32_4x4x4_16b_bf16 v[72:75], v[240:241], v[240:241], v[72:75]
    v_mfma_f32_4x4x4_16b_bf16 v[76:79], v[242:243], v[242:243], v[76:79]
    v_mfma_f32_4x4x4_16b_bf16 v[80:83], v[244:245], v[244:245], v[80:83]
    v_mfma_f32_4x4x4_16b_bf16 v[84:87], v[246:247], v[246:247], v[84:87]
    v_mfma_f32_4x4x4_16b_bf16 v[72:75], v[248:249], v[248:249], v[72:75]
    v_mfma_f32_4x4x4_16b_bf16 v[76:79], v[250:251], v[250:251], v[76:79]
    v_mfma_f32_4x4x4_16b_bf16 v[80:83], v[252:253], v[252:253], v[80:83]
    v_mfma_f32_4x4x4_16b_bf16 v[84:87], v[254:255], v[254:255], v[84:87]
    v_mfma_f32_16x16x32_bf16 v[68:71], v[116:119], v[252:255], v[68:71]
    v_mfma_f32_16x16x32_bf16 v[64:67], v[20:23], v[28:31], v[64:67]
    v_mfma_f32_32x32x16_bf16 v[48:63], v[28:31], v[252:255], v[48:63]
    s_nop 0
    v_add_f32 v72, v72, v80
    v_add_f32 v73, v73, v81
    v_add_f32 v74, v74, v82
    v_add_f32 v75, v75, v83
    v_add_f32 v76, v76, v84
    v_add_f32 v77, v77, v85
    v_add_f32 v78, v78, v86
    v_add_f32 v79, v79, v87
    v_add_f32 v72, v72, v76
    v_add_f32 v73, v73, v77
    v_add_f32 v74, v74, v78
    v_add_f32_e64 v75, v75, v79
    v_cndmask_b32 v72, v72, v73, s[96:97]
    v_cndmask_b32 v72, v72, v74, s[98:99]
    v_cndmask_b32 v72, v72, v75, s[100:101]
    v_mov_b32 v73, v72
    v_mul_f32 v14, 0xbfb8aa3b, v69
    v_exp_f32 v14, v14
    v_permlane32_swap_b32 v72, v73
    v_add_f32 v72, v72, v73
    v_mul_f32 v45, 0xbb000000, v68
    v_cvt_pk_bf16_f32 v104, v45, v45
    v_lshlrev_b32 v47, 16, v104
    v_sub_f32 v47, v45, v47
    v_cvt_pk_bf16_f32 v47, v47, v47
    v_cndmask_b32 v104, v104, v47, s[52:53]
    v_cvt_pk_bf16_f32 v47, v64, v64
    v_lshlrev_b32 v47, 16, v47
    v_sub_f32 v47, v64, v47
    v_cvt_pk_bf16_f32 v108, v64, v47
    s_nop 1
    v_mfma_f32_32x32x16_bf16 v[48:63], v[108:111], v[104:107], v[48:63]
    s_barrier
    v_mul_f32_e64 v46, v45, v45
    v_mov_b32 v47, 0x3b000000
    v_fma_f32 v46, v72, v47, -v46
    v_max_f32 v46, 0, v46
    v_add_f32 v46, 0x3727c5ac, v46
    v_rsq_f32 v47, v46
    v_add_f32 v14, 1.0, v14
    v_mul_f32 v100, v46, v47
    v_mul_f32 v96, 0xc0135761, v47
    v_mul_f32 v46, v47, v47
    v_mul_f32 v46, 0x3d372713, v46
    v_mul_f32 v98, v96, v46
    v_rcp_f32_e64 v14, v14
    v_pk_mul_f32 v[64:65], v[48:49], v[48:49]
    v_pk_mul_f32 v[66:67], v[50:51], v[50:51]
    v_pk_mul_f32 v[68:69], v[52:53], v[52:53]
    v_pk_mul_f32 v[70:71], v[54:55], v[54:55]
    v_pk_mul_f32 v[72:73], v[56:57], v[56:57]
    v_pk_mul_f32 v[74:75], v[58:59], v[58:59]
    v_pk_mul_f32 v[76:77], v[60:61], v[60:61]
    v_pk_mul_f32 v[78:79], v[62:63], v[62:63]
    v_pk_fma_f32 v[64:65], v[64:65], v[98:99], v[96:97] op_sel_hi:[1,0,0]
    v_pk_fma_f32 v[66:67], v[66:67], v[98:99], v[96:97] op_sel_hi:[1,0,0]
    v_pk_fma_f32 v[68:69], v[68:69], v[98:99], v[96:97] op_sel_hi:[1,0,0]
    v_pk_fma_f32 v[70:71], v[70:71], v[98:99], v[96:97] op_sel_hi:[1,0,0]
    v_pk_fma_f32 v[72:73], v[72:73], v[98:99], v[96:97] op_sel_hi:[1,0,0]
    v_pk_fma_f32 v[74:75], v[74:75], v[98:99], v[96:97] op_sel_hi:[1,0,0]
    v_pk_fma_f32 v[76:77], v[76:77], v[98:99], v[96:97] op_sel_hi:[1,0,0]
    v_pk_fma_f32 v[78:79], v[78:79], v[98:99], v[96:97] op_sel_hi:[1,0,0]
    v_pk_mul_f32 v[64:65], v[64:65], v[48:49]
    v_pk_mul_f32 v[66:67], v[66:67], v[50:51]
    v_pk_mul_f32 v[68:69], v[68:69], v[52:53]
    v_pk_mul_f32 v[70:71], v[70:71], v[54:55]
    v_pk_mul_f32 v[72:73], v[72:73], v[56:57]
    v_pk_mul_f32 v[74:75], v[74:75], v[58:59]
    v_pk_mul_f32 v[76:77], v[76:77], v[60:61]
    v_pk_mul_f32 v[78:79], v[78:79], v[62:63]
    v_exp_f32 v64, v64
    v_exp_f32 v65, v65
    v_exp_f32 v66, v66
    v_exp_f32 v67, v67
L_pg4:
    s_cbranch_execz L_pr4
    v_exp_f32 v68, v68
    v_exp_f32 v69, v69
    v_exp_f32 v70, v70
    v_exp_f32 v71, v71
    v_exp_f32 v72, v72
    v_exp_f32 v73, v73
    v_exp_f32 v74, v74
    v_exp_f32 v75, v75
    v_exp_f32 v76, v76
    v_exp_f32 v77, v77
    v_exp_f32 v78, v78
    v_exp_f32_e64 v79, v79
    v_pk_fma_f32 v[64:65], v[64:65], v[100:101], v[100:101] op_sel_hi:[1,0,0]
    v_pk_fma_f32 v[66:67], v[66:67], v[100:101], v[100:101] op_sel_hi:[1,0,0]
    v_pk_fma_f32 v[68:69], v[68:69], v[100:101], v[100:101] op_sel_hi:[1,0,0]
    v_pk_fma_f32 v[70:71], v[70:71], v[100:101], v[100:101] op_sel_hi:[1,0,0]
    v_pk_fma_f32 v[72:73], v[72:73], v[100:101], v[100:101] op_sel_hi:[1,0,0]
    v_pk_fma_f32 v[74:75], v[74:75], v[100:101], v[100:101] op_sel_hi:[1,0,0]
    v_pk_fma_f32 v[76:77], v[76:77], v[100:101], v[100:101] op_sel_hi:[1,0,0]
    v_pk_fma_f32 v[78:79], v[78:79], v[100:101], v[100:101] op_sel_hi:[1,0,0]
    v_rcp_f32 v64, v64
    v_rcp_f32 v65, v65
    v_rcp_f32 v66, v66
    v_rcp_f32 v67, v67
    v_rcp_f32 v68, v68
    v_rcp_f32 v69, v69
    v_rcp_f32 v70, v70
    v_rcp_f32 v71, v71
    v_rcp_f32 v72, v72
    v_rcp_f32 v73, v73
    v_rcp_f32 v74, v74
    v_rcp_f32 v75, v75
    v_rcp_f32 v76, v76
    v_rcp_f32 v77, v77
    v_rcp_f32 v78, v78
    v_rcp_f32 v79, v79
    v_pk_mul_f32 v[64:65], v[64:65], v[48:49]
    v_pk_mul_f32 v[66:67], v[66:67], v[50:51]
    v_pk_mul_f32 v[68:69], v[68:69], v[52:53]
    v_pk_mul_f32 v[70:71], v[70:71], v[54:55]
    v_pk_mul_f32 v[72:73], v[72:73], v[56:57]
    v_pk_mul_f32 v[74:75], v[74:75], v[58:59]
    v_pk_mul_f32 v[76:77], v[76:77], v[60:61]
    v_pk_mul_f32 v[78:79], v[78:79], v[62:63]
    v_cvt_pk_bf16_f32 v36, v64, v65
    v_cvt_pk_bf16_f32 v37, v66, v67
    v_cvt_pk_bf16_f32 v38, v68, v69
    v_cvt_pk_bf16_f32 v39, v70, v71
    v_cvt_pk_bf16_f32 v40, v72, v73
    v_cvt_pk_bf16_f32 v41, v74, v75
    v_cvt_pk_bf16_f32 v42, v76, v77
    v_cvt_pk_bf16_f32 v43, v78, v79
    v_cndmask_b32 v36, v36, 0, s[44:45]
    v_cndmask_b32 v37, v37, 0, s[44:45]
    v_cndmask_b32 v38, v38, 0, s[44:45]
    v_cndmask_b32 v39, v39, 0, s[44:45]
    v_cndmask_b32 v40, v40, 0, s[44:45]
    v_cndmask_b32 v41, v41, 0, s[44:45]
    v_cndmask_b32 v42, v42, 0, s[44:45]
    v_cndmask_b32 v43, v43, 0, s[44:45]
    buffer_store_dwordx4 v[36:39], v10, s[36:39], s4 offen sc1
    buffer_store_dwordx4 v[40:43], v10, s[36:39], s4 offen offset:2048 sc1
    s_barrier
    s_nop 0
    ds_read_b64_tr_b16 v[24:25], v1 offset:8192
    ds_read_b64_tr_b16 v[26:27], v1 offset:8704
    ds_read_b64_tr_b16 v[28:29], v1 offset:10240
    ds_read_b64_tr_b16 v[30:31], v1 offset:10752
    ds_read_b64_tr_b16 v[32:33], v1 offset:12288
    ds_read_b64_tr_b16 v[34:35], v1 offset:12800
    s_waitcnt lgkmcnt(4)
    v_mfma_f32_32x32x16_bf16 v[48:63], v[24:27], v[128:131], 0
    ds_read_b64_tr_b16 v[24:25], v1 offset:14336
    ds_read_b64_tr_b16 v[26:27], v1 offset:14848
    s_waitcnt lgkmcnt(4)
    v_mfma_f32_32x32x16_bf16 v[48:63], v[28:31], v[132:135], v[48:63]
    s_barrier
    ds_read_b64_tr_b16 v[28:29], v2 offset:8192
    ds_read_b64_tr_b16 v[30:31], v2 offset:8704
    s_waitcnt lgkmcnt(4)
    v_mfma_f32_32x32x16_bf16 v[48:63], v[32:35], v[136:139], v[48:63]
    ds_read_b64_tr_b16 v[32:33], v2 offset:10240
    ds_read_b64_tr_b16 v[34:35], v2 offset:10752
    s_waitcnt lgkmcnt(4)
    v_mfma_f32_32x32x16_bf16 v[48:63], v[24:27], v[140:143], v[48:63]
    ds_read_b64_tr_b16 v[24:25], v2 offset:12288
    ds_read_b64_tr_b16 v[26:27], v2 offset:12800
    s_waitcnt lgkmcnt(4)
    v_mfma_f32_32x32x16_bf16 v[48:63], v[28:31], v[144:147], v[48:63]
    ds_read_b64_tr_b16 v[28:29], v2 offset:14336
    ds_read_b64_tr_b16 v[30:31], v2 offset:14848
    s_waitcnt lgkmcnt(4)
    v_mfma_f32_32x32x16_bf16 v[48:63], v[32:35], v[148:151], v[48:63]
    s_barrier
    ds_read_b64_tr_b16 v[32:33], v2 offset:49152
    ds_read_b64_tr_b16 v[34:35], v2 offset:49664
    s_waitcnt lgkmcnt(4)
    v_mfma_f32_32x32x16_bf16 v[48:63], v[24:27], v[152:155], v[48:63]
    ds_read_b64_tr_b16 v[24:25], v2 offset:51200
    ds_read_b64_tr_b16 v[26:27], v2 offset:51712
    s_waitcnt lgkmcnt(4)
    v_mfma_f32_32x32x16_bf16 v[48:63], v[28:31], v[156:159], v[48:63]
    ds_read_b64_tr_b16 v[28:29], v2 offset:53248
    ds_read_b64_tr_b16 v[30:31], v2 offset:53760
    s_waitcnt lgkmcnt(4)
    v_mfma_f32_32x32x16_bf16 v[48:63], v[32:35], v[160:163], v[48:63]
    ds_read_b64_tr_b16 v[32:33], v2 offset:55296
    ds_read_b64_tr_b16 v[34:35], v2 offset:55808
    s_waitcnt lgkmcnt(4)
    v_mfma_f32_32x32x16_bf16 v[48:63], v[24:27], v[164:167], v[48:63]
    s_barrier
    ds_read_b64_tr_b16 v[24:25], v1 offset:16384
    ds_read_b64_tr_b16 v[26:27], v1 offset:16896
    s_waitcnt lgkmcnt(4)
    v_mfma_f32_32x32x16_bf16 v[48:63], v[28:31], v[168:171], v[48:63]
    ds_read_b64_tr_b16 v[28:29], v1 offset:18432
    ds_read_b64_tr_b16 v[30:31], v1 offset:18944
    s_waitcnt lgkmcnt(4)
    v_mfma_f32_32x32x16_bf16 v[48:63], v[32:35], v[172:175], v[48:63]
    ds_read_b64_tr_b16 v[32:33], v1 offset:20480
    ds_read_b64_tr_b16 v[34:35], v1 offset:20992
    s_waitcnt lgkmcnt(4)
    v_mfma_f32_32x32x16_bf16 v[48:63], v[24:27], v[176:179], v[48:63]
    ds_read_b64_tr_b16 v[24:25], v1 offset:22528
    ds_read_b64_tr_b16 v[26:27], v1 offset:23040
    s_waitcnt lgkmcnt(4)
    v_mfma_f32_32x32x16_bf16 v[48:63], v[28:31], v[180:183], v[48:63]
    s_barrier
    ds_read_b64_tr_b16 v[28:29], v1 offset:24576
    ds_read_b64_tr_b16 v[30:31], v1 offset:25088
    s_waitcnt lgkmcnt(4)
    v_mfma_f32_32x32x16_bf16 v[48:63], v[32:35], v[184:187], v[48:63]
    ds_read_b64_tr_b16 v[32:33], v1 offset:26624
    ds_read_b64_tr_b16 v[34:35], v1 offset:27136
    s_waitcnt lgkmcnt(4)
    v_mfma_f32_32x32x16_bf16 v[48:63], v[24:27], v[188:191], v[48:63]
    ds_read_b64_tr_b16 v[24:25], v1 offset:28672
    ds_read_b64_tr_b16 v[26:27], v1 offset:29184
    s_waitcnt lgkmcnt(4)
    v_mfma_f32_32x32x16_bf16 v[48:63], v[28:31], v[192:195], v[48:63]
    ds_read_b64_tr_b16 v[28:29], v1 offset:30720
    ds_read_b64_tr_b16 v[30:31], v1 offset:31232
    s_waitcnt lgkmcnt(4)
    v_mfma_f32_32x32x16_bf16 v[48:63], v[32:35], v[196:199], v[48:63]
    s_barrier
    ds_read_b64_tr_b16 v[32:33], v1 offset:32768
    ds_read_b64_tr_b16 v[34:35], v1 offset:33280
    s_waitcnt lgkmcnt(4)
    v_mfma_f32_32x32x16_bf16 v[48:63], v[24:27], v[200:203], v[48:63]
    ds_read_b64_tr_b16 v[24:25], v1 offset:34816
    ds_read_b64_tr_b16 v[26:27], v1 offset:35328
    s_waitcnt lgkmcnt(4)
    v_mfma_f32_32x32x16_bf16 v[48:63], v[28:31], v[204:207], v[48:63]
    ds_read_b64_tr_b16 v[28:29], v1 offset:36864
    ds_read_b64_tr_b16 v[30:31], v1 offset:37376
    s_waitcnt lgkmcnt(4)
    v_mfma_f32_32x32x16_bf16 v[48:63], v[32:35], v[208:211], v[48:63]
    ds_read_b64_tr_b16 v[32:33], v1 offset:38912
    ds_read_b64_tr_b16 v[34:35], v1 offset:39424
    s_waitcnt lgkmcnt(4)
    v_mfma_f32_32x32x16_bf16 v[48:63], v[24:27], v[212:215], v[48:63]
    s_waitcnt vmcnt(0)
    s_barrier
    ds_read_b64_tr_b16 v[24:25], v2 offset:16384
    ds_read_b64_tr_b16 v[26:27], v2 offset:16896
    s_waitcnt lgkmcnt(4)
    v_mfma_f32_32x32x16_bf16 v[48:63], v[28:31], v[216:219], v[48:63]
    ds_read_b64_tr_b16 v[28:29], v2 offset:18432
    ds_read_b64_tr_b16 v[30:31], v2 offset:18944
    s_waitcnt lgkmcnt(4)
    v_mfma_f32_32x32x16_bf16 v[48:63], v[32:35], v[220:223], v[48:63]
    ds_read_b64_tr_b16 v[32:33], v2 offset:20480
    ds_read_b64_tr_b16 v[34:35], v2 offset:20992
    s_waitcnt lgkmcnt(4)
    v_mfma_f32_32x32x16_bf16 v[48:63], v[24:27], v[224:227], v[48:63]
    ds_read_b64_tr_b16 v[24:25], v2 offset:22528
    ds_read_b64_tr_b16 v[26:27], v2 offset:23040
    s_waitcnt lgkmcnt(4)
    v_mfma_f32_32x32x16_bf16 v[48:63], v[28:31], v[228:231], v[48:63]
    s_barrier
    ds_read_b64_tr_b16 v[28:29], v1 offset:40960
    ds_read_b64_tr_b16 v[30:31], v1 offset:41472
    s_waitcnt lgkmcnt(4)
    v_mfma_f32_32x32x16_bf16 v[48:63], v[32:35], v[232:235], v[48:63]
    ds_read_b64_tr_b16 v[32:33], v1 offset:43008
    ds_read_b64_tr_b16 v[34:35], v1 offset:43520
    s_waitcnt lgkmcnt(4)
    v_mfma_f32_32x32x16_bf16 v[48:63], v[24:27], v[236:239], v[48:63]
    ds_read_b64_tr_b16 v[24:25], v1 offset:45056
    ds_read_b64_tr_b16 v[26:27], v1 offset:45568
    s_waitcnt lgkmcnt(4)
    v_mfma_f32_32x32x16_bf16 v[48:63], v[28:31], v[240:243], v[48:63]
    ds_read_b64_tr_b16 v[28:29], v1 offset:47104
    ds_read_b64_tr_b16 v[30:31], v1 offset:47616
    s_waitcnt lgkmcnt(4)
    v_mfma_f32_32x32x16_bf16 v[48:63], v[32:35], v[244:247], v[48:63]
    s_barrier
    ds_read_b64_tr_b16 v[32:33], v2 offset:24576
    ds_read_b64_tr_b16 v[34:35], v2 offset:25088
    s_waitcnt lgkmcnt(4)
    v_mfma_f32_32x32x16_bf16 v[48:63], v[24:27], v[248:251], v[48:63]
    ds_read_b64_tr_b16 v[24:25], v2 offset:26624
    ds_read_b64_tr_b16 v[26:27], v2 offset:27136
    s_waitcnt lgkmcnt(4)
    v_mfma_f32_32x32x16_bf16 v[48:63], v[28:31], v[252:255], v[48:63]
    ds_read_b64_tr_b16 v[28:29], v2 offset:28672
    ds_read_b64_tr_b16 v[30:31], v2 offset:29184
    s_waitcnt lgkmcnt(4)
    v_mfma_f32_32x32x16_bf16 v[64:79], v[128:131], v[32:35], 0
    ds_read_b64_tr_b16 v[32:33], v2 offset:30720
    ds_read_b64_tr_b16 v[34:35], v2 offset:31232
    s_waitcnt lgkmcnt(4)
    v_mfma_f32_32x32x16_bf16 v[64:79], v[132:135], v[24:27], v[64:79]
    s_barrier
    ds_read_b64_tr_b16 v[24:25], v1 offset:0
    ds_read_b64_tr_b16 v[26:27], v1 offset:512
    s_waitcnt lgkmcnt(4)
    v_mfma_f32_32x32x16_bf16 v[64:79], v[136:139], v[28:31], v[64:79]
    ds_read_b64_tr_b16 v[28:29], v1 offset:2048
    ds_read_b64_tr_b16 v[30:31], v1 offset:2560
    s_waitcnt lgkmcnt(4)
    v_mfma_f32_32x32x16_bf16 v[64:79], v[140:143], v[32:35], v[64:79]
    ds_read_b64_tr_b16 v[32:33], v1 offset:4096
    ds_read_b64_tr_b16 v[34:35], v1 offset:4608
    v_cvt_pk_bf16_f32 v96, v48, v49
    v_cvt_pk_bf16_f32 v97, v50, v51
    s_waitcnt lgkmcnt(4)
    v_mfma_f32_32x32x16_bf16 v[64:79], v[144:147], v[24:27], v[64:79]
    ds_read_b64_tr_b16 v[24:25], v1 offset:6144
    ds_read_b64_tr_b16 v[26:27], v1 offset:6656
    v_cvt_pk_bf16_f32 v98, v52, v53
    v_cvt_pk_bf16_f32 v99, v54, v55
    s_waitcnt lgkmcnt(4)
    v_mfma_f32_32x32x16_bf16 v[64:79], v[148:151], v[28:31], v[64:79]
    s_barrier
    ds_read_b64_tr_b16 v[28:29], v1 offset:49152
    ds_read_b64_tr_b16 v[30:31], v1 offset:49664
    v_cvt_pk_bf16_f32 v100, v56, v57
    v_cvt_pk_bf16_f32 v101, v58, v59
    s_waitcnt lgkmcnt(4)
    v_mfma_f32_32x32x16_bf16 v[64:79], v[152:155], v[32:35], v[64:79]
    ds_read_b64_tr_b16 v[32:33], v1 offset:51200
    ds_read_b64_tr_b16 v[34:35], v1 offset:51712
    v_cvt_pk_bf16_f32 v102, v60, v61
    v_cvt_pk_bf16_f32 v103, v62, v63
    s_waitcnt lgkmcnt(4)
    v_mfma_f32_32x32x16_bf16 v[64:79], v[156:159], v[24:27], v[64:79]
    ds_read_b64_tr_b16 v[24:25], v1 offset:53248
    ds_read_b64_tr_b16 v[26:27], v1 offset:53760
    buffer_store_dwordx4 v[96:99], v7, s[36:39], s5 offen sc1
    buffer_store_dwordx4 v[100:103], v7, s[36:39], s6 offen offset:0 sc1
    s_waitcnt lgkmcnt(4)
    v_mfma_f32_32x32x16_bf16 v[64:79], v[160:163], v[28:31], v[64:79]
    ds_read_b64_tr_b16 v[28:29], v1 offset:55296
    ds_read_b64_tr_b16 v[30:31], v1 offset:55808
    s_waitcnt lgkmcnt(4)
    v_mfma_f32_32x32x16_bf16 v[64:79], v[164:167], v[32:35], v[64:79]
    s_barrier
    ds_read_b64_tr_b16 v[32:33], v1 offset:8192
    ds_read_b64_tr_b16 v[34:35], v1 offset:8704
    s_waitcnt lgkmcnt(4)
    v_mfma_f32_32x32x16_bf16 v[64:79], v[168:171], v[24:27], v[64:79]
    ds_read_b64_tr_b16 v[24:25], v1 offset:10240
    ds_read_b64_tr_b16 v[26:27], v1 offset:10752
    s_waitcnt lgkmcnt(4)
    v_mfma_f32_32x32x16_bf16 v[64:79], v[172:175], v[28:31], v[64:79]
    ds_read_b64_tr_b16 v[28:29], v1 offset:12288
    ds_read_b64_tr_b16 v[30:31], v1 offset:12800
    s_waitcnt lgkmcnt(4)
    v_mfma_f32_32x32x16_bf16 v[64:79], v[176:179], v[32:35], v[64:79]
    ds_read_b64_tr_b16 v[32:33], v1 offset:14336
    ds_read_b64_tr_b16 v[34:35], v1 offset:14848
    s_sub_u32 s47, s29, s46
    s_and_b32 s47, s47, 7
    s_lshl_b32 s47, s47, 1
    s_add_u32 s47, s47, s59
    s_lshl_b32 s47, s47, 3
    s_set_gpr_idx_on s47, 1
    v_mov_b32_e32 v88, v128
    v_mov_b32_e32 v89, v129
    v_mov_b32_e32 v90, v130
    v_mov_b32_e32 v91, v131
    s_set_gpr_idx_off
    s_waitcnt lgkmcnt(4)
    v_mfma_f32_32x32x16_bf16 v[64:79], v[180:183], v[24:27], v[64:79]
    s_barrier
    ds_read_b64_tr_b16 v[24:25], v1 offset:57344
    ds_read_b64_tr_b16 v[26:27], v1 offset:57856
    s_set_gpr_idx_on s47, 1
    v_mov_b32_e32 v92, v132
    v_mov_b32_e32 v93, v133
    v_mov_b32_e32 v94, v134
    v_mov_b32_e32 v95, v135
    s_set_gpr_idx_off
    s_waitcnt lgkmcnt(4)
    v_mfma_f32_32x32x16_bf16 v[64:79], v[184:187], v[28:31], v[64:79]
    ds_read_b64_tr_b16 v[28:29], v1 offset:59392
    ds_read_b64_tr_b16 v[30:31], v1 offset:59904
    v_add_u32 v10, 65536, v5
    v_permlane32_swap_b32 v88, v90
    s_waitcnt lgkmcnt(4)
    v_mfma_f32_32x32x16_bf16 v[64:79], v[188:191], v[32:35], v[64:79]
    ds_read_b64_tr_b16 v[32:33], v1 offset:61440
    ds_read_b64_tr_b16 v[34:35], v1 offset:61952
    v_permlane32_swap_b32 v89, v91
    s_waitcnt lgkmcnt(4)
    v_mfma_f32_32x32x16_bf16 v[64:79], v[192:195], v[24:27], v[64:79]
    ds_read_b64_tr_b16 v[24:25], v1 offset:63488
    ds_read_b64_tr_b16 v[26:27], v1 offset:64000
    v_permlane32_swap_b32 v92, v94
    v_permlane32_swap_b32 v93, v95
    s_waitcnt lgkmcnt(4)
    v_mfma_f32_32x32x16_bf16 v[64:79], v[196:199], v[28:31], v[64:79]
    s_barrier
    ds_read_b64_tr_b16 v[28:29], v2 offset:0
    ds_read_b64_tr_b16 v[30:31], v2 offset:512
    v_lshlrev_b32_e64 v80, 16, v88
    s_waitcnt lgkmcnt(4)
    v_mfma_f32_32x32x16_bf16 v[64:79], v[200:203], v[32:35], v[64:79]
    ds_read_b64_tr_b16 v[32:33], v2 offset:2048
    ds_read_b64_tr_b16 v[34:35], v2 offset:2560
    v_and_b32 v81, 0xffff0000, v88
    v_lshlrev_b32 v82, 16, v89
    s_waitcnt lgkmcnt(4)
    v_mfma_f32_32x32x16_bf16 v[64:79], v[204:207], v[24:27], v[64:79]
    ds_read_b64_tr_b16 v[24:25], v2 offset:4096
    ds_read_b64_tr_b16 v[26:27], v2 offset:4608
    v_and_b32 v83, 0xffff0000, v89
    s_waitcnt lgkmcnt(4)
    v_mfma_f32_32x32x16_bf16 v[64:79], v[208:211], v[28:31], v[64:79]
    ds_read_b64_tr_b16 v[28:29], v2 offset:6144
    ds_read_b64_tr_b16 v[30:31], v2 offset:6656
    v_lshlrev_b32 v84, 16, v90
    v_and_b32 v85, 0xffff0000, v90
    s_waitcnt lgkmcnt(4)
    v_mfma_f32_32x32x16_bf16 v[64:79], v[212:215], v[32:35], v[64:79]
    s_barrier
    ds_read_b64_tr_b16 v[32:33], v1 offset:16384
    ds_read_b64_tr_b16 v[34:35], v1 offset:16896
    v_lshlrev_b32 v86, 16, v91
    s_waitcnt lgkmcnt(4)
    v_mfma_f32_32x32x16_bf16 v[64:79], v[216:219], v[24:27], v[64:79]
    ds_read_b64_tr_b16 v[24:25], v1 offset:18432
    ds_read_b64_tr_b16 v[26:27], v1 offset:18944
    v_and_b32 v87, 0xffff0000, v91
    v_lshlrev_b32 v88, 16, v92
    s_waitcnt lgkmcnt(4)
    v_mfma_f32_32x32x16_bf16 v[64:79], v[220:223], v[28:31], v[64:79]
    ds_read_b64_tr_b16 v[28:29], v1 offset:20480
    ds_read_b64_tr_b16 v[30:31], v1 offset:20992
    v_and_b32 v89, 0xffff0000, v92
    s_waitcnt lgkmcnt(4)
    v_mfma_f32_32x32x16_bf16 v[64:79], v[224:227], v[32:35], v[64:79]
    ds_read_b64_tr_b16 v[32:33], v1 offset:22528
    ds_read_b64_tr_b16 v[34:35], v1 offset:23040
    v_lshlrev_b32 v90, 16, v93
    v_and_b32 v91, 0xffff0000, v93
    s_waitcnt lgkmcnt(4)
    v_mfma_f32_32x32x16_bf16 v[64:79], v[228:231], v[24:27], v[64:79]
    s_barrier
    ds_read_b64_tr_b16 v[24:25], v1 offset:24576
    ds_read_b64_tr_b16 v[26:27], v1 offset:25088
    v_lshlrev_b32 v92, 16, v94
    s_waitcnt lgkmcnt(4)
    v_mfma_f32_32x32x16_bf16 v[64:79], v[232:235], v[28:31], v[64:79]
    ds_read_b64_tr_b16 v[28:29], v1 offset:26624
    ds_read_b64_tr_b16 v[30:31], v1 offset:27136
    v_and_b32 v93, 0xffff0000, v94
    v_lshlrev_b32 v94, 16, v95
    s_waitcnt lgkmcnt(4)
    v_mfma_f32_32x32x16_bf16 v[64:79], v[236:239], v[32:35], v[64:79]
    ds_read_b64_tr_b16 v[32:33], v1 offset:28672
    ds_read_b64_tr_b16 v[34:35], v1 offset:29184
    v_and_b32 v95, 0xffff0000, v95
    s_waitcnt lgkmcnt(4)
    v_mfma_f32_32x32x16_bf16 v[64:79], v[240:243], v[24:27], v[64:79]
    ds_read_b64_tr_b16 v[24:25], v1 offset:30720
    ds_read_b64_tr_b16 v[26:27], v1 offset:31232
    v_and_b32 v11, 1023, v5
    v_lshrrev_b32 v11, 1, v11
    s_waitcnt lgkmcnt(4)
    v_mfma_f32_32x32x16_bf16 v[64:79], v[244:247], v[28:31], v[64:79]
    s_barrier
    ds_read_b64_tr_b16 v[28:29], v1 offset:32768
    ds_read_b64_tr_b16 v[30:31], v1 offset:33280
    v_mov_b32 v12, 0x3f803f80
    s_waitcnt lgkmcnt(4)
    v_mfma_f32_32x32x16_bf16 v[64:79], v[248:251], v[32:35], v[64:79]
    ds_read_b64_tr_b16 v[32:33], v1 offset:34816
    ds_read_b64_tr_b16 v[34:35], v1 offset:35328
    s_waitcnt lgkmcnt(4)
    v_mfma_f32_32x32x16_bf16 v[64:79], v[252:255], v[24:27], v[64:79]
    ds_read_b64_tr_b16 v[24:25], v1 offset:36864
    ds_read_b64_tr_b16 v[26:27], v1 offset:37376
    s_waitcnt lgkmcnt(4)
    v_mfma_f32_32x32x16_bf16 v[48:63], v[28:31], v[128:131], 0
    ds_read_b64_tr_b16 v[28:29], v1 offset:38912
    ds_read_b64_tr_b16 v[30:31], v1 offset:39424
    s_waitcnt lgkmcnt(4)
    v_mfma_f32_32x32x16_bf16 v[48:63], v[32:35], v[132:135], v[48:63]
    s_barrier
    ds_read_b64_tr_b16 v[32:33], v2 offset:8192
    ds_read_b64_tr_b16 v[34:35], v2 offset:8704
    s_waitcnt lgkmcnt(4)
    v_mfma_f32_32x32x16_bf16 v[48:63], v[24:27], v[136:139], v[48:63]
    ds_read_b64_tr_b16 v[24:25], v2 offset:10240
    ds_read_b64_tr_b16 v[26:27], v2 offset:10752
    v_cvt_pk_bf16_f32 v112, v64, v65
    v_cvt_pk_bf16_f32 v113, v66, v67
    v_cvt_pk_bf16_f32 v114, v68, v69
    s_waitcnt lgkmcnt(4)
    s_nop 0
    v_mfma_f32_32x32x16_bf16 v[48:63], v[28:31], v[140:143], v[48:63]
    ds_read_b64_tr_b16 v[28:29], v2 offset:12288
    ds_read_b64_tr_b16 v[30:31], v2 offset:12800
    v_cvt_pk_bf16_f32 v115, v70, v71
    v_cvt_pk_bf16_f32 v116, v72, v73
    v_cvt_pk_bf16_f32 v117, v74, v75
    s_waitcnt lgkmcnt(4)
    s_nop 0
    v_mfma_f32_32x32x16_bf16 v[48:63], v[32:35], v[144:147], v[48:63]
    ds_read_b64_tr_b16 v[32:33], v2 offset:14336
    ds_read_b64_tr_b16 v[34:35], v2 offset:14848
    v_cvt_pk_bf16_f32 v118, v76, v77
    v_cvt_pk_bf16_f32 v119, v78, v79
    buffer_store_dwordx4 v[112:115], v9, s[36:39], s5 offen sc1
    buffer_store_dwordx4 v[116:119], v9, s[36:39], s5 offen offset:512 sc1
    s_waitcnt lgkmcnt(4)
    v_mfma_f32_32x32x16_bf16 v[48:63], v[24:27], v[148:151], v[48:63]
    s_barrier
    ds_read_b64_tr_b16 v[24:25], v1 offset:40960
    ds_read_b64_tr_b16 v[26:27], v1 offset:41472
    s_waitcnt lgkmcnt(4)
    v_mfma_f32_32x32x16_bf16 v[48:63], v[28:31], v[152:155], v[48:63]
    ds_read_b64_tr_b16 v[28:29], v1 offset:43008
    ds_read_b64_tr_b16 v[30:31], v1 offset:43520
    s_waitcnt lgkmcnt(4)
    v_mfma_f32_32x32x16_bf16 v[48:63], v[32:35], v[156:159], v[48:63]
    ds_read_b64_tr_b16 v[32:33], v1 offset:45056
    ds_read_b64_tr_b16 v[34:35], v1 offset:45568
    s_waitcnt lgkmcnt(4)
    v_mfma_f32_32x32x16_bf16 v[48:63], v[24:27], v[160:163], v[48:63]
    ds_read_b64_tr_b16 v[24:25], v1 offset:47104
    ds_read_b64_tr_b16 v[26:27], v1 offset:47616
    v_mov_b32 v17, 0xffff0000
    s_waitcnt lgkmcnt(4)
    v_mfma_f32_32x32x16_bf16 v[48:63], v[28:31], v[164:167], v[48:63]
    s_barrier
    ds_read_b64_tr_b16 v[28:29], v2 offset:16384
    ds_read_b64_tr_b16 v[30:31], v2 offset:16896
    v_mov_b32 v18, 0xffff
    s_waitcnt lgkmcnt(4)
    v_mfma_f32_32x32x16_bf16 v[48:63], v[32:35], v[168:171], v[48:63]
    ds_read_b64_tr_b16 v[32:33], v2 offset:18432
    ds_read_b64_tr_b16 v[34:35], v2 offset:18944
    v_cndmask_b32 v20, 0, v18, s[60:61]
    s_waitcnt lgkmcnt(4)
    v_mfma_f32_32x32x16_bf16 v[48:63], v[24:27], v[172:175], v[48:63]
    ds_read_b64_tr_b16 v[24:25], v2 offset:20480
    ds_read_b64_tr_b16 v[26:27], v2 offset:20992
    s_waitcnt lgkmcnt(4)
    v_mfma_f32_32x32x16_bf16 v[48:63], v[28:31], v[176:179], v[48:63]
    ds_read_b64_tr_b16 v[28:29], v2 offset:22528
    ds_read_b64_tr_b16 v[30:31], v2 offset:23040
    v_cndmask_b32 v16, 0, v17, s[62:63]
    s_waitcnt lgkmcnt(4)
    v_mfma_f32_32x32x16_bf16 v[48:63], v[32:35], v[180:183], v[48:63]
    s_barrier
    ds_read_b64_tr_b16 v[32:33], v1 offset:0
    ds_read_b64_tr_b16 v[34:35], v1 offset:512
    v_or_b32 v20, v20, v16
    s_waitcnt lgkmcnt(4)
    v_mfma_f32_32x32x16_bf16 v[48:63], v[24:27], v[184:187], v[48:63]
    ds_read_b64_tr_b16 v[24:25], v1 offset:2048
    ds_read_b64_tr_b16 v[26:27], v1 offset:2560
    s_waitcnt lgkmcnt(4)
    v_mfma_f32_32x32x16_bf16 v[48:63], v[28:31], v[188:191], v[48:63]
    ds_read_b64_tr_b16 v[28:29], v1 offset:4096
    ds_read_b64_tr_b16 v[30:31], v1 offset:4608
    v_cndmask_b32 v21, 0, v18, s[64:65]
    s_waitcnt lgkmcnt(4)
    v_mfma_f32_32x32x16_bf16 v[48:63], v[32:35], v[192:195], v[48:63]
    ds_read_b64_tr_b16 v[32:33], v1 offset:6144
    ds_read_b64_tr_b16 v[34:35], v1 offset:6656
    v_cndmask_b32 v16, 0, v17, s[66:67]
    s_waitcnt lgkmcnt(4)
    v_mfma_f32_32x32x16_bf16 v[48:63], v[24:27], v[196:199], v[48:63]
    s_barrier
    ds_read_b64_tr_b16 v[24:25], v1 offset:49152
    ds_read_b64_tr_b16 v[26:27], v1 offset:49664
    s_waitcnt lgkmcnt(4)
    v_mfma_f32_32x32x16_bf16 v[48:63], v[28:31], v[200:203], v[48:63]
    ds_read_b64_tr_b16 v[28:29], v1 offset:51200
    ds_read_b64_tr_b16 v[30:31], v1 offset:51712
    v_or_b32_e64 v21, v21, v16
    s_waitcnt lgkmcnt(4)
    v_mfma_f32_32x32x16_bf16 v[48:63], v[32:35], v[204:207], v[48:63]
    ds_read_b64_tr_b16 v[32:33], v1 offset:53248
    ds_read_b64_tr_b16 v[34:35], v1 offset:53760
    v_cndmask_b32 v22, 0, v18, s[68:69]
    s_waitcnt lgkmcnt(4)
    v_mfma_f32_32x32x16_bf16 v[48:63], v[24:27], v[208:211], v[48:63]
    ds_read_b64_tr_b16 v[24:25], v1 offset:55296
    ds_read_b64_tr_b16 v[26:27], v1 offset:55808
    v_cndmask_b32 v16, 0, v17, s[70:71]
    s_waitcnt lgkmcnt(4)
    v_mfma_f32_32x32x16_bf16 v[48:63], v[28:31], v[212:215], v[48:63]
    s_barrier
    ds_read_b64_tr_b16 v[28:29], v1 offset:8192
    ds_read_b64_tr_b16 v[30:31], v1 offset:8704
    s_waitcnt lgkmcnt(4)
    v_mfma_f32_32x32x16_bf16 v[48:63], v[32:35], v[216:219], v[48:63]
    ds_read_b64_tr_b16 v[32:33], v1 offset:10240
    ds_read_b64_tr_b16 v[34:35], v1 offset:10752
    v_or_b32 v22, v22, v16
    s_waitcnt lgkmcnt(4)
    v_mfma_f32_32x32x16_bf16 v[48:63], v[24:27], v[220:223], v[48:63]
    ds_read_b64_tr_b16 v[24:25], v1 offset:12288
    ds_read_b64_tr_b16 v[26:27], v1 offset:12800
    v_cndmask_b32 v23, 0, v18, s[72:73]
    s_waitcnt lgkmcnt(4)
    v_mfma_f32_32x32x16_bf16 v[48:63], v[28:31], v[224:227], v[48:63]
    ds_read_b64_tr_b16 v[28:29], v1 offset:14336
    ds_read_b64_tr_b16 v[30:31], v1 offset:14848
    s_waitcnt lgkmcnt(4)
    v_mfma_f32_32x32x16_bf16 v[48:63], v[32:35], v[228:231], v[48:63]
    s_waitcnt vmcnt(0)
    s_barrier
    ds_read_b64_tr_b16 v[32:33], v1 offset:57344
    ds_read_b64_tr_b16 v[34:35], v1 offset:57856
    v_cndmask_b32 v16, 0, v17, s[74:75]
    s_waitcnt lgkmcnt(4)
    v_mfma_f32_32x32x16_bf16 v[48:63], v[24:27], v[232:235], v[48:63]
    ds_read_b64_tr_b16 v[24:25], v1 offset:59392
    ds_read_b64_tr_b16 v[26:27], v1 offset:59904
    v_or_b32_e64 v23, v23, v16
    s_waitcnt lgkmcnt(4)
    v_mfma_f32_32x32x16_bf16 v[48:63], v[28:31], v[236:239], v[48:63]
    ds_read_b64_tr_b16 v[28:29], v1 offset:61440
    ds_read_b64_tr_b16 v[30:31], v1 offset:61952
    s_waitcnt lgkmcnt(4)
    v_mfma_f32_32x32x16_bf16 v[48:63], v[32:35], v[240:243], v[48:63]
    ds_read_b64_tr_b16 v[32:33], v1 offset:63488
    ds_read_b64_tr_b16 v[34:35], v1 offset:64000
    s_waitcnt lgkmcnt(4)
    v_mfma_f32_32x32x16_bf16 v[48:63], v[24:27], v[244:247], v[48:63]
    s_barrier
    ds_read_b128 v[36:39], v5 offset:32768
    ds_read_b64_tr_b16 v[24:25], v4 offset:0
    ds_read_b64_tr_b16 v[26:27], v4 offset:1024
    s_waitcnt lgkmcnt(5)
    v_mfma_f32_32x32x16_bf16 v[48:63], v[28:31], v[248:251], v[48:63]
    ds_read_b128 v[40:43], v5 offset:34816
    ds_read_b64_tr_b16 v[28:29], v4 offset:2048
    ds_read_b64_tr_b16 v[30:31], v4 offset:3072
    s_waitcnt lgkmcnt(6)
    v_mfma_f32_32x32x16_bf16 v[48:63], v[32:35], v[252:255], v[48:63]
    ds_read_b128 v[44:47], v5 offset:36864
    ds_read_b64_tr_b16 v[32:33], v4 offset:4096
    ds_read_b64_tr_b16 v[34:35], v4 offset:5120
    s_waitcnt lgkmcnt(6)
    v_mfma_f32_32x32x16_bf16 v[80:95], v[24:27], v[36:39], v[80:95]
    ds_read_b128 v[36:39], v5 offset:38912
    ds_read_b64_tr_b16 v[24:25], v4 offset:6144
    ds_read_b64_tr_b16 v[26:27], v4 offset:7168
    s_waitcnt lgkmcnt(6)
    v_mfma_f32_32x32x16_bf16 v[80:95], v[28:31], v[40:43], v[80:95]
    s_barrier
    ds_read_b128 v[40:43], v10 offset:8192
    ds_read_b64_tr_b16 v[28:29], v3 offset:16384
    ds_read_b64_tr_b16 v[30:31], v3 offset:17408
    s_waitcnt lgkmcnt(6)
    v_mfma_f32_32x32x16_bf16 v[80:95], v[32:35], v[44:47], v[80:95]
    ds_read_b128 v[44:47], v10 offset:10240
    ds_read_b64_tr_b16 v[32:33], v3 offset:18432
    ds_read_b64_tr_b16 v[34:35], v3 offset:19456
    s_waitcnt lgkmcnt(6)
    v_mfma_f32_32x32x16_bf16 v[80:95], v[24:27], v[36:39], v[80:95]
    ds_read_b128 v[36:39], v10 offset:12288
    ds_read_b64_tr_b16 v[24:25], v3 offset:20480
    ds_read_b64_tr_b16 v[26:27], v3 offset:21504
    v_mul_f32 v48, 0x3eb8aa3b, v48
    v_mul_f32 v49, 0x3eb8aa3b, v49
    s_waitcnt lgkmcnt(6)
    s_nop 0
    v_mfma_f32_32x32x16_bf16 v[80:95], v[28:31], v[40:43], v[80:95]
    ds_read_b128 v[40:43], v10 offset:14336
    ds_read_b64_tr_b16 v[28:29], v3 offset:22528
    ds_read_b64_tr_b16 v[30:31], v3 offset:23552
    v_mul_f32 v50, 0x3eb8aa3b, v50
    v_mul_f32 v51, 0x3eb8aa3b, v51
    s_waitcnt lgkmcnt(6)
    v_mfma_f32_32x32x16_bf16 v[80:95], v[32:35], v[44:47], v[80:95]
    s_barrier
    ds_read_b128 v[44:47], v5 offset:40960
    ds_read_b64_tr_b16 v[32:33], v3 offset:24576
    ds_read_b64_tr_b16 v[34:35], v3 offset:25600
    v_mul_f32 v52, 0x3eb8aa3b, v52
    v_mul_f32 v53, 0x3eb8aa3b, v53
    s_waitcnt lgkmcnt(6)
    s_nop 0
    v_mfma_f32_32x32x16_bf16 v[80:95], v[24:27], v[36:39], v[80:95]
    ds_read_b128 v[36:39], v5 offset:43008
    ds_read_b64_tr_b16 v[24:25], v3 offset:26624
    ds_read_b64_tr_b16 v[26:27], v3 offset:27648
    v_mul_f32 v54, 0x3eb8aa3b, v54
    v_mul_f32 v55, 0x3eb8aa3b, v55
    s_waitcnt lgkmcnt(6)
    s_nop 0
    v_mfma_f32_32x32x16_bf16 v[80:95], v[28:31], v[40:43], v[80:95]
L_pg5:
    s_cbranch_execz L_pr5
    ds_read_b128 v[40:43], v5 offset:45056
    ds_read_b64_tr_b16 v[28:29], v3 offset:28672
    ds_read_b64_tr_b16 v[30:31], v3 offset:29696
    v_mul_f32 v56, 0x3eb8aa3b, v56
    v_mul_f32 v57, 0x3eb8aa3b, v57
    s_waitcnt lgkmcnt(6)
    v_mfma_f32_32x32x16_bf16 v[80:95], v[32:35], v[44:47], v[80:95]
    ds_read_b128 v[44:47], v5 offset:47104
    ds_read_b64_tr_b16 v[32:33], v3 offset:30720
    ds_read_b64_tr_b16 v[34:35], v3 offset:31744
    v_mul_f32 v58, 0x3eb8aa3b, v58
    v_mul_f32 v59, 0x3eb8aa3b, v59
    s_waitcnt lgkmcnt(6)
    v_mfma_f32_32x32x16_bf16 v[80:95], v[24:27], v[36:39], v[80:95]
    s_barrier
    ds_read_b128 v[36:39], v10 offset:16384
    ds_read_b64_tr_b16 v[24:25], v3 offset:0
    ds_read_b64_tr_b16 v[26:27], v3 offset:1024
    v_mul_f32 v60, 0x3eb8aa3b, v60
    v_mul_f32 v61, 0x3eb8aa3b, v61
    s_waitcnt lgkmcnt(6)
    s_nop 0
    v_mfma_f32_32x32x16_bf16 v[80:95], v[28:31], v[40:43], v[80:95]
    ds_read_b128 v[40:43], v10 offset:18432
    ds_read_b64_tr_b16 v[28:29], v3 offset:2048
    ds_read_b64_tr_b16 v[30:31], v3 offset:3072
    v_mul_f32 v62, 0x3eb8aa3b, v62
    v_mul_f32 v63, 0x3eb8aa3b, v63
    s_waitcnt lgkmcnt(6)
    s_nop 0
    v_mfma_f32_32x32x16_bf16 v[80:95], v[32:35], v[44:47], v[80:95]
    ds_read_b128 v[44:47], v10 offset:20480
    ds_read_b64_tr_b16 v[32:33], v3 offset:4096
    ds_read_b64_tr_b16 v[34:35], v3 offset:5120
    v_cvt_pk_bf16_f32 v120, v48, v49
    v_cvt_pk_bf16_f32 v121, v50, v51
    s_waitcnt lgkmcnt(6)
    s_nop 0
    v_mfma_f32_32x32x16_bf16 v[80:95], v[24:27], v[36:39], v[80:95]
    ds_read_b128 v[36:39], v10 offset:22528
    ds_read_b64_tr_b16 v[24:25], v3 offset:6144
    ds_read_b64_tr_b16 v[26:27], v3 offset:7168
    v_cvt_pk_bf16_f32 v122, v52, v53
    v_cvt_pk_bf16_f32 v123, v54, v55
    s_waitcnt lgkmcnt(6)
    v_mfma_f32_32x32x16_bf16 v[80:95], v[28:31], v[40:43], v[80:95]
    s_barrier
    ds_read_b128 v[40:43], v10 offset:24576
    ds_read_b64_tr_b16 v[28:29], v3 offset:49152
    ds_read_b64_tr_b16 v[30:31], v3 offset:50176
    v_cvt_pk_bf16_f32 v124, v56, v57
    v_cvt_pk_bf16_f32 v125, v58, v59
    s_waitcnt lgkmcnt(6)
    s_nop 0
    v_mfma_f32_32x32x16_bf16 v[80:95], v[32:35], v[44:47], v[80:95]
    ds_read_b128 v[44:47], v10 offset:26624
    ds_read_b64_tr_b16 v[32:33], v3 offset:51200
    ds_read_b64_tr_b16 v[34:35], v3 offset:52224
    v_cvt_pk_bf16_f32 v126, v60, v61
    v_cvt_pk_bf16_f32 v127, v62, v63
    s_waitcnt lgkmcnt(6)
    s_nop 0
    v_mfma_f32_32x32x16_bf16 v[80:95], v[24:27], v[36:39], v[80:95]
    ds_read_b128 v[36:39], v10 offset:28672
    ds_read_b64_tr_b16 v[24:25], v3 offset:53248
    ds_read_b64_tr_b16 v[26:27], v3 offset:54272
    v_cndmask_b32 v252, 0, v18, s[76:77]
    v_cndmask_b32 v16, 0, v17, s[78:79]
    s_waitcnt lgkmcnt(6)
    v_mfma_f32_32x32x16_bf16 v[80:95], v[28:31], v[40:43], v[80:95]
    ds_read_b128 v[40:43], v10 offset:30720
    ds_read_b64_tr_b16 v[28:29], v3 offset:55296
    ds_read_b64_tr_b16 v[30:31], v3 offset:56320
    v_or_b32 v252, v252, v16
    s_waitcnt lgkmcnt(6)
    v_mfma_f32_32x32x16_bf16 v[80:95], v[32:35], v[44:47], v[80:95]
    s_barrier
    ds_read_b128 v[44:47], v10 offset:32768
    ds_read_b64_tr_b16 v[32:33], v3 offset:57344
    ds_read_b64_tr_b16 v[34:35], v3 offset:58368
    v_cndmask_b32 v253, 0, v18, s[80:81]
    s_waitcnt lgkmcnt(6)
    v_mfma_f32_32x32x16_bf16 v[80:95], v[24:27], v[36:39], v[80:95]
    ds_read_b128 v[36:39], v10 offset:34816
    ds_read_b64_tr_b16 v[24:25], v3 offset:59392
    ds_read_b64_tr_b16 v[26:27], v3 offset:60416
    v_cndmask_b32 v16, 0, v17, s[82:83]
    s_waitcnt lgkmcnt(6)
    v_mfma_f32_32x32x16_bf16 v[80:95], v[28:31], v[40:43], v[80:95]
    ds_read_b128 v[40:43], v10 offset:36864
    ds_read_b64_tr_b16 v[28:29], v3 offset:61440
    ds_read_b64_tr_b16 v[30:31], v3 offset:62464
    v_or_b32 v253, v253, v16
    s_waitcnt lgkmcnt(6)
    v_mfma_f32_32x32x16_bf16 v[80:95], v[32:35], v[44:47], v[80:95]
    ds_read_b128 v[44:47], v10 offset:38912
    ds_read_b64_tr_b16 v[32:33], v3 offset:63488
    ds_read_b64_tr_b16 v[34:35], v3 offset:64512
    v_cndmask_b32 v254, 0, v18, s[84:85]
    s_waitcnt lgkmcnt(6)
    v_mfma_f32_32x32x16_bf16 v[80:95], v[24:27], v[36:39], v[80:95]
    s_barrier
    ds_read_b128 v[36:39], v10 offset:40960
    ds_read_b64_tr_b16 v[24:25], v4 offset:49152
    ds_read_b64_tr_b16 v[26:27], v4 offset:50176
    v_cndmask_b32 v16, 0, v17, s[86:87]
    s_waitcnt lgkmcnt(6)
    v_mfma_f32_32x32x16_bf16 v[80:95], v[28:31], v[40:43], v[80:95]
    ds_read_b128 v[40:43], v10 offset:43008
    ds_read_b64_tr_b16 v[28:29], v4 offset:51200
    ds_read_b64_tr_b16 v[30:31], v4 offset:52224
    v_or_b32_e64 v254, v254, v16
    s_waitcnt lgkmcnt(6)
    v_mfma_f32_32x32x16_bf16 v[80:95], v[32:35], v[44:47], v[80:95]
    ds_read_b128 v[44:47], v10 offset:45056
    ds_read_b64_tr_b16 v[32:33], v4 offset:53248
    ds_read_b64_tr_b16 v[34:35], v4 offset:54272
    v_cndmask_b32 v255, 0, v18, s[88:89]
    s_waitcnt lgkmcnt(6)
    v_mfma_f32_32x32x16_bf16 v[80:95], v[24:27], v[36:39], v[80:95]
    ds_read_b128 v[36:39], v10 offset:47104
    ds_read_b64_tr_b16 v[24:25], v4 offset:55296
    ds_read_b64_tr_b16 v[26:27], v4 offset:56320
    v_cndmask_b32 v16, 0, v17, s[90:91]
    s_waitcnt lgkmcnt(6)
    v_mfma_f32_32x32x16_bf16 v[80:95], v[28:31], v[40:43], v[80:95]
    s_barrier
    ds_read_b128 v[40:43], v10 offset:57344
    ds_read_b64_tr_b16 v[28:29], v0 offset:0
    ds_read_b64_tr_b16 v[30:31], v0 offset:1024
    v_or_b32_e64 v255, v255, v16
    s_waitcnt lgkmcnt(6)
    v_mfma_f32_32x32x16_bf16 v[80:95], v[32:35], v[44:47], v[80:95]
    ds_read_b128 v[44:47], v10 offset:59392
    ds_read_b64_tr_b16 v[32:33], v0 offset:2048
    ds_read_b64_tr_b16 v[34:35], v0 offset:3072
    v_add_u32 v13, 40960, v7
    s_waitcnt lgkmcnt(6)
    v_mfma_f32_32x32x16_bf16 v[80:95], v[24:27], v[36:39], v[80:95]
    ds_read_b128 v[36:39], v10 offset:61440
    ds_read_b64_tr_b16 v[24:25], v0 offset:4096
    ds_read_b64_tr_b16 v[26:27], v0 offset:5120
    v_mov_b32 v19, 4096
    s_waitcnt lgkmcnt(6)
    v_mfma_f32_32x32x16_bf16 v[80:95], v[28:31], v[40:43], v[80:95]
    ds_read_b128 v[40:43], v10 offset:63488
    ds_read_b64_tr_b16 v[28:29], v0 offset:6144
    ds_read_b64_tr_b16 v[30:31], v0 offset:7168
    v_cndmask_b32 v1, 16, v19, s[54:55]
    s_waitcnt lgkmcnt(6)
    v_mfma_f32_32x32x16_bf16 v[80:95], v[32:35], v[44:47], v[80:95]
    v_mov_b32 v19, 40960
    s_waitcnt lgkmcnt(3)
    v_mfma_f32_32x32x16_bf16 v[80:95], v[24:27], v[36:39], v[80:95]
    v_cndmask_b32 v15, 0, v19, s[54:55]
    s_waitcnt lgkmcnt(0)
    v_mfma_f32_32x32x16_bf16 v[80:95], v[28:31], v[40:43], v[80:95]
    v_add_u32_e64 v15, v15, v8
    s_nop 10
    v_cvt_pk_bf16_f32 v36, v80, v81
    v_cvt_pk_bf16_f32 v37, v82, v83
    v_cvt_pk_bf16_f32 v38, v84, v85
    v_cvt_pk_bf16_f32 v39, v86, v87
    v_cvt_pk_bf16_f32 v40, v88, v89
    v_cvt_pk_bf16_f32 v41, v90, v91
    v_cvt_pk_bf16_f32 v42, v92, v93
    v_cvt_pk_bf16_f32 v43, v94, v95
    buffer_store_dwordx4 v[36:39], v5, s[36:39], s7 offen sc1
    buffer_store_dwordx4 v[40:43], v5, s[36:39], s7 offen offset:2048 sc1
    v_dot2_f32_bf16 v48, v36, v12, 0
    v_dot2_f32_bf16 v49, v36, v36, 0
    v_dot2_f32_bf16 v48, v37, v12, v48
    v_dot2_f32_bf16 v49, v37, v37, v49
    v_dot2_f32_bf16 v48, v38, v12, v48
    v_dot2_f32_bf16 v49, v38, v38, v49
    v_dot2_f32_bf16 v48, v39, v12, v48
    v_dot2_f32_bf16 v49, v39, v39, v49
    v_dot2_f32_bf16 v48, v40, v12, v48
    v_dot2_f32_bf16 v49, v40, v40, v49
    v_dot2_f32_bf16 v48, v41, v12, v48
    v_dot2_f32_bf16 v49, v41, v41, v49
    v_dot2_f32_bf16 v48, v42, v12, v48
    v_dot2_f32_bf16 v49, v42, v42, v49
    v_dot2_f32_bf16 v48, v43, v12, v48
    v_dot2_f32_bf16 v49, v43, v43, v49
    s_nop 1
    v_mov_b32 v50, v48
    v_mov_b32 v51, v49
    s_nop 0
    v_permlane32_swap_b32 v48, v50
    v_permlane32_swap_b32 v49, v51
    v_add_f32 v48, v48, v50
    v_add_f32 v49, v49, v51
    buffer_store_dwordx2 v[48:49], v11, s[36:39], s8 offen sc1
    s_barrier
    v_mov_b32 v18, 0x207
    s_barrier
    ds_read_b128 v[128:131], v7 offset:0
    ds_read_b128 v[160:163], v7 offset:32768
    ds_read_b128 v[132:135], v7 offset:4096
    ds_read_b128 v[136:139], v7 offset:8192
    s_waitcnt lgkmcnt(3)
    v_mfma_f32_32x32x16_bf16 v[64:79], v[128:131], v[120:123], 0
    ds_read_b128 v[164:167], v8
    ds_read_b128 v[168:171], v8 offset:512
    v_mad_u32_u24 v2, v1, 8, v8
    s_waitcnt lgkmcnt(4)
    v_mfma_f32_32x32x16_bf16 v[24:39], v[160:163], v[120:123], 0
    ds_read_b128 v[228:231], v2
    ds_read_b128 v[232:235], v2 offset:512
    s_waitcnt lgkmcnt(5)
    v_mfma_f32_32x32x16_bf16 v[236:251], v[132:135], v[120:123], 0
    ds_read_b128 v[140:143], v7 offset:12288
    ds_read_b128 v[144:147], v7 offset:16384
    s_nop 5
    v_cndmask_b32 v64, v24, v64, s[60:61]
    v_cndmask_b32 v65, v25, v65, s[62:63]
    v_cndmask_b32 v66, v26, v66, s[64:65]
    v_cndmask_b32 v67, v27, v67, s[66:67]
    v_cndmask_b32 v68, v28, v68, s[68:69]
    v_cndmask_b32 v69, v29, v69, s[70:71]
    v_cndmask_b32 v70, v30, v70, s[72:73]
    v_cndmask_b32 v71, v31, v71, s[74:75]
    v_cndmask_b32 v72, v32, v72, s[76:77]
    v_cndmask_b32 v73, v33, v73, s[78:79]
    v_cndmask_b32 v74, v34, v74, s[80:81]
    v_cndmask_b32 v75, v35, v75, s[82:83]
    v_cndmask_b32 v76, v36, v76, s[84:85]
    v_cndmask_b32 v77, v37, v77, s[86:87]
    v_cndmask_b32 v78, v38, v78, s[88:89]
    v_cndmask_b32 v79, v39, v79, s[90:91]
    v_exp_f32 v64, v64
    v_mad_u32_u24 v2, v1, 1, v8
    s_waitcnt lgkmcnt(6)
    v_mfma_f32_32x32x16_bf16 v[96:111], v[136:139], v[120:123], 0
    ds_read_b128 v[172:175], v2
    ds_read_b128 v[176:179], v2 offset:512
    v_exp_f32 v65, v65
    v_exp_f32 v66, v66
    v_exp_f32 v67, v67
    v_exp_f32 v68, v68
    v_exp_f32 v69, v69
    v_exp_f32 v70, v70
    v_exp_f32 v71, v71
    v_exp_f32 v72, v72
    v_exp_f32 v73, v73
    v_exp_f32 v74, v74
    v_exp_f32 v75, v75
    v_exp_f32 v76, v76
    v_exp_f32 v77, v77
    v_exp_f32 v78, v78
    v_exp_f32_e64 v79, v79
    v_cvt_pk_bf16_f32 v64, v64, v65
    v_cvt_pk_bf16_f32 v65, v66, v67
    v_cvt_pk_bf16_f32 v66, v68, v69
    v_cvt_pk_bf16_f32 v67, v70, v71
    v_cvt_pk_bf16_f32 v68, v72, v73
    v_cvt_pk_bf16_f32 v69, v74, v75
    v_cvt_pk_bf16_f32 v70, v76, v77
    v_cvt_pk_bf16_f32 v71, v78, v79
    v_and_b32 v72, v64, v20
    v_and_b32 v73, v65, v21
    v_and_b32 v74, v66, v22
    v_and_b32 v75, v67, v23
    v_and_b32 v76, v68, v252
    v_and_b32 v77, v69, v253
    v_and_b32 v78, v70, v254
    v_and_b32 v79, v71, v255
    v_xor_b32 v64, v64, v72
    v_mad_u32_u24 v2, v1, 2, v8
    s_waitcnt lgkmcnt(6)
    v_mfma_f32_32x32x16_bf16 v[48:63], v[164:167], v[72:75], 0
    ds_read_b128 v[180:183], v2
    ds_read_b128 v[184:187], v2 offset:512
    v_xor_b32 v65, v65, v73
    v_xor_b32 v66, v66, v74
    v_xor_b32 v67, v67, v75
    v_xor_b32 v68, v68, v76
    v_xor_b32 v69, v69, v77
    v_xor_b32 v70, v70, v78
    v_xor_b32 v71, v71, v79
    s_barrier
    v_exp_f32_e64 v236, v236
    v_mfma_f32_32x32x16_bf16 v[48:63], v[168:171], v[76:79], v[48:63]
    ds_read_b128 v[148:151], v7 offset:20480
    ds_read_b128 v[152:155], v7 offset:24576
    v_exp_f32 v237, v237
    v_exp_f32 v238, v238
    v_exp_f32 v239, v239
    v_mad_u32_u24 v2, v1, 3, v8
    s_waitcnt lgkmcnt(8)
    v_mfma_f32_32x32x16_bf16 v[48:63], v[228:231], v[64:67], v[48:63]
    ds_read_b128 v[188:191], v2
    ds_read_b128 v[192:195], v2 offset:512
    v_exp_f32 v240, v240
    v_exp_f32 v241, v241
    v_exp_f32_e64 v242, v242
    v_mad_u32_u24 v2, v1, 4, v8
    v_mfma_f32_32x32x16_bf16 v[48:63], v[232:235], v[68:71], v[48:63]
    ds_read_b128 v[196:199], v2
    ds_read_b128 v[200:203], v2 offset:512
    v_exp_f32 v243, v243
    v_exp_f32 v244, v244
    v_exp_f32 v245, v245
    v_exp_f32 v246, v246
    v_exp_f32 v247, v247
    v_exp_f32 v248, v248
    v_exp_f32 v249, v249
    v_exp_f32 v250, v250
    v_exp_f32_e64 v251, v251
    v_cvt_pk_bf16_f32 v236, v236, v237
    v_cvt_pk_bf16_f32 v237, v238, v239
    v_cvt_pk_bf16_f32 v238, v240, v241
    v_cvt_pk_bf16_f32 v239, v242, v243
    v_cvt_pk_bf16_f32 v240, v244, v245
    v_cvt_pk_bf16_f32 v241, v246, v247
    v_cvt_pk_bf16_f32 v242, v248, v249
    v_cvt_pk_bf16_f32 v243, v250, v251
    s_waitcnt vmcnt(0)
    s_barrier
    v_exp_f32 v96, v96
    s_waitcnt lgkmcnt(8)
    v_mfma_f32_32x32x16_bf16 v[48:63], v[172:175], v[236:239], v[48:63]
    ds_read_b128 v[156:159], v7 offset:28672
    v_exp_f32 v97, v97
    v_exp_f32 v98, v98
    v_exp_f32_e64 v99, v99
    v_mad_u32_u24 v2, v1, 5, v8
    v_mfma_f32_32x32x16_bf16 v[48:63], v[176:179], v[240:243], v[48:63]
    ds_read_b128 v[204:207], v2
    ds_read_b128 v[208:211], v2 offset:512
    v_exp_f32 v100, v100
    v_exp_f32 v101, v101
    v_exp_f32_e64 v102, v102
    v_mad_u32_u24 v2, v1, 6, v8
    v_mfma_f32_32x32x16_bf16 v[236:251], v[140:143], v[120:123], 0
    ds_read_b128 v[212:215], v2
    ds_read_b128 v[216:219], v2 offset:512
    v_exp_f32 v103, v103
    v_exp_f32 v104, v104
    v_exp_f32 v105, v105
    v_exp_f32 v106, v106
    v_exp_f32 v107, v107
    v_exp_f32 v108, v108
    v_exp_f32 v109, v109
    v_exp_f32 v110, v110
    v_exp_f32_e64 v111, v111
    v_cvt_pk_bf16_f32 v96, v96, v97
    v_cvt_pk_bf16_f32 v97, v98, v99
    v_cvt_pk_bf16_f32 v98, v100, v101
    v_cvt_pk_bf16_f32 v99, v102, v103
    v_cvt_pk_bf16_f32 v100, v104, v105
    v_cvt_pk_bf16_f32 v101, v106, v107
    v_cvt_pk_bf16_f32 v102, v108, v109
    v_cvt_pk_bf16_f32 v103, v110, v111
    s_barrier
    v_exp_f32 v236, v236
    v_mad_u32_u24 v2, v1, 7, v8
    s_waitcnt lgkmcnt(11)
    v_mfma_f32_32x32x16_bf16 v[48:63], v[180:183], v[96:99], v[48:63]
    ds_read_b128 v[220:223], v2
    ds_read_b128 v[224:227], v2 offset:512
    v_exp_f32 v237, v237
    v_exp_f32 v238, v238
    v_exp_f32 v239, v239
    v_mfma_f32_32x32x16_bf16 v[48:63], v[184:187], v[100:103], v[48:63]
    v_exp_f32 v240, v240
    v_exp_f32 v241, v241
    v_exp_f32 v242, v242
    v_mfma_f32_32x32x16_bf16 v[96:111], v[144:147], v[120:123], 0
    v_exp_f32 v243, v243
    v_exp_f32 v244, v244
    v_exp_f32 v245, v245
    v_exp_f32 v246, v246
    v_exp_f32 v247, v247
    v_exp_f32 v248, v248
    v_exp_f32 v249, v249
    v_exp_f32 v250, v250
    v_exp_f32 v251, v251
    v_cvt_pk_bf16_f32 v236, v236, v237
    v_cvt_pk_bf16_f32 v237, v238, v239
    v_cvt_pk_bf16_f32 v238, v240, v241
    v_cvt_pk_bf16_f32 v239, v242, v243
    v_cvt_pk_bf16_f32 v240, v244, v245
    v_cvt_pk_bf16_f32 v241, v246, v247
    v_cvt_pk_bf16_f32 v242, v248, v249
    v_cvt_pk_bf16_f32 v243, v250, v251
    s_waitcnt lgkmcnt(0)
    s_barrier
    v_exp_f32_e64 v96, v96
    v_mfma_f32_32x32x16_bf16 v[48:63], v[188:191], v[236:239], v[48:63]
    ds_read_b128 v[128:131], v13 offset:0
    ds_read_b128 v[160:163], v13 offset:32768
    v_exp_f32 v97, v97
    v_exp_f32 v98, v98
    v_exp_f32_e64 v99, v99
    v_mfma_f32_32x32x16_bf16 v[48:63], v[192:195], v[240:243], v[48:63]
    ds_read_b128 v[132:135], v13 offset:4096
    ds_read_b128 v[136:139], v13 offset:8192
    v_exp_f32 v100, v100
    v_exp_f32 v101, v101
    v_exp_f32_e64 v102, v102
    v_mfma_f32_32x32x16_bf16 v[236:251], v[148:151], v[120:123], 0
    ds_read_b128 v[140:143], v13 offset:12288
    ds_read_b128 v[144:147], v13 offset:16384
    v_exp_f32 v103, v103
    v_exp_f32 v104, v104
    v_exp_f32 v105, v105
    v_exp_f32 v106, v106
    v_exp_f32 v107, v107
    v_exp_f32 v108, v108
    v_exp_f32 v109, v109
    v_exp_f32 v110, v110
    v_exp_f32_e64 v111, v111
    v_cvt_pk_bf16_f32 v96, v96, v97
    v_cvt_pk_bf16_f32 v97, v98, v99
    v_cvt_pk_bf16_f32 v98, v100, v101
    v_cvt_pk_bf16_f32 v99, v102, v103
    v_cvt_pk_bf16_f32 v100, v104, v105
    v_cvt_pk_bf16_f32 v101, v106, v107
    v_cvt_pk_bf16_f32 v102, v108, v109
    v_cvt_pk_bf16_f32 v103, v110, v111
    s_barrier
    v_exp_f32 v236, v236
    v_mfma_f32_32x32x16_bf16 v[48:63], v[196:199], v[96:99], v[48:63]
    ds_read_b128 v[148:151], v13 offset:20480
    v_exp_f32 v237, v237
    v_exp_f32 v238, v238
    v_exp_f32_e64 v239, v239
    v_mfma_f32_32x32x16_bf16 v[48:63], v[200:203], v[100:103], v[48:63]
    ds_read_b128 v[164:167], v15
    ds_read_b128 v[168:171], v15 offset:512
    v_exp_f32 v240, v240
    v_exp_f32 v241, v241
    v_exp_f32_e64 v242, v242
    v_mad_u32_u24 v2, v1, 8, v15
    v_mfma_f32_32x32x16_bf16 v[96:111], v[152:155], v[120:123], 0
    ds_read_b128 v[228:231], v2
    ds_read_b128 v[232:235], v2 offset:512
    v_exp_f32 v243, v243
    v_exp_f32 v244, v244
    v_exp_f32 v245, v245
    v_exp_f32 v246, v246
    v_exp_f32 v247, v247
    v_exp_f32 v248, v248
    v_exp_f32 v249, v249
    v_exp_f32 v250, v250
    v_exp_f32_e64 v251, v251
    v_cvt_pk_bf16_f32 v236, v236, v237
    v_cvt_pk_bf16_f32 v237, v238, v239
    v_cvt_pk_bf16_f32 v238, v240, v241
    v_cvt_pk_bf16_f32 v239, v242, v243
    v_cvt_pk_bf16_f32 v240, v244, v245
    v_cvt_pk_bf16_f32 v241, v246, v247
    v_cvt_pk_bf16_f32 v242, v248, v249
    v_cvt_pk_bf16_f32 v243, v250, v251
    s_barrier
    v_exp_f32 v96, v96
    v_mfma_f32_32x32x16_bf16 v[48:63], v[204:207], v[236:239], v[48:63]
    ds_read_b128 v[152:155], v13 offset:24576
    v_exp_f32 v97, v97
    v_exp_f32 v98, v98
    v_exp_f32_e64 v99, v99
    v_mad_u32_u24 v2, v1, 1, v15
    v_mfma_f32_32x32x16_bf16 v[48:63], v[208:211], v[240:243], v[48:63]
    ds_read_b128 v[172:175], v2
    ds_read_b128 v[176:179], v2 offset:512
    v_exp_f32 v100, v100
    v_exp_f32 v101, v101
    v_exp_f32_e64 v102, v102
    v_mad_u32_u24 v2, v1, 2, v15
    v_mfma_f32_32x32x16_bf16 v[236:251], v[156:159], v[120:123], 0
    ds_read_b128 v[180:183], v2
    ds_read_b128 v[184:187], v2 offset:512
    v_exp_f32 v103, v103
    v_exp_f32 v104, v104
    v_exp_f32 v105, v105
    v_exp_f32 v106, v106
    v_exp_f32 v107, v107
    v_exp_f32 v108, v108
    v_exp_f32 v109, v109
    v_exp_f32 v110, v110
    v_exp_f32_e64 v111, v111
    v_cvt_pk_bf16_f32 v96, v96, v97
    v_cvt_pk_bf16_f32 v97, v98, v99
    v_cvt_pk_bf16_f32 v98, v100, v101
    v_cvt_pk_bf16_f32 v99, v102, v103
    v_cvt_pk_bf16_f32 v100, v104, v105
    v_cvt_pk_bf16_f32 v101, v106, v107
    v_cvt_pk_bf16_f32 v102, v108, v109
    v_cvt_pk_bf16_f32 v103, v110, v111
    s_barrier
    v_exp_f32 v236, v236
    v_mfma_f32_32x32x16_bf16 v[48:63], v[212:215], v[96:99], v[48:63]
    ds_read_b128 v[156:159], v13 offset:28672
    v_exp_f32 v237, v237
    v_exp_f32 v238, v238
    v_exp_f32_e64 v239, v239
    v_mad_u32_u24 v2, v1, 3, v15
    v_mfma_f32_32x32x16_bf16 v[48:63], v[216:219], v[100:103], v[48:63]
    ds_read_b128 v[188:191], v2
    ds_read_b128 v[192:195], v2 offset:512
    v_exp_f32 v240, v240
    v_exp_f32 v241, v241
    v_exp_f32 v242, v242
    v_mad_u32_u24 v2, v1, 4, v15
    s_waitcnt lgkmcnt(14)
    v_mfma_f32_32x32x16_bf16 v[64:79], v[128:131], v[124:127], 0
    ds_read_b128 v[196:199], v2
    ds_read_b128 v[200:203], v2 offset:512
    v_exp_f32 v243, v243
    v_exp_f32 v244, v244
    v_exp_f32_e64 v245, v245
    v_mad_u32_u24 v2, v1, 5, v15
    v_mfma_f32_32x32x16_bf16 v[24:39], v[160:163], v[124:127], 0
    ds_read_b128 v[204:207], v2
    ds_read_b128 v[208:211], v2 offset:512
    v_exp_f32 v246, v246
    v_exp_f32 v247, v247
    v_exp_f32 v248, v248
    v_exp_f32 v249, v249
    v_exp_f32 v250, v250
    v_exp_f32 v251, v251
    v_cvt_pk_bf16_f32 v236, v236, v237
    v_cvt_pk_bf16_f32 v237, v238, v239
    v_cvt_pk_bf16_f32 v238, v240, v241
    v_cvt_pk_bf16_f32 v239, v242, v243
    v_cvt_pk_bf16_f32 v240, v244, v245
    v_cvt_pk_bf16_f32 v241, v246, v247
    v_cvt_pk_bf16_f32 v242, v248, v249
    v_cvt_pk_bf16_f32 v243, v250, v251
    v_cndmask_b32 v64, v24, v64, s[60:61]
    v_mad_u32_u24 v2, v1, 6, v15
    v_mfma_f32_32x32x16_bf16 v[48:63], v[220:223], v[236:239], v[48:63]
    ds_read_b128 v[212:215], v2
    ds_read_b128 v[216:219], v2 offset:512
    v_cndmask_b32 v65, v25, v65, s[62:63]
    v_cndmask_b32 v66, v26, v66, s[64:65]
    v_cndmask_b32 v67, v27, v67, s[66:67]
    v_cndmask_b32 v68, v28, v68, s[68:69]
    v_cndmask_b32 v69, v29, v69, s[70:71]
    v_cndmask_b32 v70, v30, v70, s[72:73]
    v_mfma_f32_32x32x16_bf16 v[48:63], v[224:227], v[240:243], v[48:63]
    v_cndmask_b32 v71, v31, v71, s[74:75]
    v_cndmask_b32 v72, v32, v72, s[76:77]
    v_cndmask_b32 v73, v33, v73, s[78:79]
    v_cndmask_b32 v74, v34, v74, s[80:81]
    v_cndmask_b32 v75, v35, v75, s[82:83]
    v_cndmask_b32 v76, v36, v76, s[84:85]
    v_mad_u32_u24 v2, v1, 7, v15
    v_mfma_f32_32x32x16_bf16 v[236:251], v[132:135], v[124:127], 0
    ds_read_b128 v[220:223], v2
    ds_read_b128 v[224:227], v2 offset:512
    v_cndmask_b32 v77, v37, v77, s[86:87]
    v_cndmask_b32 v78, v38, v78, s[88:89]
    v_cndmask_b32 v79, v39, v79, s[90:91]
    v_exp_f32 v64, v64
    v_exp_f32 v65, v65
    v_mfma_f32_32x32x16_bf16 v[96:111], v[136:139], v[124:127], 0
    v_exp_f32 v66, v66
    v_exp_f32 v67, v67
    v_exp_f32 v68, v68
    v_exp_f32 v69, v69
    v_exp_f32 v70, v70
    v_exp_f32 v71, v71
    v_exp_f32 v72, v72
    v_exp_f32 v73, v73
    v_exp_f32 v74, v74
    v_exp_f32 v75, v75
    v_exp_f32 v76, v76
    v_exp_f32 v77, v77
    v_exp_f32 v78, v78
    v_exp_f32 v79, v79
    v_rcp_f32 v57, v56
    v_subrev_u32 v58, 528482304, v56
    v_lshrrev_b32 v58, 30, v58
    v_cmp_ne_u32 s[96:97], 0, v58
    v_mul_f32 v48, v48, v57
    v_mul_f32 v49, v49, v57
    v_mul_f32 v50, v50, v57
    v_mul_f32 v51, v51, v57
    v_mul_f32 v52, v52, v57
    v_mul_f32 v53, v53, v57
    v_mul_f32 v54, v54, v57
    v_mul_f32 v55, v55, v57
    v_cvt_pk_bf16_f32 v112, v48, v49
    v_cvt_pk_bf16_f32 v113, v50, v51
    v_cvt_pk_bf16_f32 v114, v52, v53
    v_cvt_pk_bf16_f32 v115, v54, v55
    v_add_f32_e64 v59, |v48|, |v49|
    v_add_f32_e64 v59, v59, |v50|
    v_add_f32_e64 v59, v59, |v51|
    v_add_f32_e64 v59, v59, |v52|
    v_add_f32_e64 v59, v59, |v53|
    v_add_f32_e64 v59, v59, |v54|
    v_add_f32_e64 v59, v59, |v55|
    v_cmp_class_f32 vcc, v59, v18
    s_nop 0
    s_or_b64 s[96:97], s[96:97], vcc
    s_nop 0
    v_cvt_pk_bf16_f32 v64, v64, v65
    v_cvt_pk_bf16_f32 v65, v66, v67
    v_cvt_pk_bf16_f32 v66, v68, v69
    v_cvt_pk_bf16_f32 v67, v70, v71
    v_cvt_pk_bf16_f32 v68, v72, v73
    v_cvt_pk_bf16_f32 v69, v74, v75
    v_cvt_pk_bf16_f32 v70, v76, v77
    v_cvt_pk_bf16_f32 v71, v78, v79
    v_and_b32 v72, v64, v20
    v_and_b32 v73, v65, v21
    v_and_b32 v74, v66, v22
    v_and_b32 v75, v67, v23
    v_and_b32 v76, v68, v252
    v_and_b32 v77, v69, v253
    v_and_b32 v78, v70, v254
    v_and_b32 v79, v71, v255
    v_xor_b32 v64, v64, v72
    s_waitcnt lgkmcnt(14)
    v_mfma_f32_32x32x16_bf16 v[48:63], v[164:167], v[72:75], 0
    v_xor_b32 v65, v65, v73
    v_xor_b32 v66, v66, v74
    v_xor_b32 v67, v67, v75
    v_xor_b32 v68, v68, v76
    v_xor_b32 v69, v69, v77
    v_xor_b32 v70, v70, v78
    v_xor_b32 v71, v71, v79
    s_waitcnt lgkmcnt(0)
    s_barrier
    v_exp_f32 v236, v236
    v_mfma_f32_32x32x16_bf16 v[48:63], v[168:171], v[76:79], v[48:63]
    v_exp_f32 v237, v237
    v_exp_f32 v238, v238
    v_exp_f32 v239, v239
    v_mfma_f32_32x32x16_bf16 v[48:63], v[228:231], v[64:67], v[48:63]
L_pg6:
    s_cbranch_execz L_pr6
    v_exp_f32 v240, v240
    v_exp_f32 v241, v241
    v_exp_f32 v242, v242
    v_mfma_f32_32x32x16_bf16 v[48:63], v[232:235], v[68:71], v[48:63]
    v_exp_f32 v243, v243
    v_exp_f32 v244, v244
    v_exp_f32 v245, v245
    v_exp_f32 v246, v246
    v_exp_f32 v247, v247
    v_exp_f32 v248, v248
    v_exp_f32 v249, v249
    v_exp_f32 v250, v250
    v_exp_f32 v251, v251
    v_cvt_pk_bf16_f32 v236, v236, v237
    v_cvt_pk_bf16_f32 v237, v238, v239
    v_cvt_pk_bf16_f32 v238, v240, v241
    v_cvt_pk_bf16_f32 v239, v242, v243
    v_cvt_pk_bf16_f32 v240, v244, v245
    v_cvt_pk_bf16_f32 v241, v246, v247
    v_cvt_pk_bf16_f32 v242, v248, v249
    v_cvt_pk_bf16_f32 v243, v250, v251
    s_barrier
    v_exp_f32 v96, v96
    v_mfma_f32_32x32x16_bf16 v[48:63], v[172:175], v[236:239], v[48:63]
    v_exp_f32 v97, v97
    v_exp_f32 v98, v98
    v_exp_f32 v99, v99
    v_mfma_f32_32x32x16_bf16 v[48:63], v[176:179], v[240:243], v[48:63]
    v_exp_f32 v100, v100
    v_exp_f32 v101, v101
    v_exp_f32 v102, v102
    v_mfma_f32_32x32x16_bf16 v[236:251], v[140:143], v[124:127], 0
    v_exp_f32 v103, v103
    v_exp_f32 v104, v104
    v_exp_f32 v105, v105
    v_exp_f32 v106, v106
    v_exp_f32 v107, v107
    v_exp_f32 v108, v108
    v_exp_f32 v109, v109
    v_exp_f32 v110, v110
    v_exp_f32_e64 v111, v111
    v_cvt_pk_bf16_f32 v96, v96, v97
    v_cvt_pk_bf16_f32 v97, v98, v99
    v_cvt_pk_bf16_f32 v98, v100, v101
    v_cvt_pk_bf16_f32 v99, v102, v103
    v_cvt_pk_bf16_f32 v100, v104, v105
    v_cvt_pk_bf16_f32 v101, v106, v107
    v_cvt_pk_bf16_f32 v102, v108, v109
    v_cvt_pk_bf16_f32 v103, v110, v111
    s_barrier
    v_exp_f32 v236, v236
    v_mfma_f32_32x32x16_bf16 v[48:63], v[180:183], v[96:99], v[48:63]
    v_exp_f32 v237, v237
    v_exp_f32 v238, v238
    v_exp_f32 v239, v239
    v_mfma_f32_32x32x16_bf16 v[48:63], v[184:187], v[100:103], v[48:63]
    v_exp_f32 v240, v240
    v_exp_f32 v241, v241
    v_exp_f32 v242, v242
    v_mfma_f32_32x32x16_bf16 v[96:111], v[144:147], v[124:127], 0
    v_exp_f32 v243, v243
    v_exp_f32 v244, v244
    v_exp_f32 v245, v245
    v_exp_f32 v246, v246
    v_exp_f32 v247, v247
    v_exp_f32 v248, v248
    v_exp_f32 v249, v249
    v_exp_f32 v250, v250
    v_exp_f32_e64 v251, v251
    v_cvt_pk_bf16_f32 v236, v236, v237
    v_cvt_pk_bf16_f32 v237, v238, v239
    v_cvt_pk_bf16_f32 v238, v240, v241
    v_cvt_pk_bf16_f32 v239, v242, v243
    v_cvt_pk_bf16_f32 v240, v244, v245
    v_cvt_pk_bf16_f32 v241, v246, v247
    v_cvt_pk_bf16_f32 v242, v248, v249
    v_cvt_pk_bf16_f32 v243, v250, v251
    s_barrier
    v_exp_f32 v96, v96
    v_mfma_f32_32x32x16_bf16 v[48:63], v[188:191], v[236:239], v[48:63]
    v_exp_f32 v97, v97
    v_exp_f32 v98, v98
    v_exp_f32 v99, v99
    v_mfma_f32_32x32x16_bf16 v[48:63], v[192:195], v[240:243], v[48:63]
    v_exp_f32 v100, v100
    v_exp_f32 v101, v101
    v_exp_f32 v102, v102
    v_mfma_f32_32x32x16_bf16 v[236:251], v[148:151], v[124:127], 0
    v_exp_f32 v103, v103
    v_exp_f32 v104, v104
    v_exp_f32 v105, v105
    v_exp_f32 v106, v106
    v_exp_f32 v107, v107
    v_exp_f32 v108, v108
    v_exp_f32 v109, v109
    v_exp_f32 v110, v110
    v_exp_f32_e64 v111, v111
    v_cvt_pk_bf16_f32 v96, v96, v97
    v_cvt_pk_bf16_f32 v97, v98, v99
    v_cvt_pk_bf16_f32 v98, v100, v101
    v_cvt_pk_bf16_f32 v99, v102, v103
    v_cvt_pk_bf16_f32 v100, v104, v105
    v_cvt_pk_bf16_f32 v101, v106, v107
    v_cvt_pk_bf16_f32 v102, v108, v109
    v_cvt_pk_bf16_f32 v103, v110, v111
    s_barrier
    v_exp_f32 v236, v236
    v_mfma_f32_32x32x16_bf16 v[48:63], v[196:199], v[96:99], v[48:63]
    v_exp_f32 v237, v237
    v_exp_f32 v238, v238
    v_exp_f32 v239, v239
    v_mfma_f32_32x32x16_bf16 v[48:63], v[200:203], v[100:103], v[48:63]
    v_exp_f32 v240, v240
    v_exp_f32 v241, v241
    v_exp_f32 v242, v242
    v_mfma_f32_32x32x16_bf16 v[96:111], v[152:155], v[124:127], 0
    v_exp_f32 v243, v243
    v_exp_f32 v244, v244
    v_exp_f32 v245, v245
    v_exp_f32 v246, v246
    v_exp_f32 v247, v247
    v_exp_f32 v248, v248
    v_exp_f32 v249, v249
    v_exp_f32 v250, v250
    v_exp_f32_e64 v251, v251
    v_cvt_pk_bf16_f32 v236, v236, v237
    v_cvt_pk_bf16_f32 v237, v238, v239
    v_cvt_pk_bf16_f32 v238, v240, v241
    v_cvt_pk_bf16_f32 v239, v242, v243
    v_cvt_pk_bf16_f32 v240, v244, v245
    v_cvt_pk_bf16_f32 v241, v246, v247
    v_cvt_pk_bf16_f32 v242, v248, v249
    v_cvt_pk_bf16_f32 v243, v250, v251
    s_barrier
    v_exp_f32 v96, v96
    v_mfma_f32_32x32x16_bf16 v[48:63], v[204:207], v[236:239], v[48:63]
    v_exp_f32 v97, v97
    v_exp_f32 v98, v98
    v_exp_f32 v99, v99
    v_mfma_f32_32x32x16_bf16 v[48:63], v[208:211], v[240:243], v[48:63]
    v_exp_f32 v100, v100
    v_exp_f32 v101, v101
    v_exp_f32 v102, v102
    v_mfma_f32_32x32x16_bf16 v[236:251], v[156:159], v[124:127], 0
    v_exp_f32 v103, v103
    v_exp_f32 v104, v104
    v_exp_f32 v105, v105
    v_exp_f32 v106, v106
    v_exp_f32 v107, v107
    v_exp_f32 v108, v108
    v_exp_f32 v109, v109
    v_exp_f32 v110, v110
    v_exp_f32_e64 v111, v111
    v_cvt_pk_bf16_f32 v96, v96, v97
    v_cvt_pk_bf16_f32 v97, v98, v99
    v_cvt_pk_bf16_f32 v98, v100, v101
    v_cvt_pk_bf16_f32 v99, v102, v103
    v_cvt_pk_bf16_f32 v100, v104, v105
    v_cvt_pk_bf16_f32 v101, v106, v107
    v_cvt_pk_bf16_f32 v102, v108, v109
    v_cvt_pk_bf16_f32 v103, v110, v111
    s_barrier
    v_exp_f32 v236, v236
    v_mfma_f32_32x32x16_bf16 v[48:63], v[212:215], v[96:99], v[48:63]
    v_exp_f32 v237, v237
    v_exp_f32 v238, v238
    v_exp_f32 v239, v239
    v_mfma_f32_32x32x16_bf16 v[48:63], v[216:219], v[100:103], v[48:63]
    v_exp_f32 v240, v240
    v_exp_f32 v241, v241
    v_exp_f32 v242, v242
    v_exp_f32 v243, v243
    v_exp_f32 v244, v244
    v_exp_f32 v245, v245
    v_exp_f32 v246, v246
    v_exp_f32 v247, v247
    v_exp_f32 v248, v248
    v_exp_f32 v249, v249
    v_exp_f32 v250, v250
    v_exp_f32_e64 v251, v251
    v_cvt_pk_bf16_f32 v236, v236, v237
    v_cvt_pk_bf16_f32 v237, v238, v239
    v_cvt_pk_bf16_f32 v238, v240, v241
    v_cvt_pk_bf16_f32 v239, v242, v243
    v_cvt_pk_bf16_f32 v240, v244, v245
    v_cvt_pk_bf16_f32 v241, v246, v247
    v_cvt_pk_bf16_f32 v242, v248, v249
    v_cvt_pk_bf16_f32 v243, v250, v251
    v_mfma_f32_32x32x16_bf16 v[48:63], v[220:223], v[236:239], v[48:63]
    s_nop 0
    v_mfma_f32_32x32x16_bf16 v[48:63], v[224:227], v[240:243], v[48:63]
    v_lshrrev_b32 v12, 10, v5
    v_lshl_add_u32 v11, v12, 12, v11
    v_add_u32 v11, 40960, v11
    s_nop 8
    v_rcp_f32 v57, v56
    v_subrev_u32 v58, 528482304, v56
    v_lshrrev_b32 v58, 30, v58
    v_cmp_ne_u32 s[98:99], 0, v58
    v_mul_f32 v48, v48, v57
    v_mul_f32 v49, v49, v57
    v_mul_f32 v50, v50, v57
    v_mul_f32 v51, v51, v57
    v_mul_f32 v52, v52, v57
    v_mul_f32 v53, v53, v57
    v_mul_f32 v54, v54, v57
    v_mul_f32_e64 v55, v55, v57
    v_cvt_pk_bf16_f32 v116, v48, v49
    v_cvt_pk_bf16_f32 v117, v50, v51
    v_cvt_pk_bf16_f32 v118, v52, v53
    v_cvt_pk_bf16_f32 v119, v54, v55
    buffer_store_dwordx4 v[112:115], v5, s[36:39], s9 offen sc1
    buffer_store_dwordx4 v[116:119], v5, s[36:39], s9 offen offset:2048 sc1
    v_add_f32_e64 v59, |v48|, |v49|
    v_add_f32_e64 v59, v59, |v50|
    v_add_f32_e64 v59, v59, |v51|
    v_add_f32_e64 v59, v59, |v52|
    v_add_f32_e64 v59, v59, |v53|
    v_add_f32_e64 v59, v59, |v54|
    v_add_f32_e64 v59, v59, |v55|
    v_cmp_class_f32 vcc, v59, v18
    s_nop 0
    s_or_b64 s[98:99], s[98:99], vcc
    s_or_b64 vcc, s[96:97], s[98:99]
    s_cbranch_scc1 L_fb
L_fb_done:
    v_and_b32 v120, 511, v5
    v_lshrrev_b32 v120, 2, v120
    v_lshl_add_u32 v120, v12, 10, v120
    s_lshl_b32 s47, s59, 7
    s_add_u32 s47, s47, 155648
    v_add_u32 v120, s47, v120
    v_add_u32 v121, 2048, v120
    v_add_u32 v122, 4096, v120
    s_barrier
    s_nop 0
    ds_read_b128 v[128:131], v5 offset:49152
    ds_read_b64_tr_b16 v[24:25], v4 offset:16384
    ds_read_b64_tr_b16 v[26:27], v4 offset:17408
    ds_read_b128 v[132:135], v5 offset:51200
    ds_read_b64_tr_b16 v[28:29], v4 offset:18432
    ds_read_b64_tr_b16 v[30:31], v4 offset:19456
    ds_read_b128 v[136:139], v5 offset:53248
    ds_read_b64_tr_b16 v[32:33], v4 offset:20480
    ds_read_b64_tr_b16 v[34:35], v4 offset:21504
    s_waitcnt lgkmcnt(6)
    s_nop 0
    v_mfma_f32_32x32x16_bf16 v[48:63], v[24:27], v[128:131], 0
    ds_read_b128 v[140:143], v5 offset:55296
    ds_read_b64_tr_b16 v[24:25], v4 offset:22528
    ds_read_b64_tr_b16 v[26:27], v4 offset:23552
    ds_read_b64 v[64:65], v11 offset:0
    ds_read_b64 v[66:67], v11 offset:512
    ds_read_b64 v[68:69], v11 offset:1024
    ds_read_b64 v[70:71], v11 offset:1536
    ds_read_b64 v[72:73], v11 offset:2048
    ds_read_b64 v[74:75], v11 offset:2560
    ds_read_b64 v[76:77], v11 offset:3072
    ds_read_b64 v[78:79], v11 offset:3584
    s_waitcnt lgkmcnt(14)
    v_mfma_f32_32x32x16_bf16 v[48:63], v[28:31], v[132:135], v[48:63]
    s_barrier
    ds_read_b128 v[144:147], v5 offset:57344
    ds_read_b64_tr_b16 v[28:29], v4 offset:32768
    ds_read_b64_tr_b16 v[30:31], v4 offset:33792
    s_waitcnt lgkmcnt(14)
    s_nop 0
    v_mfma_f32_32x32x16_bf16 v[48:63], v[32:35], v[136:139], v[48:63]
    ds_read_b128 v[148:151], v5 offset:59392
    ds_read_b64_tr_b16 v[32:33], v4 offset:34816
    ds_read_b64_tr_b16 v[34:35], v4 offset:35840
    ds_read2_b32 v[36:37], v120 offset0:0 offset1:64
    ds_read2_b32 v[38:39], v120 offset0:128 offset1:192
    ds_read2_b32 v[40:41], v121 offset0:0 offset1:64
    ds_read2_b32 v[42:43], v121 offset0:128 offset1:192
    ds_read2_b32 v[44:45], v122 offset0:0 offset1:64
    ds_read2_b32 v[46:47], v122 offset0:128 offset1:192
    s_waitcnt lgkmcnt(14)
    v_mfma_f32_32x32x16_bf16 v[48:63], v[24:27], v[140:143], v[48:63]
    ds_read_b128 v[152:155], v5 offset:61440
    ds_read_b64_tr_b16 v[24:25], v4 offset:36864
    ds_read_b64_tr_b16 v[26:27], v4 offset:37888
    s_waitcnt lgkmcnt(12)
    v_mfma_f32_32x32x16_bf16 v[48:63], v[28:31], v[144:147], v[48:63]
    ds_read_b128 v[156:159], v5 offset:63488
    ds_read_b64_tr_b16 v[28:29], v4 offset:38912
    ds_read_b64_tr_b16 v[30:31], v4 offset:39936
    s_waitcnt lgkmcnt(6)
    v_add_f32 v64, v64, v66
    v_mfma_f32_32x32x16_bf16 v[48:63], v[32:35], v[148:151], v[48:63]
    s_barrier
    ds_read_b128 v[160:163], v10 offset:0
    ds_read_b64_tr_b16 v[32:33], v3 offset:0
    ds_read_b64_tr_b16 v[34:35], v3 offset:1024
    v_add_f32 v65, v65, v67
    v_add_f32 v64, v64, v68
    s_waitcnt lgkmcnt(6)
    v_mfma_f32_32x32x16_bf16 v[48:63], v[24:27], v[152:155], v[48:63]
    ds_read_b128 v[164:167], v10 offset:2048
    ds_read_b64_tr_b16 v[24:25], v3 offset:2048
    ds_read_b64_tr_b16 v[26:27], v3 offset:3072
    v_add_f32 v65, v65, v69
    v_add_f32_e64 v64, v64, v70
    s_waitcnt lgkmcnt(6)
    v_mfma_f32_32x32x16_bf16 v[48:63], v[28:31], v[156:159], v[48:63]
    ds_read_b128 v[168:171], v10 offset:4096
    ds_read_b64_tr_b16 v[28:29], v3 offset:4096
    ds_read_b64_tr_b16 v[30:31], v3 offset:5120
    v_add_f32 v65, v65, v71
    v_add_f32_e64 v64, v64, v72
    s_waitcnt lgkmcnt(6)
    v_mfma_f32_32x32x16_bf16 v[48:63], v[32:35], v[160:163], v[48:63]
    ds_read_b128 v[172:175], v10 offset:6144
    ds_read_b64_tr_b16 v[32:33], v3 offset:6144
    ds_read_b64_tr_b16 v[34:35], v3 offset:7168
    v_add_f32 v65, v65, v73
    v_add_f32 v64, v64, v74
    s_waitcnt lgkmcnt(6)
    v_mfma_f32_32x32x16_bf16 v[48:63], v[24:27], v[164:167], v[48:63]
    s_barrier
    ds_read_b128 v[176:179], v10 offset:8192
    ds_read_b64_tr_b16 v[24:25], v3 offset:16384
    ds_read_b64_tr_b16 v[26:27], v3 offset:17408
    v_add_f32 v65, v65, v75
    v_add_f32_e64 v64, v64, v76
    s_waitcnt lgkmcnt(6)
    v_mfma_f32_32x32x16_bf16 v[48:63], v[28:31], v[168:171], v[48:63]
    ds_read_b128 v[180:183], v10 offset:10240
    ds_read_b64_tr_b16 v[28:29], v3 offset:18432
    ds_read_b64_tr_b16 v[30:31], v3 offset:19456
    v_add_f32 v65, v65, v77
    v_add_f32_e64 v64, v64, v78
    s_waitcnt lgkmcnt(6)
    v_mfma_f32_32x32x16_bf16 v[48:63], v[32:35], v[172:175], v[48:63]
    ds_read_b128 v[184:187], v10 offset:12288
    ds_read_b64_tr_b16 v[32:33], v3 offset:20480
    ds_read_b64_tr_b16 v[34:35], v3 offset:21504
    v_add_f32 v65, v65, v79
    v_mov_b32_e64 v13, v64
    s_waitcnt lgkmcnt(6)
    v_mfma_f32_32x32x16_bf16 v[48:63], v[24:27], v[176:179], v[48:63]
    ds_read_b128 v[188:191], v10 offset:14336
    ds_read_b64_tr_b16 v[24:25], v3 offset:22528
    ds_read_b64_tr_b16 v[26:27], v3 offset:23552
    v_mov_b32 v15, v65
    v_permlane32_swap_b32 v64, v13
    s_waitcnt lgkmcnt(6)
    v_mfma_f32_32x32x16_bf16 v[48:63], v[28:31], v[180:183], v[48:63]
    s_barrier
    ds_read_b128 v[192:195], v6 offset:0
    ds_read_b64_tr_b16 v[28:29], v3 offset:32768
    ds_read_b64_tr_b16 v[30:31], v3 offset:33792
    v_permlane32_swap_b32 v65, v15
    v_add_f32_e64 v13, v64, v13
    s_waitcnt lgkmcnt(6)
    v_mfma_f32_32x32x16_bf16 v[48:63], v[32:35], v[184:187], v[48:63]
    ds_read_b128 v[196:199], v6 offset:2048
    ds_read_b64_tr_b16 v[32:33], v3 offset:34816
    ds_read_b64_tr_b16 v[34:35], v3 offset:35840
    v_add_f32 v15, v65, v15
    v_mov_b32_e64 v106, 0
    s_waitcnt lgkmcnt(6)
    v_mfma_f32_32x32x16_bf16 v[48:63], v[24:27], v[188:191], v[48:63]
    ds_read_b128 v[200:203], v6 offset:4096
    ds_read_b64_tr_b16 v[24:25], v3 offset:36864
    ds_read_b64_tr_b16 v[26:27], v3 offset:37888
    v_mov_b32 v107, 0
    v_mov_b32_e64 v110, 0
    s_waitcnt lgkmcnt(6)
    v_mfma_f32_32x32x16_bf16 v[48:63], v[28:31], v[192:195], v[48:63]
    ds_read_b128 v[204:207], v6 offset:6144
    ds_read_b64_tr_b16 v[28:29], v3 offset:38912
    ds_read_b64_tr_b16 v[30:31], v3 offset:39936
    v_mov_b32 v111, 0
    s_waitcnt lgkmcnt(6)
    v_mfma_f32_32x32x16_bf16 v[48:63], v[32:35], v[196:199], v[48:63]
    s_barrier
    ds_read_b128 v[208:211], v6 offset:8192
    ds_read_b64_tr_b16 v[32:33], v4 offset:57344
    ds_read_b64_tr_b16 v[34:35], v4 offset:58368
    v_mul_f32 v16, 0xbb000000, v13
    v_mul_f32_e64 v17, v16, v16
    s_waitcnt lgkmcnt(6)
    v_mfma_f32_32x32x16_bf16 v[48:63], v[24:27], v[200:203], v[48:63]
    ds_read_b128 v[212:215], v6 offset:10240
    ds_read_b64_tr_b16 v[24:25], v4 offset:59392
    ds_read_b64_tr_b16 v[26:27], v4 offset:60416
    v_mov_b32 v18, 0x3b000000
    v_fma_f32 v17, v15, v18, -v17
    s_waitcnt lgkmcnt(6)
    v_mfma_f32_32x32x16_bf16 v[48:63], v[28:31], v[204:207], v[48:63]
    ds_read_b128 v[216:219], v6 offset:12288
    ds_read_b64_tr_b16 v[28:29], v4 offset:61440
    ds_read_b64_tr_b16 v[30:31], v4 offset:62464
    v_max_f32 v17, 0, v17
    v_add_f32 v17, 0x3727c5ac, v17
    s_waitcnt lgkmcnt(6)
    v_mfma_f32_32x32x16_bf16 v[48:63], v[32:35], v[208:211], v[48:63]
    ds_read_b128 v[220:223], v6 offset:14336
    ds_read_b64_tr_b16 v[32:33], v4 offset:63488
    ds_read_b64_tr_b16 v[34:35], v4 offset:64512
    v_rsq_f32 v18, v17
    v_cvt_pk_bf16_f32 v104, v16, v16
    s_waitcnt lgkmcnt(6)
    v_mfma_f32_32x32x16_bf16 v[48:63], v[24:27], v[212:215], v[48:63]
    s_waitcnt vmcnt(0)
    s_barrier
    ds_read_b128 v[224:227], v5 offset:40960
    ds_read_b64_tr_b16 v[24:25], v3 offset:49152
    ds_read_b64_tr_b16 v[26:27], v3 offset:50176
    v_mul_f32 v100, v17, v18
    v_mul_f32 v96, 0xc0135761, v18
    s_waitcnt lgkmcnt(6)
    v_mfma_f32_32x32x16_bf16 v[48:63], v[28:31], v[216:219], v[48:63]
    ds_read_b128 v[228:231], v5 offset:43008
    ds_read_b64_tr_b16 v[28:29], v3 offset:51200
    ds_read_b64_tr_b16 v[30:31], v3 offset:52224
    v_mul_f32 v17, v18, v18
    v_mul_f32 v17, 0x3d372713, v17
    s_waitcnt lgkmcnt(6)
    v_mfma_f32_32x32x16_bf16 v[48:63], v[32:35], v[220:223], v[48:63]
    ds_read_b128 v[232:235], v5 offset:45056
    ds_read_b64_tr_b16 v[32:33], v3 offset:53248
    ds_read_b64_tr_b16 v[34:35], v3 offset:54272
    v_mul_f32 v98, v96, v17
    v_lshlrev_b32 v17, 16, v104
    s_waitcnt lgkmcnt(6)
    v_mfma_f32_32x32x16_bf16 v[48:63], v[24:27], v[224:227], v[48:63]
    ds_read_b128 v[236:239], v5 offset:47104
    ds_read_b64_tr_b16 v[24:25], v3 offset:55296
    ds_read_b64_tr_b16 v[26:27], v3 offset:56320
    v_sub_f32 v17, v16, v17
    v_cvt_pk_bf16_f32 v105, v17, v17
    s_waitcnt lgkmcnt(6)
    v_mfma_f32_32x32x16_bf16 v[48:63], v[28:31], v[228:231], v[48:63]
    s_barrier
    ds_read_b128 v[240:243], v5 offset:57344
    ds_read_b64_tr_b16 v[28:29], v4 offset:32768
    ds_read_b64_tr_b16 v[30:31], v4 offset:33792
    v_add_f32 v36, v36, v37
    v_add_f32 v38, v38, v39
    s_waitcnt lgkmcnt(6)
    v_mfma_f32_32x32x16_bf16 v[48:63], v[32:35], v[232:235], v[48:63]
    ds_read_b128 v[244:247], v5 offset:59392
    ds_read_b64_tr_b16 v[32:33], v4 offset:34816
    ds_read_b64_tr_b16 v[34:35], v4 offset:35840
    v_add_f32 v36, v36, v38
    v_cvt_pk_bf16_f32 v37, v36, v36
    s_waitcnt lgkmcnt(6)
    v_mfma_f32_32x32x16_bf16 v[48:63], v[24:27], v[236:239], v[48:63]
    ds_read_b128 v[248:251], v5 offset:61440
    ds_read_b64_tr_b16 v[24:25], v4 offset:36864
    ds_read_b64_tr_b16 v[26:27], v4 offset:37888
    v_lshlrev_b32 v37, 16, v37
    v_sub_f32_e64 v37, v36, v37
    s_waitcnt lgkmcnt(6)
    v_mfma_f32_32x32x16_bf16 v[48:63], v[28:31], v[240:243], v[48:63]
    ds_read_b128 v[252:255], v5 offset:63488
    ds_read_b64_tr_b16 v[28:29], v4 offset:38912
    ds_read_b64_tr_b16 v[30:31], v4 offset:39936
    v_cvt_pk_bf16_f32 v108, v36, v37
    v_mov_b32 v109, v108
    s_waitcnt lgkmcnt(6)
    v_mfma_f32_32x32x16_bf16 v[48:63], v[32:35], v[244:247], v[48:63]
    s_barrier
    ds_read_b64_tr_b16 v[32:33], v4 offset:24576
    ds_read_b64_tr_b16 v[34:35], v4 offset:25600
    v_mfma_f32_32x32x16_bf16 v[48:63], v[108:111], v[104:107], v[48:63]
    s_waitcnt lgkmcnt(5)
    v_mfma_f32_32x32x16_bf16 v[48:63], v[24:27], v[248:251], v[48:63]
    ds_read_b64_tr_b16 v[24:25], v4 offset:26624
    ds_read_b64_tr_b16 v[26:27], v4 offset:27648
    s_waitcnt lgkmcnt(4)
    v_mfma_f32_32x32x16_bf16 v[48:63], v[28:31], v[252:255], v[48:63]
    ds_read_b64_tr_b16 v[28:29], v4 offset:28672
    ds_read_b64_tr_b16 v[30:31], v4 offset:29696
    s_waitcnt lgkmcnt(4)
    v_mfma_f32_32x32x16_bf16 v[64:79], v[32:35], v[128:131], 0
    ds_read_b64_tr_b16 v[32:33], v4 offset:30720
    ds_read_b64_tr_b16 v[34:35], v4 offset:31744
    s_waitcnt lgkmcnt(4)
    v_mfma_f32_32x32x16_bf16 v[64:79], v[24:27], v[132:135], v[64:79]
    s_barrier
    ds_read_b64_tr_b16 v[24:25], v4 offset:40960
    ds_read_b64_tr_b16 v[26:27], v4 offset:41984
    s_waitcnt lgkmcnt(4)
    v_mfma_f32_32x32x16_bf16 v[64:79], v[28:31], v[136:139], v[64:79]
    ds_read_b64_tr_b16 v[28:29], v4 offset:43008
    ds_read_b64_tr_b16 v[30:31], v4 offset:44032
    s_waitcnt lgkmcnt(4)
    v_mfma_f32_32x32x16_bf16 v[64:79], v[32:35], v[140:143], v[64:79]
    ds_read_b64_tr_b16 v[32:33], v4 offset:45056
    ds_read_b64_tr_b16 v[34:35], v4 offset:46080
    v_mul_f32 v16, v48, v48
    v_mul_f32 v17, v49, v49
    v_fma_f32 v16, v16, v98, v96
    v_fma_f32 v17, v17, v98, v96
    v_mul_f32 v16, v16, v48
    v_mul_f32_e64 v17, v17, v49
    s_waitcnt lgkmcnt(4)
    v_mfma_f32_32x32x16_bf16 v[64:79], v[24:27], v[144:147], v[64:79]
    ds_read_b64_tr_b16 v[24:25], v4 offset:47104
    ds_read_b64_tr_b16 v[26:27], v4 offset:48128
    v_exp_f32 v16, v16
    v_exp_f32 v17, v17
    v_fma_f32 v16, v16, v100, v100
    v_fma_f32 v17, v17, v100, v100
    v_rcp_f32 v16, v16
    v_rcp_f32 v17, v17
    s_waitcnt lgkmcnt(4)
    v_mfma_f32_32x32x16_bf16 v[64:79], v[28:31], v[148:151], v[64:79]
    s_barrier
    ds_read_b64_tr_b16 v[28:29], v3 offset:8192
    ds_read_b64_tr_b16 v[30:31], v3 offset:9216
    v_mul_f32 v16, v16, v48
    v_mul_f32 v17, v17, v49
    v_cvt_pk_bf16_f32 v112, v16, v17
    v_mul_f32 v18, v50, v50
    v_mul_f32_e64 v19, v51, v51
    s_waitcnt lgkmcnt(4)
    v_mfma_f32_32x32x16_bf16 v[64:79], v[32:35], v[152:155], v[64:79]
    ds_read_b64_tr_b16 v[32:33], v3 offset:10240
    ds_read_b64_tr_b16 v[34:35], v3 offset:11264
    v_fma_f32 v18, v18, v98, v96
    v_fma_f32 v19, v19, v98, v96
    v_mul_f32 v18, v18, v50
    v_mul_f32 v19, v19, v51
    v_exp_f32 v18, v18
    v_exp_f32_e64 v19, v19
    s_waitcnt lgkmcnt(4)
    v_mfma_f32_32x32x16_bf16 v[64:79], v[24:27], v[156:159], v[64:79]
    ds_read_b64_tr_b16 v[24:25], v3 offset:12288
    ds_read_b64_tr_b16 v[26:27], v3 offset:13312
    v_fma_f32 v18, v18, v100, v100
    v_fma_f32 v19, v19, v100, v100
    v_rcp_f32 v18, v18
    v_rcp_f32 v19, v19
    v_mul_f32 v18, v18, v50
    s_waitcnt lgkmcnt(4)
    v_mfma_f32_32x32x16_bf16 v[64:79], v[28:31], v[160:163], v[64:79]
    ds_read_b64_tr_b16 v[28:29], v3 offset:14336
    ds_read_b64_tr_b16 v[30:31], v3 offset:15360
    v_mul_f32 v19, v19, v51
    v_cvt_pk_bf16_f32 v113, v18, v19
    v_mul_f32 v16, v52, v52
    v_mul_f32_e64 v17, v53, v53
    v_fma_f32 v16, v16, v98, v96
    v_fma_f32 v17, v17, v98, v96
    s_waitcnt lgkmcnt(4)
    v_mfma_f32_32x32x16_bf16 v[64:79], v[32:35], v[164:167], v[64:79]
    s_barrier
    ds_read_b64_tr_b16 v[32:33], v3 offset:24576
    ds_read_b64_tr_b16 v[34:35], v3 offset:25600
    v_mul_f32 v16, v16, v52
    v_mul_f32 v17, v17, v53
    v_exp_f32 v16, v16
    v_exp_f32 v17, v17
    v_fma_f32 v16, v16, v100, v100
    v_fma_f32 v17, v17, v100, v100
    s_waitcnt lgkmcnt(4)
    v_mfma_f32_32x32x16_bf16 v[64:79], v[24:27], v[168:171], v[64:79]
    ds_read_b64_tr_b16 v[24:25], v3 offset:26624
    ds_read_b64_tr_b16 v[26:27], v3 offset:27648
    v_rcp_f32 v16, v16
    v_rcp_f32 v17, v17
    v_mul_f32 v16, v16, v52
    v_mul_f32 v17, v17, v53
    v_cvt_pk_bf16_f32 v114, v16, v17
    s_waitcnt lgkmcnt(4)
    v_mfma_f32_32x32x16_bf16 v[64:79], v[28:31], v[172:175], v[64:79]
    ds_read_b64_tr_b16 v[28:29], v3 offset:28672
    ds_read_b64_tr_b16 v[30:31], v3 offset:29696
    v_mul_f32 v18, v54, v54
    v_mul_f32 v19, v55, v55
    v_fma_f32 v18, v18, v98, v96
    v_fma_f32 v19, v19, v98, v96
    v_mul_f32 v18, v18, v54
    v_mul_f32_e64 v19, v19, v55
    s_waitcnt lgkmcnt(4)
    v_mfma_f32_32x32x16_bf16 v[64:79], v[32:35], v[176:179], v[64:79]
    ds_read_b64_tr_b16 v[32:33], v3 offset:30720
    ds_read_b64_tr_b16 v[34:35], v3 offset:31744
    v_exp_f32 v18, v18
    v_exp_f32 v19, v19
    v_fma_f32 v18, v18, v100, v100
    v_fma_f32 v19, v19, v100, v100
    v_rcp_f32 v18, v18
    s_waitcnt lgkmcnt(4)
    v_mfma_f32_32x32x16_bf16 v[64:79], v[24:27], v[180:183], v[64:79]
    s_barrier
    ds_read_b64_tr_b16 v[24:25], v4 offset:49152
    ds_read_b64_tr_b16 v[26:27], v4 offset:50176
    v_rcp_f32 v19, v19
    v_mul_f32 v18, v18, v54
    v_mul_f32 v19, v19, v55
    v_cvt_pk_bf16_f32 v115, v18, v19
    v_mul_f32 v16, v56, v56
    v_mul_f32_e64 v17, v57, v57
    s_waitcnt lgkmcnt(4)
    v_mfma_f32_32x32x16_bf16 v[64:79], v[28:31], v[184:187], v[64:79]
    ds_read_b64_tr_b16 v[28:29], v4 offset:51200
    ds_read_b64_tr_b16 v[30:31], v4 offset:52224
    v_fma_f32 v16, v16, v98, v96
    v_fma_f32 v17, v17, v98, v96
    v_mul_f32 v16, v16, v56
    v_mul_f32 v17, v17, v57
    v_exp_f32 v16, v16
    v_exp_f32_e64 v17, v17
    s_waitcnt lgkmcnt(4)
    v_mfma_f32_32x32x16_bf16 v[64:79], v[32:35], v[188:191], v[64:79]
    ds_read_b64_tr_b16 v[32:33], v4 offset:53248
    ds_read_b64_tr_b16 v[34:35], v4 offset:54272
    v_fma_f32 v16, v16, v100, v100
    v_fma_f32 v17, v17, v100, v100
    v_rcp_f32 v16, v16
    v_rcp_f32 v17, v17
    v_mul_f32 v16, v16, v56
    s_waitcnt lgkmcnt(4)
    v_mfma_f32_32x32x16_bf16 v[64:79], v[24:27], v[192:195], v[64:79]
    ds_read_b64_tr_b16 v[24:25], v4 offset:55296
    ds_read_b64_tr_b16 v[26:27], v4 offset:56320
    v_mul_f32 v17, v17, v57
    v_cvt_pk_bf16_f32 v116, v16, v17
    v_mul_f32 v18, v58, v58
    v_mul_f32_e64 v19, v59, v59
    v_fma_f32 v18, v18, v98, v96
    v_fma_f32 v19, v19, v98, v96
    s_waitcnt lgkmcnt(4)
    v_mfma_f32_32x32x16_bf16 v[64:79], v[28:31], v[196:199], v[64:79]
    s_barrier
    ds_read_b64_tr_b16 v[28:29], v0 offset:16384
    ds_read_b64_tr_b16 v[30:31], v0 offset:17408
    v_mul_f32 v18, v18, v58
    v_mul_f32 v19, v19, v59
    v_exp_f32 v18, v18
    v_exp_f32 v19, v19
    v_fma_f32 v18, v18, v100, v100
    s_waitcnt lgkmcnt(4)
    v_mfma_f32_32x32x16_bf16 v[64:79], v[32:35], v[200:203], v[64:79]
    ds_read_b64_tr_b16 v[32:33], v0 offset:18432
    ds_read_b64_tr_b16 v[34:35], v0 offset:19456
    v_fma_f32 v19, v19, v100, v100
    v_rcp_f32 v18, v18
    v_rcp_f32 v19, v19
    v_mul_f32 v18, v18, v58
    v_mul_f32 v19, v19, v59
    v_cvt_pk_bf16_f32 v117, v18, v19
    s_waitcnt lgkmcnt(4)
    v_mfma_f32_32x32x16_bf16 v[64:79], v[24:27], v[204:207], v[64:79]
    ds_read_b64_tr_b16 v[24:25], v0 offset:20480
    ds_read_b64_tr_b16 v[26:27], v0 offset:21504
L_pg7:
    s_cbranch_execz L_pr7
    v_mul_f32 v16, v60, v60
    v_mul_f32_e64 v17, v61, v61
    v_fma_f32 v16, v16, v98, v96
    v_fma_f32 v17, v17, v98, v96
    v_mul_f32 v16, v16, v60
    v_mul_f32_e64 v17, v17, v61
    s_waitcnt lgkmcnt(4)
    v_mfma_f32_32x32x16_bf16 v[64:79], v[28:31], v[208:211], v[64:79]
    ds_read_b64_tr_b16 v[28:29], v0 offset:22528
    ds_read_b64_tr_b16 v[30:31], v0 offset:23552
    v_exp_f32 v16, v16
    v_exp_f32 v17, v17
    v_fma_f32 v16, v16, v100, v100
    v_fma_f32 v17, v17, v100, v100
    v_rcp_f32 v16, v16
    s_waitcnt lgkmcnt(4)
    v_mfma_f32_32x32x16_bf16 v[64:79], v[32:35], v[212:215], v[64:79]
    s_barrier
    ds_read_b64_tr_b16 v[32:33], v4 offset:16384
    ds_read_b64_tr_b16 v[34:35], v4 offset:17408
    v_rcp_f32 v17, v17
    v_mul_f32 v16, v16, v60
    v_mul_f32 v17, v17, v61
    v_cvt_pk_bf16_f32 v118, v16, v17
    v_mul_f32 v18, v62, v62
    v_mul_f32_e64 v19, v63, v63
    s_waitcnt lgkmcnt(4)
    v_mfma_f32_32x32x16_bf16 v[64:79], v[24:27], v[216:219], v[64:79]
    ds_read_b64_tr_b16 v[24:25], v4 offset:18432
    ds_read_b64_tr_b16 v[26:27], v4 offset:19456
    v_fma_f32 v18, v18, v98, v96
    v_fma_f32 v19, v19, v98, v96
    v_mul_f32 v18, v18, v62
    v_mul_f32 v19, v19, v63
    v_exp_f32 v18, v18
    s_waitcnt lgkmcnt(4)
    v_mfma_f32_32x32x16_bf16 v[64:79], v[28:31], v[220:223], v[64:79]
    ds_read_b64_tr_b16 v[28:29], v4 offset:20480
    ds_read_b64_tr_b16 v[30:31], v4 offset:21504
    v_exp_f32_e64 v19, v19
    v_fma_f32 v18, v18, v100, v100
    v_fma_f32 v19, v19, v100, v100
    v_rcp_f32 v18, v18
    v_rcp_f32 v19, v19
    v_mul_f32 v18, v18, v62
    s_waitcnt lgkmcnt(4)
    v_mfma_f32_32x32x16_bf16 v[64:79], v[32:35], v[224:227], v[64:79]
    ds_read_b64_tr_b16 v[32:33], v4 offset:22528
    ds_read_b64_tr_b16 v[34:35], v4 offset:23552
    v_mul_f32_e64 v19, v19, v63
    v_cvt_pk_bf16_f32 v119, v18, v19
    buffer_store_dwordx4 v[112:115], v5, s[36:39], s10 offen sc1
    buffer_store_dwordx4 v[116:119], v5, s[36:39], s10 offen offset:2048 sc1
    s_add_u32 s10, s10, 8192
    s_waitcnt lgkmcnt(4)
    v_mfma_f32_32x32x16_bf16 v[64:79], v[24:27], v[228:231], v[64:79]
    s_barrier
    ds_read_b64_tr_b16 v[24:25], v3 offset:0
    ds_read_b64_tr_b16 v[26:27], v3 offset:1024
    s_waitcnt lgkmcnt(4)
    v_mfma_f32_32x32x16_bf16 v[64:79], v[28:31], v[232:235], v[64:79]
    ds_read_b64_tr_b16 v[28:29], v3 offset:2048
    ds_read_b64_tr_b16 v[30:31], v3 offset:3072
    s_waitcnt lgkmcnt(4)
    v_mfma_f32_32x32x16_bf16 v[64:79], v[32:35], v[236:239], v[64:79]
    ds_read_b64_tr_b16 v[32:33], v3 offset:4096
    ds_read_b64_tr_b16 v[34:35], v3 offset:5120
    s_waitcnt lgkmcnt(4)
    v_mfma_f32_32x32x16_bf16 v[64:79], v[24:27], v[240:243], v[64:79]
    ds_read_b64_tr_b16 v[24:25], v3 offset:6144
    ds_read_b64_tr_b16 v[26:27], v3 offset:7168
    v_add_f32 v40, v40, v41
    v_add_f32 v42, v42, v43
    v_add_f32 v40, v40, v42
    s_waitcnt lgkmcnt(4)
    v_mfma_f32_32x32x16_bf16 v[64:79], v[28:31], v[244:247], v[64:79]
    s_barrier
    ds_read_b64_tr_b16 v[28:29], v3 offset:16384
    ds_read_b64_tr_b16 v[30:31], v3 offset:17408
    v_cvt_pk_bf16_f32 v41, v40, v40
    v_lshlrev_b32 v41, 16, v41
    s_waitcnt lgkmcnt(4)
    v_mfma_f32_32x32x16_bf16 v[64:79], v[32:35], v[248:251], v[64:79]
    ds_read_b64_tr_b16 v[32:33], v3 offset:18432
    ds_read_b64_tr_b16 v[34:35], v3 offset:19456
    v_sub_f32 v41, v40, v41
    v_cvt_pk_bf16_f32 v108, v40, v41
    s_waitcnt lgkmcnt(4)
    v_mfma_f32_32x32x16_bf16 v[64:79], v[24:27], v[252:255], v[64:79]
    ds_read_b64_tr_b16 v[24:25], v3 offset:20480
    ds_read_b64_tr_b16 v[26:27], v3 offset:21504
    v_mov_b32 v109, v108
    s_nop 1
    v_mfma_f32_32x32x16_bf16 v[64:79], v[108:111], v[104:107], v[64:79]
    s_waitcnt lgkmcnt(4)
    v_mfma_f32_32x32x16_bf16 v[48:63], v[28:31], v[128:131], 0
    ds_read_b64_tr_b16 v[28:29], v3 offset:22528
    ds_read_b64_tr_b16 v[30:31], v3 offset:23552
    v_add_f32 v44, v44, v45
    v_add_f32 v46, v46, v47
    v_add_f32 v44, v44, v46
    s_waitcnt lgkmcnt(4)
    v_mfma_f32_32x32x16_bf16 v[48:63], v[32:35], v[132:135], v[48:63]
    s_barrier
    ds_read_b64_tr_b16 v[32:33], v3 offset:32768
    ds_read_b64_tr_b16 v[34:35], v3 offset:33792
    v_cvt_pk_bf16_f32 v45, v44, v44
    v_lshlrev_b32 v45, 16, v45
    v_sub_f32_e64 v45, v44, v45
    s_waitcnt lgkmcnt(4)
    v_mfma_f32_32x32x16_bf16 v[48:63], v[24:27], v[136:139], v[48:63]
    ds_read_b64_tr_b16 v[24:25], v3 offset:34816
    ds_read_b64_tr_b16 v[26:27], v3 offset:35840
    v_cvt_pk_bf16_f32 v108, v44, v45
    v_mov_b32 v109, v108
    s_nop 1
    v_mfma_f32_32x32x16_bf16 v[48:63], v[108:111], v[104:107], v[48:63]
    s_waitcnt lgkmcnt(4)
    v_mfma_f32_32x32x16_bf16 v[48:63], v[28:31], v[140:143], v[48:63]
    ds_read_b64_tr_b16 v[28:29], v3 offset:36864
    ds_read_b64_tr_b16 v[30:31], v3 offset:37888
    v_mul_f32 v16, v64, v64
    v_mul_f32_e64 v17, v65, v65
    v_fma_f32 v16, v16, v98, v96
    v_fma_f32 v17, v17, v98, v96
    v_mul_f32 v16, v16, v64
    v_mul_f32_e64 v17, v17, v65
    s_waitcnt lgkmcnt(4)
    v_mfma_f32_32x32x16_bf16 v[48:63], v[32:35], v[144:147], v[48:63]
    ds_read_b64_tr_b16 v[32:33], v3 offset:38912
    ds_read_b64_tr_b16 v[34:35], v3 offset:39936
    v_exp_f32 v16, v16
    v_exp_f32 v17, v17
    v_fma_f32 v16, v16, v100, v100
    v_fma_f32 v17, v17, v100, v100
    v_rcp_f32 v16, v16
    s_waitcnt lgkmcnt(4)
    v_mfma_f32_32x32x16_bf16 v[48:63], v[24:27], v[148:151], v[48:63]
    s_barrier
    ds_read_b64_tr_b16 v[24:25], v3 offset:40960
    ds_read_b64_tr_b16 v[26:27], v3 offset:41984
    v_rcp_f32 v17, v17
    v_mul_f32 v16, v16, v64
    v_mul_f32 v17, v17, v65
    v_cvt_pk_bf16_f32 v112, v16, v17
    v_mul_f32 v18, v66, v66
    s_waitcnt lgkmcnt(4)
    v_mfma_f32_32x32x16_bf16 v[48:63], v[28:31], v[152:155], v[48:63]
    ds_read_b64_tr_b16 v[28:29], v3 offset:43008
    ds_read_b64_tr_b16 v[30:31], v3 offset:44032
    v_mul_f32_e64 v19, v67, v67
    v_fma_f32 v18, v18, v98, v96
    v_fma_f32 v19, v19, v98, v96
    v_mul_f32 v18, v18, v66
    v_mul_f32_e64 v19, v19, v67
    s_waitcnt lgkmcnt(4)
    v_mfma_f32_32x32x16_bf16 v[48:63], v[32:35], v[156:159], v[48:63]
    ds_read_b64_tr_b16 v[32:33], v3 offset:45056
    ds_read_b64_tr_b16 v[34:35], v3 offset:46080
    v_exp_f32 v18, v18
    v_exp_f32 v19, v19
    v_fma_f32 v18, v18, v100, v100
    v_fma_f32 v19, v19, v100, v100
    v_rcp_f32 v18, v18
    s_waitcnt lgkmcnt(4)
    v_mfma_f32_32x32x16_bf16 v[48:63], v[24:27], v[160:163], v[48:63]
    ds_read_b64_tr_b16 v[24:25], v3 offset:47104
    ds_read_b64_tr_b16 v[26:27], v3 offset:48128
    v_rcp_f32 v19, v19
    v_mul_f32 v18, v18, v66
    v_mul_f32 v19, v19, v67
    v_cvt_pk_bf16_f32 v113, v18, v19
    v_mul_f32 v16, v68, v68
    s_waitcnt lgkmcnt(4)
    v_mfma_f32_32x32x16_bf16 v[48:63], v[28:31], v[164:167], v[48:63]
    s_barrier
    ds_read_b64_tr_b16 v[28:29], v3 offset:49152
    ds_read_b64_tr_b16 v[30:31], v3 offset:50176
    v_mul_f32_e64 v17, v69, v69
    v_fma_f32 v16, v16, v98, v96
    v_fma_f32 v17, v17, v98, v96
    v_mul_f32 v16, v16, v68
    v_mul_f32_e64 v17, v17, v69
    s_waitcnt lgkmcnt(4)
    v_mfma_f32_32x32x16_bf16 v[48:63], v[32:35], v[168:171], v[48:63]
    ds_read_b64_tr_b16 v[32:33], v3 offset:51200
    ds_read_b64_tr_b16 v[34:35], v3 offset:52224
    v_exp_f32 v16, v16
    v_exp_f32 v17, v17
    v_fma_f32 v16, v16, v100, v100
    v_fma_f32 v17, v17, v100, v100
    v_rcp_f32 v16, v16
    s_waitcnt lgkmcnt(4)
    v_mfma_f32_32x32x16_bf16 v[48:63], v[24:27], v[172:175], v[48:63]
    ds_read_b64_tr_b16 v[24:25], v3 offset:53248
    ds_read_b64_tr_b16 v[26:27], v3 offset:54272
    v_rcp_f32 v17, v17
    v_mul_f32 v16, v16, v68
    v_mul_f32 v17, v17, v69
    v_cvt_pk_bf16_f32 v114, v16, v17
    v_mul_f32 v18, v70, v70
    v_mul_f32 v19, v71, v71
    s_waitcnt lgkmcnt(4)
    v_mfma_f32_32x32x16_bf16 v[48:63], v[28:31], v[176:179], v[48:63]
    ds_read_b64_tr_b16 v[28:29], v3 offset:55296
    ds_read_b64_tr_b16 v[30:31], v3 offset:56320
    v_fma_f32 v18, v18, v98, v96
    v_fma_f32 v19, v19, v98, v96
    v_mul_f32 v18, v18, v70
    v_mul_f32 v19, v19, v71
    v_exp_f32 v18, v18
    s_waitcnt lgkmcnt(4)
    v_mfma_f32_32x32x16_bf16 v[48:63], v[32:35], v[180:183], v[48:63]
    s_waitcnt vmcnt(0)
    s_barrier
    ds_read_b64_tr_b16 v[32:33], v3 offset:57344
    ds_read_b64_tr_b16 v[34:35], v3 offset:58368
    v_exp_f32_e64 v19, v19
    v_fma_f32 v18, v18, v100, v100
    v_fma_f32 v19, v19, v100, v100
    v_rcp_f32 v18, v18
    v_rcp_f32_e64 v19, v19
    s_waitcnt lgkmcnt(4)
    v_mfma_f32_32x32x16_bf16 v[48:63], v[24:27], v[184:187], v[48:63]
    ds_read_b64_tr_b16 v[24:25], v3 offset:59392
    ds_read_b64_tr_b16 v[26:27], v3 offset:60416
    v_mul_f32 v18, v18, v70
    v_mul_f32 v19, v19, v71
    v_cvt_pk_bf16_f32 v115, v18, v19
    v_mul_f32 v16, v72, v72
    v_mul_f32_e64 v17, v73, v73
    s_waitcnt lgkmcnt(4)
    v_mfma_f32_32x32x16_bf16 v[48:63], v[28:31], v[188:191], v[48:63]
    ds_read_b64_tr_b16 v[28:29], v3 offset:61440
    ds_read_b64_tr_b16 v[30:31], v3 offset:62464
    v_fma_f32 v16, v16, v98, v96
    v_fma_f32 v17, v17, v98, v96
    v_mul_f32 v16, v16, v72
    v_mul_f32 v17, v17, v73
    v_exp_f32 v16, v16
    s_waitcnt lgkmcnt(4)
    v_mfma_f32_32x32x16_bf16 v[48:63], v[32:35], v[192:195], v[48:63]
    ds_read_b64_tr_b16 v[32:33], v3 offset:63488
    ds_read_b64_tr_b16 v[34:35], v3 offset:64512
    v_exp_f32_e64 v17, v17
    v_fma_f32 v16, v16, v100, v100
    v_fma_f32 v17, v17, v100, v100
    v_rcp_f32 v16, v16
    v_rcp_f32 v17, v17
    s_waitcnt lgkmcnt(4)
    v_mfma_f32_32x32x16_bf16 v[48:63], v[24:27], v[196:199], v[48:63]
    s_barrier
    ds_read_b64_tr_b16 v[24:25], v4 offset:0
    ds_read_b64_tr_b16 v[26:27], v4 offset:1024
    v_mul_f32 v16, v16, v72
    v_mul_f32 v17, v17, v73
    v_cvt_pk_bf16_f32 v116, v16, v17
    v_mul_f32 v18, v74, v74
    v_mul_f32_e64 v19, v75, v75
    s_waitcnt lgkmcnt(4)
    v_mfma_f32_32x32x16_bf16 v[48:63], v[28:31], v[200:203], v[48:63]
    ds_read_b64_tr_b16 v[28:29], v4 offset:2048
    ds_read_b64_tr_b16 v[30:31], v4 offset:3072
    v_fma_f32 v18, v18, v98, v96
    v_fma_f32 v19, v19, v98, v96
    v_mul_f32 v18, v18, v74
    v_mul_f32 v19, v19, v75
    v_exp_f32 v18, v18
    s_waitcnt lgkmcnt(4)
    v_mfma_f32_32x32x16_bf16 v[48:63], v[32:35], v[204:207], v[48:63]
    ds_read_b64_tr_b16 v[32:33], v4 offset:4096
    ds_read_b64_tr_b16 v[34:35], v4 offset:5120
    v_exp_f32_e64 v19, v19
    v_fma_f32 v18, v18, v100, v100
    v_fma_f32 v19, v19, v100, v100
    v_rcp_f32 v18, v18
    v_rcp_f32 v19, v19
    v_mul_f32 v18, v18, v74
    s_waitcnt lgkmcnt(4)
    v_mfma_f32_32x32x16_bf16 v[48:63], v[24:27], v[208:211], v[48:63]
    ds_read_b64_tr_b16 v[24:25], v4 offset:6144
    ds_read_b64_tr_b16 v[26:27], v4 offset:7168
    v_mul_f32 v19, v19, v75
    v_cvt_pk_bf16_f32 v117, v18, v19
    v_mul_f32 v16, v76, v76
    v_mul_f32 v17, v77, v77
    v_fma_f32 v16, v16, v98, v96
    s_waitcnt lgkmcnt(4)
    v_mfma_f32_32x32x16_bf16 v[48:63], v[28:31], v[212:215], v[48:63]
    s_barrier
    ds_read_b64_tr_b16 v[28:29], v3 offset:8192
    ds_read_b64_tr_b16 v[30:31], v3 offset:9216
    v_fma_f32 v17, v17, v98, v96
    v_mul_f32 v16, v16, v76
    v_mul_f32 v17, v17, v77
    v_exp_f32 v16, v16
    v_exp_f32 v17, v17
    s_waitcnt lgkmcnt(4)
    v_mfma_f32_32x32x16_bf16 v[48:63], v[32:35], v[216:219], v[48:63]
    ds_read_b64_tr_b16 v[32:33], v3 offset:10240
    ds_read_b64_tr_b16 v[34:35], v3 offset:11264
    v_fma_f32 v16, v16, v100, v100
    v_fma_f32 v17, v17, v100, v100
    v_rcp_f32 v16, v16
    v_rcp_f32 v17, v17
    v_mul_f32 v16, v16, v76
    s_waitcnt lgkmcnt(4)
    v_mfma_f32_32x32x16_bf16 v[48:63], v[24:27], v[220:223], v[48:63]
    ds_read_b64_tr_b16 v[24:25], v3 offset:12288
    ds_read_b64_tr_b16 v[26:27], v3 offset:13312
    v_mul_f32 v17, v17, v77
    v_cvt_pk_bf16_f32 v118, v16, v17
    v_mul_f32 v18, v78, v78
    v_mul_f32 v19, v79, v79
    v_fma_f32 v18, v18, v98, v96
    s_waitcnt lgkmcnt(4)
    v_mfma_f32_32x32x16_bf16 v[48:63], v[28:31], v[224:227], v[48:63]
    ds_read_b64_tr_b16 v[28:29], v3 offset:14336
    ds_read_b64_tr_b16 v[30:31], v3 offset:15360
    v_fma_f32 v19, v19, v98, v96
    v_mul_f32 v18, v18, v78
    v_mul_f32 v19, v19, v79
    v_exp_f32 v18, v18
    v_exp_f32 v19, v19
    s_waitcnt lgkmcnt(4)
    v_mfma_f32_32x32x16_bf16 v[48:63], v[32:35], v[228:231], v[48:63]
    s_barrier
    ds_read_b64_tr_b16 v[32:33], v3 offset:24576
    ds_read_b64_tr_b16 v[34:35], v3 offset:25600
    v_fma_f32 v18, v18, v100, v100
    v_fma_f32 v19, v19, v100, v100
    v_rcp_f32 v18, v18
    v_rcp_f32 v19, v19
    v_mul_f32 v18, v18, v78
    s_waitcnt lgkmcnt(4)
    v_mfma_f32_32x32x16_bf16 v[48:63], v[24:27], v[232:235], v[48:63]
    ds_read_b64_tr_b16 v[24:25], v3 offset:26624
    ds_read_b64_tr_b16 v[26:27], v3 offset:27648
    v_mul_f32_e64 v19, v19, v79
    v_cvt_pk_bf16_f32 v119, v18, v19
    buffer_store_dwordx4 v[112:115], v5, s[36:39], s10 offen sc1
    buffer_store_dwordx4 v[116:119], v5, s[36:39], s10 offen offset:2048 sc1
    s_mov_b32 s10, s13
    s_waitcnt lgkmcnt(4)
    v_mfma_f32_32x32x16_bf16 v[48:63], v[28:31], v[236:239], v[48:63]
    ds_read_b64_tr_b16 v[28:29], v3 offset:28672
    ds_read_b64_tr_b16 v[30:31], v3 offset:29696
    s_waitcnt lgkmcnt(4)
    v_mfma_f32_32x32x16_bf16 v[48:63], v[32:35], v[240:243], v[48:63]
    ds_read_b64_tr_b16 v[32:33], v3 offset:30720
    ds_read_b64_tr_b16 v[34:35], v3 offset:31744
    s_waitcnt lgkmcnt(4)
    v_mfma_f32_32x32x16_bf16 v[48:63], v[24:27], v[244:247], v[48:63]
    s_barrier
    ds_read_b128 v[36:39], v10 offset:32768
    ds_read_b64_tr_b16 v[24:25], v4 offset:8192
    ds_read_b64_tr_b16 v[26:27], v4 offset:9216
    s_waitcnt lgkmcnt(5)
    v_mfma_f32_32x32x16_bf16 v[48:63], v[28:31], v[248:251], v[48:63]
    ds_read_b128 v[40:43], v10 offset:34816
    ds_read_b64_tr_b16 v[28:29], v4 offset:10240
    ds_read_b64_tr_b16 v[30:31], v4 offset:11264
    s_waitcnt lgkmcnt(6)
    v_mfma_f32_32x32x16_bf16 v[48:63], v[32:35], v[252:255], v[48:63]
    ds_read_b128 v[44:47], v10 offset:36864
    ds_read_b64_tr_b16 v[32:33], v4 offset:12288
    ds_read_b64_tr_b16 v[34:35], v4 offset:13312
    s_waitcnt lgkmcnt(6)
    v_mfma_f32_32x32x16_bf16 v[64:79], v[24:27], v[36:39], 0
    ds_read_b128 v[36:39], v10 offset:38912
    ds_read_b64_tr_b16 v[24:25], v4 offset:14336
    ds_read_b64_tr_b16 v[26:27], v4 offset:15360
    s_waitcnt lgkmcnt(6)
    v_mfma_f32_32x32x16_bf16 v[64:79], v[28:31], v[40:43], v[64:79]
    s_barrier
    ds_read_b128 v[40:43], v10 offset:40960
    ds_read_b64_tr_b16 v[28:29], v4 offset:24576
    ds_read_b64_tr_b16 v[30:31], v4 offset:25600
    s_waitcnt lgkmcnt(6)
    v_mfma_f32_32x32x16_bf16 v[64:79], v[32:35], v[44:47], v[64:79]
    ds_read_b128 v[44:47], v10 offset:43008
    ds_read_b64_tr_b16 v[32:33], v4 offset:26624
    ds_read_b64_tr_b16 v[34:35], v4 offset:27648
    s_waitcnt lgkmcnt(6)
    v_mfma_f32_32x32x16_bf16 v[64:79], v[24:27], v[36:39], v[64:79]
    ds_read_b128 v[36:39], v10 offset:45056
    ds_read_b64_tr_b16 v[24:25], v4 offset:28672
    ds_read_b64_tr_b16 v[26:27], v4 offset:29696
    v_mul_f32 v16, v48, v48
    v_mul_f32 v17, v49, v49
    v_fma_f32 v16, v16, v98, v96
    v_fma_f32 v17, v17, v98, v96
    v_mul_f32 v16, v16, v48
    v_mul_f32_e64 v17, v17, v49
    s_waitcnt lgkmcnt(6)
    v_mfma_f32_32x32x16_bf16 v[64:79], v[28:31], v[40:43], v[64:79]
    ds_read_b128 v[40:43], v10 offset:47104
    ds_read_b64_tr_b16 v[28:29], v4 offset:30720
    ds_read_b64_tr_b16 v[30:31], v4 offset:31744
    v_exp_f32 v16, v16
    v_exp_f32 v17, v17
    v_fma_f32 v16, v16, v100, v100
    v_fma_f32 v17, v17, v100, v100
    v_rcp_f32 v16, v16
    s_waitcnt lgkmcnt(6)
    v_mfma_f32_32x32x16_bf16 v[64:79], v[32:35], v[44:47], v[64:79]
    s_barrier
    ds_read_b128 v[44:47], v10 offset:16384
    ds_read_b64_tr_b16 v[32:33], v3 offset:0
    ds_read_b64_tr_b16 v[34:35], v3 offset:1024
    v_rcp_f32 v17, v17
    v_mul_f32 v16, v16, v48
    v_mul_f32 v17, v17, v49
    v_cvt_pk_bf16_f32 v112, v16, v17
    v_mul_f32 v18, v50, v50
    s_waitcnt lgkmcnt(6)
    v_mfma_f32_32x32x16_bf16 v[64:79], v[24:27], v[36:39], v[64:79]
    ds_read_b128 v[36:39], v10 offset:18432
    ds_read_b64_tr_b16 v[24:25], v3 offset:2048
    ds_read_b64_tr_b16 v[26:27], v3 offset:3072
    v_mul_f32_e64 v19, v51, v51
    v_fma_f32 v18, v18, v98, v96
    v_fma_f32 v19, v19, v98, v96
    v_mul_f32 v18, v18, v50
    v_mul_f32_e64 v19, v19, v51
    s_waitcnt lgkmcnt(6)
    v_mfma_f32_32x32x16_bf16 v[64:79], v[28:31], v[40:43], v[64:79]
    ds_read_b128 v[40:43], v10 offset:20480
    ds_read_b64_tr_b16 v[28:29], v3 offset:4096
    ds_read_b64_tr_b16 v[30:31], v3 offset:5120
    v_exp_f32 v18, v18
    v_exp_f32 v19, v19
    v_fma_f32 v18, v18, v100, v100
    v_fma_f32 v19, v19, v100, v100
    v_rcp_f32 v18, v18
    s_waitcnt lgkmcnt(6)
    v_mfma_f32_32x32x16_bf16 v[64:79], v[32:35], v[44:47], v[64:79]
    ds_read_b128 v[44:47], v10 offset:22528
    ds_read_b64_tr_b16 v[32:33], v3 offset:6144
    ds_read_b64_tr_b16 v[34:35], v3 offset:7168
    v_rcp_f32 v19, v19
    v_mul_f32 v18, v18, v50
    v_mul_f32 v19, v19, v51
    v_cvt_pk_bf16_f32 v113, v18, v19
    v_mul_f32 v16, v52, v52
    s_waitcnt lgkmcnt(6)
    v_mfma_f32_32x32x16_bf16 v[64:79], v[24:27], v[36:39], v[64:79]
    s_barrier
    ds_read_b128 v[36:39], v10 offset:49152
    ds_read_b64_tr_b16 v[24:25], v3 offset:16384
    ds_read_b64_tr_b16 v[26:27], v3 offset:17408
    v_mul_f32_e64 v17, v53, v53
    v_fma_f32 v16, v16, v98, v96
    v_fma_f32 v17, v17, v98, v96
    v_mul_f32 v16, v16, v52
    v_mul_f32_e64 v17, v17, v53
    s_waitcnt lgkmcnt(6)
    v_mfma_f32_32x32x16_bf16 v[64:79], v[28:31], v[40:43], v[64:79]
    ds_read_b128 v[40:43], v10 offset:51200
    ds_read_b64_tr_b16 v[28:29], v3 offset:18432
    ds_read_b64_tr_b16 v[30:31], v3 offset:19456
    v_exp_f32 v16, v16
    v_exp_f32 v17, v17
    v_fma_f32 v16, v16, v100, v100
    v_fma_f32 v17, v17, v100, v100
    v_rcp_f32 v16, v16
    s_waitcnt lgkmcnt(6)
    v_mfma_f32_32x32x16_bf16 v[64:79], v[32:35], v[44:47], v[64:79]
    ds_read_b128 v[44:47], v10 offset:53248
    ds_read_b64_tr_b16 v[32:33], v3 offset:20480
    ds_read_b64_tr_b16 v[34:35], v3 offset:21504
    v_rcp_f32 v17, v17
    v_mul_f32 v16, v16, v52
    v_mul_f32 v17, v17, v53
    v_cvt_pk_bf16_f32 v114, v16, v17
    v_mul_f32 v18, v54, v54
    v_mul_f32 v19, v55, v55
    s_waitcnt lgkmcnt(6)
    v_mfma_f32_32x32x16_bf16 v[64:79], v[24:27], v[36:39], v[64:79]
    ds_read_b128 v[36:39], v10 offset:55296
    ds_read_b64_tr_b16 v[24:25], v3 offset:22528
    ds_read_b64_tr_b16 v[26:27], v3 offset:23552
    v_fma_f32 v18, v18, v98, v96
    v_fma_f32 v19, v19, v98, v96
    v_mul_f32 v18, v18, v54
    v_mul_f32 v19, v19, v55
    v_exp_f32 v18, v18
    s_waitcnt lgkmcnt(6)
    v_mfma_f32_32x32x16_bf16 v[64:79], v[28:31], v[40:43], v[64:79]
    s_waitcnt vmcnt(0)
    s_barrier
    ds_read_b128 v[40:43], v10 offset:57344
    ds_read_b64_tr_b16 v[28:29], v3 offset:32768
    ds_read_b64_tr_b16 v[30:31], v3 offset:33792
    v_exp_f32_e64 v19, v19
    v_fma_f32 v18, v18, v100, v100
    v_fma_f32 v19, v19, v100, v100
    v_rcp_f32 v18, v18
    v_rcp_f32_e64 v19, v19
    s_waitcnt lgkmcnt(6)
    v_mfma_f32_32x32x16_bf16 v[64:79], v[32:35], v[44:47], v[64:79]
    ds_read_b128 v[44:47], v10 offset:59392
    ds_read_b64_tr_b16 v[32:33], v3 offset:34816
    ds_read_b64_tr_b16 v[34:35], v3 offset:35840
    v_mul_f32 v18, v18, v54
    v_mul_f32 v19, v19, v55
    v_cvt_pk_bf16_f32 v115, v18, v19
    v_mul_f32 v16, v56, v56
    v_mul_f32_e64 v17, v57, v57
    s_waitcnt lgkmcnt(6)
    v_mfma_f32_32x32x16_bf16 v[64:79], v[24:27], v[36:39], v[64:79]
    ds_read_b128 v[36:39], v10 offset:61440
    ds_read_b64_tr_b16 v[24:25], v3 offset:36864
    ds_read_b64_tr_b16 v[26:27], v3 offset:37888
    v_fma_f32 v16, v16, v98, v96
    v_fma_f32 v17, v17, v98, v96
    v_mul_f32 v16, v16, v56
    v_mul_f32 v17, v17, v57
    v_exp_f32 v16, v16
    s_waitcnt lgkmcnt(6)
    v_mfma_f32_32x32x16_bf16 v[64:79], v[28:31], v[40:43], v[64:79]
    ds_read_b128 v[40:43], v10 offset:63488
    ds_read_b64_tr_b16 v[28:29], v3 offset:38912
    ds_read_b64_tr_b16 v[30:31], v3 offset:39936
    v_exp_f32_e64 v17, v17
    v_fma_f32 v16, v16, v100, v100
    v_fma_f32 v17, v17, v100, v100
    v_rcp_f32 v16, v16
    v_rcp_f32 v17, v17
    s_waitcnt lgkmcnt(6)
    v_mfma_f32_32x32x16_bf16 v[64:79], v[32:35], v[44:47], v[64:79]
    s_barrier
    ds_read_b128 v[44:47], v5 offset:40960
    ds_read_b64_tr_b16 v[32:33], v0 offset:0
    ds_read_b64_tr_b16 v[34:35], v0 offset:1024
    v_mul_f32 v16, v16, v56
    v_mul_f32 v17, v17, v57
    v_cvt_pk_bf16_f32 v116, v16, v17
    v_mul_f32 v18, v58, v58
    v_mul_f32_e64 v19, v59, v59
    s_waitcnt lgkmcnt(6)
    v_mfma_f32_32x32x16_bf16 v[64:79], v[24:27], v[36:39], v[64:79]
    ds_read_b128 v[36:39], v5 offset:43008
    ds_read_b64_tr_b16 v[24:25], v0 offset:2048
    ds_read_b64_tr_b16 v[26:27], v0 offset:3072
    v_fma_f32 v18, v18, v98, v96
    v_fma_f32 v19, v19, v98, v96
    v_mul_f32 v18, v18, v58
    v_mul_f32 v19, v19, v59
    v_exp_f32 v18, v18
    s_waitcnt lgkmcnt(6)
    v_mfma_f32_32x32x16_bf16 v[64:79], v[28:31], v[40:43], v[64:79]
    ds_read_b128 v[40:43], v5 offset:45056
    ds_read_b64_tr_b16 v[28:29], v0 offset:4096
    ds_read_b64_tr_b16 v[30:31], v0 offset:5120
    v_exp_f32_e64 v19, v19
    v_fma_f32 v18, v18, v100, v100
    v_fma_f32 v19, v19, v100, v100
    v_rcp_f32 v18, v18
    v_rcp_f32 v19, v19
    v_mul_f32 v18, v18, v58
    s_waitcnt lgkmcnt(6)
    v_mfma_f32_32x32x16_bf16 v[64:79], v[32:35], v[44:47], v[64:79]
    ds_read_b128 v[44:47], v5 offset:47104
    ds_read_b64_tr_b16 v[32:33], v0 offset:6144
    ds_read_b64_tr_b16 v[34:35], v0 offset:7168
    v_mul_f32 v19, v19, v59
    v_cvt_pk_bf16_f32 v117, v18, v19
    v_mul_f32 v16, v60, v60
    v_mul_f32 v17, v61, v61
    v_fma_f32 v16, v16, v98, v96
    s_waitcnt lgkmcnt(6)
    v_mfma_f32_32x32x16_bf16 v[64:79], v[24:27], v[36:39], v[64:79]
    s_barrier
    ds_read_b128 v[36:39], v5 offset:49152
    ds_read_b64_tr_b16 v[24:25], v0 offset:8192
    ds_read_b64_tr_b16 v[26:27], v0 offset:9216
    v_fma_f32 v17, v17, v98, v96
    v_mul_f32 v16, v16, v60
    v_mul_f32 v17, v17, v61
    v_exp_f32 v16, v16
    v_exp_f32 v17, v17
    s_waitcnt lgkmcnt(6)
    v_mfma_f32_32x32x16_bf16 v[64:79], v[28:31], v[40:43], v[64:79]
    ds_read_b128 v[40:43], v5 offset:51200
    ds_read_b64_tr_b16 v[28:29], v0 offset:10240
    ds_read_b64_tr_b16 v[30:31], v0 offset:11264
    v_fma_f32 v16, v16, v100, v100
    v_fma_f32 v17, v17, v100, v100
    v_rcp_f32 v16, v16
    v_rcp_f32 v17, v17
    v_mul_f32 v16, v16, v60
    s_waitcnt lgkmcnt(6)
    v_mfma_f32_32x32x16_bf16 v[64:79], v[32:35], v[44:47], v[64:79]
    ds_read_b128 v[44:47], v5 offset:53248
    ds_read_b64_tr_b16 v[32:33], v0 offset:12288
    ds_read_b64_tr_b16 v[34:35], v0 offset:13312
    v_mul_f32 v17, v17, v61
    v_cvt_pk_bf16_f32 v118, v16, v17
    v_mul_f32 v18, v62, v62
    v_mul_f32 v19, v63, v63
    v_fma_f32 v18, v18, v98, v96
    s_waitcnt lgkmcnt(6)
    v_mfma_f32_32x32x16_bf16 v[64:79], v[24:27], v[36:39], v[64:79]
    ds_read_b128 v[36:39], v5 offset:55296
    ds_read_b64_tr_b16 v[24:25], v0 offset:14336
    ds_read_b64_tr_b16 v[26:27], v0 offset:15360
    v_fma_f32 v19, v19, v98, v96
    v_mul_f32 v18, v18, v62
    v_mul_f32 v19, v19, v63
    v_exp_f32 v18, v18
    v_exp_f32 v19, v19
    s_waitcnt lgkmcnt(6)
    v_mfma_f32_32x32x16_bf16 v[64:79], v[28:31], v[40:43], v[64:79]
    s_barrier
    ds_read_b128 v[40:43], v5 offset:57344
    ds_read_b64_tr_b16 v[28:29], v4 offset:0
    ds_read_b64_tr_b16 v[30:31], v4 offset:1024
    v_fma_f32 v18, v18, v100, v100
    v_fma_f32 v19, v19, v100, v100
    v_rcp_f32 v18, v18
    v_rcp_f32 v19, v19
    v_mul_f32 v18, v18, v62
    s_waitcnt lgkmcnt(6)
    v_mfma_f32_32x32x16_bf16 v[64:79], v[32:35], v[44:47], v[64:79]
    ds_read_b128 v[44:47], v5 offset:59392
    ds_read_b64_tr_b16 v[32:33], v4 offset:2048
    ds_read_b64_tr_b16 v[34:35], v4 offset:3072
    v_mul_f32_e64 v19, v19, v63
    v_cvt_pk_bf16_f32 v119, v18, v19
    buffer_store_dwordx4 v[112:115], v5, s[36:39], s10 offen sc1
    buffer_store_dwordx4 v[116:119], v5, s[36:39], s10 offen offset:2048 sc1
    s_mov_b32 s10, s13
    s_waitcnt lgkmcnt(6)
    v_mfma_f32_32x32x16_bf16 v[64:79], v[24:27], v[36:39], v[64:79]
    ds_read_b128 v[36:39], v5 offset:61440
    ds_read_b64_tr_b16 v[24:25], v4 offset:4096
    ds_read_b64_tr_b16 v[26:27], v4 offset:5120
    s_waitcnt lgkmcnt(6)
    v_mfma_f32_32x32x16_bf16 v[64:79], v[28:31], v[40:43], v[64:79]
    ds_read_b128 v[40:43], v5 offset:63488
L_pg8:
    s_cbranch_execz L_pr8
    ds_read_b64_tr_b16 v[28:29], v4 offset:6144
    ds_read_b64_tr_b16 v[30:31], v4 offset:7168
    s_waitcnt lgkmcnt(6)
    v_mfma_f32_32x32x16_bf16 v[64:79], v[32:35], v[44:47], v[64:79]
    s_barrier
    ds_read_b128 v[44:47], v10 offset:24576
    ds_read_b64_tr_b16 v[32:33], v0 offset:16384
    ds_read_b64_tr_b16 v[34:35], v0 offset:17408
    s_waitcnt lgkmcnt(6)
    v_mfma_f32_32x32x16_bf16 v[64:79], v[24:27], v[36:39], v[64:79]
    ds_read_b128 v[36:39], v10 offset:26624
    ds_read_b64_tr_b16 v[24:25], v0 offset:18432
    ds_read_b64_tr_b16 v[26:27], v0 offset:19456
    s_waitcnt lgkmcnt(6)
    v_mfma_f32_32x32x16_bf16 v[64:79], v[28:31], v[40:43], v[64:79]
    ds_read_b128 v[40:43], v10 offset:28672
    ds_read_b64_tr_b16 v[28:29], v0 offset:20480
    ds_read_b64_tr_b16 v[30:31], v0 offset:21504
    s_waitcnt lgkmcnt(6)
    v_mfma_f32_32x32x16_bf16 v[80:95], v[32:35], v[44:47], v[80:95]
    ds_read_b128 v[44:47], v10 offset:30720
    ds_read_b64_tr_b16 v[32:33], v0 offset:22528
    ds_read_b64_tr_b16 v[34:35], v0 offset:23552
    s_waitcnt lgkmcnt(6)
    v_mfma_f32_32x32x16_bf16 v[80:95], v[24:27], v[36:39], v[80:95]
    s_barrier
    ds_read_b128 v[36:39], v10 offset:40960
    ds_read_b64_tr_b16 v[24:25], v3 offset:8192
    ds_read_b64_tr_b16 v[26:27], v3 offset:9216
    s_waitcnt lgkmcnt(6)
    v_mfma_f32_32x32x16_bf16 v[80:95], v[28:31], v[40:43], v[80:95]
    ds_read_b128 v[40:43], v10 offset:43008
    ds_read_b64_tr_b16 v[28:29], v3 offset:10240
    ds_read_b64_tr_b16 v[30:31], v3 offset:11264
    s_waitcnt lgkmcnt(6)
    v_mfma_f32_32x32x16_bf16 v[80:95], v[32:35], v[44:47], v[80:95]
    ds_read_b128 v[44:47], v10 offset:45056
    ds_read_b64_tr_b16 v[32:33], v3 offset:12288
    ds_read_b64_tr_b16 v[34:35], v3 offset:13312
    s_waitcnt lgkmcnt(6)
    v_mfma_f32_32x32x16_bf16 v[80:95], v[24:27], v[36:39], v[80:95]
    ds_read_b128 v[36:39], v10 offset:47104
    ds_read_b64_tr_b16 v[24:25], v3 offset:14336
    ds_read_b64_tr_b16 v[26:27], v3 offset:15360
    s_waitcnt lgkmcnt(6)
    v_mfma_f32_32x32x16_bf16 v[80:95], v[28:31], v[40:43], v[80:95]
    s_barrier
    ds_read_b128 v[40:43], v5 offset:0
    ds_read_b64_tr_b16 v[28:29], v3 offset:24576
    ds_read_b64_tr_b16 v[30:31], v3 offset:25600
    s_waitcnt lgkmcnt(6)
    v_mfma_f32_32x32x16_bf16 v[80:95], v[32:35], v[44:47], v[80:95]
    ds_read_b128 v[44:47], v5 offset:2048
    ds_read_b64_tr_b16 v[32:33], v3 offset:26624
    ds_read_b64_tr_b16 v[34:35], v3 offset:27648
    s_waitcnt lgkmcnt(6)
    v_mfma_f32_32x32x16_bf16 v[80:95], v[24:27], v[36:39], v[80:95]
    ds_read_b128 v[36:39], v5 offset:4096
    ds_read_b64_tr_b16 v[24:25], v3 offset:28672
    ds_read_b64_tr_b16 v[26:27], v3 offset:29696
    s_waitcnt lgkmcnt(6)
    v_mfma_f32_32x32x16_bf16 v[80:95], v[28:31], v[40:43], v[80:95]
    ds_read_b128 v[40:43], v5 offset:6144
    ds_read_b64_tr_b16 v[28:29], v3 offset:30720
    ds_read_b64_tr_b16 v[30:31], v3 offset:31744
    v_and_b32 v56, 1023, v5
    s_waitcnt lgkmcnt(6)
    v_mfma_f32_32x32x16_bf16 v[80:95], v[32:35], v[44:47], v[80:95]
    s_barrier
    ds_read_b128 v[44:47], v10 offset:16384
    ds_read_b64_tr_b16 v[32:33], v4 offset:8192
    ds_read_b64_tr_b16 v[34:35], v4 offset:9216
    v_lshrrev_b32_e64 v56, 4, v56
    s_waitcnt lgkmcnt(6)
    v_mfma_f32_32x32x16_bf16 v[80:95], v[24:27], v[36:39], v[80:95]
    ds_read_b128 v[36:39], v10 offset:18432
    ds_read_b64_tr_b16 v[24:25], v4 offset:10240
    ds_read_b64_tr_b16 v[26:27], v4 offset:11264
    v_lshrrev_b32 v57, 10, v5
    s_waitcnt lgkmcnt(6)
    v_mfma_f32_32x32x16_bf16 v[80:95], v[28:31], v[40:43], v[80:95]
    ds_read_b128 v[40:43], v10 offset:20480
    ds_read_b64_tr_b16 v[28:29], v4 offset:12288
    ds_read_b64_tr_b16 v[30:31], v4 offset:13312
    s_lshl_b32 s47, s59, 2
    v_add_u32_e64 v57, s47, v57
    s_waitcnt lgkmcnt(6)
    v_mfma_f32_32x32x16_bf16 v[80:95], v[32:35], v[44:47], v[80:95]
    ds_read_b128 v[44:47], v10 offset:22528
    ds_read_b64_tr_b16 v[32:33], v4 offset:14336
    ds_read_b64_tr_b16 v[34:35], v4 offset:15360
    v_and_b32 v58, 7, v56
    s_waitcnt lgkmcnt(6)
    v_mfma_f32_32x32x16_bf16 v[80:95], v[24:27], v[36:39], v[80:95]
    s_waitcnt vmcnt(0)
    s_barrier
    ds_read_b128 v[36:39], v5 offset:16384
    ds_read_b64_tr_b16 v[24:25], v4 offset:32768
    ds_read_b64_tr_b16 v[26:27], v4 offset:33792
    v_xor_b32 v57, v57, v58
    s_waitcnt lgkmcnt(6)
    v_mfma_f32_32x32x16_bf16 v[80:95], v[28:31], v[40:43], v[80:95]
    ds_read_b128 v[40:43], v5 offset:18432
    ds_read_b64_tr_b16 v[28:29], v4 offset:34816
    ds_read_b64_tr_b16 v[30:31], v4 offset:35840
    v_lshlrev_b32 v56, 7, v56
    s_waitcnt lgkmcnt(6)
    v_mfma_f32_32x32x16_bf16 v[80:95], v[32:35], v[44:47], v[80:95]
    ds_read_b128 v[44:47], v5 offset:20480
    ds_read_b64_tr_b16 v[32:33], v4 offset:36864
    ds_read_b64_tr_b16 v[34:35], v4 offset:37888
    s_waitcnt lgkmcnt(6)
    v_mfma_f32_32x32x16_bf16 v[80:95], v[24:27], v[36:39], v[80:95]
    ds_read_b128 v[36:39], v5 offset:22528
    ds_read_b64_tr_b16 v[24:25], v4 offset:38912
    ds_read_b64_tr_b16 v[26:27], v4 offset:39936
    v_add_u32 v56, 155648, v56
    s_waitcnt lgkmcnt(6)
    v_mfma_f32_32x32x16_bf16 v[80:95], v[28:31], v[40:43], v[80:95]
    s_barrier
    ds_read_b128 v[40:43], v10 offset:49152
    ds_read_b64_tr_b16 v[28:29], v3 offset:32768
    ds_read_b64_tr_b16 v[30:31], v3 offset:33792
    v_lshl_add_u32 v52, v57, 4, v56
    s_waitcnt lgkmcnt(6)
    v_mfma_f32_32x32x16_bf16 v[80:95], v[32:35], v[44:47], v[80:95]
    ds_read_b128 v[44:47], v10 offset:51200
    ds_read_b64_tr_b16 v[32:33], v3 offset:34816
    ds_read_b64_tr_b16 v[34:35], v3 offset:35840
    v_xor_b32 v53, 32, v52
    s_waitcnt lgkmcnt(6)
    v_mfma_f32_32x32x16_bf16 v[80:95], v[24:27], v[36:39], v[80:95]
    ds_read_b128 v[36:39], v10 offset:53248
    ds_read_b64_tr_b16 v[24:25], v3 offset:36864
    ds_read_b64_tr_b16 v[26:27], v3 offset:37888
    v_mbcnt_lo_u32_b32 v56, -1, 0
    s_waitcnt lgkmcnt(6)
    v_mfma_f32_32x32x16_bf16 v[80:95], v[28:31], v[40:43], v[80:95]
    ds_read_b128 v[40:43], v10 offset:55296
    ds_read_b64_tr_b16 v[28:29], v3 offset:38912
    ds_read_b64_tr_b16 v[30:31], v3 offset:39936
    v_mbcnt_hi_u32_b32 v56, -1, v56
    s_waitcnt lgkmcnt(6)
    v_mfma_f32_32x32x16_bf16 v[80:95], v[32:35], v[44:47], v[80:95]
    s_barrier
    ds_read_b128 v[44:47], v10 offset:57344
    ds_read_b64_tr_b16 v[32:33], v3 offset:40960
    ds_read_b64_tr_b16 v[34:35], v3 offset:41984
    s_lshl_b32 s47, s31, 11
    s_add_u32 s47, s47, 155648
    v_lshlrev_b32 v54, 4, v56
    s_waitcnt lgkmcnt(6)
    v_mfma_f32_32x32x16_bf16 v[80:95], v[24:27], v[36:39], v[80:95]
    ds_read_b128 v[36:39], v10 offset:59392
    ds_read_b64_tr_b16 v[24:25], v3 offset:43008
    ds_read_b64_tr_b16 v[26:27], v3 offset:44032
    s_waitcnt lgkmcnt(6)
    v_mfma_f32_32x32x16_bf16 v[80:95], v[28:31], v[40:43], v[80:95]
    ds_read_b128 v[40:43], v10 offset:61440
    ds_read_b64_tr_b16 v[28:29], v3 offset:45056
    ds_read_b64_tr_b16 v[30:31], v3 offset:46080
    v_add_u32_e64 v54, s47, v54
    s_waitcnt lgkmcnt(6)
    v_mfma_f32_32x32x16_bf16 v[80:95], v[32:35], v[44:47], v[80:95]
    ds_read_b128 v[44:47], v10 offset:63488
    ds_read_b64_tr_b16 v[32:33], v3 offset:47104
    ds_read_b64_tr_b16 v[34:35], v3 offset:48128
    v_lshrrev_b32 v57, 3, v56
    s_waitcnt lgkmcnt(6)
    v_mfma_f32_32x32x16_bf16 v[80:95], v[24:27], v[36:39], v[80:95]
    s_barrier
    ds_read_b128 v[36:39], v5 offset:49152
    ds_read_b64_tr_b16 v[24:25], v3 offset:57344
    ds_read_b64_tr_b16 v[26:27], v3 offset:58368
    v_and_b32_e64 v56, 7, v56
    s_waitcnt lgkmcnt(6)
    v_mfma_f32_32x32x16_bf16 v[80:95], v[28:31], v[40:43], v[80:95]
    ds_read_b128 v[40:43], v5 offset:51200
    ds_read_b64_tr_b16 v[28:29], v3 offset:59392
    ds_read_b64_tr_b16 v[30:31], v3 offset:60416
    v_xor_b32 v56, v56, v57
    s_waitcnt lgkmcnt(6)
    v_mfma_f32_32x32x16_bf16 v[80:95], v[32:35], v[44:47], v[80:95]
    ds_read_b128 v[44:47], v5 offset:53248
    ds_read_b64_tr_b16 v[32:33], v3 offset:61440
    ds_read_b64_tr_b16 v[34:35], v3 offset:62464
    v_lshlrev_b32 v56, 4, v56
    s_waitcnt lgkmcnt(6)
    v_mfma_f32_32x32x16_bf16 v[80:95], v[24:27], v[36:39], v[80:95]
    ds_read_b128 v[36:39], v5 offset:55296
    ds_read_b64_tr_b16 v[24:25], v3 offset:63488
    ds_read_b64_tr_b16 v[26:27], v3 offset:64512
    v_lshl_add_u32 v48, v57, 10, v56
    s_waitcnt lgkmcnt(6)
    v_mfma_f32_32x32x16_bf16 v[80:95], v[28:31], v[40:43], v[80:95]
    s_barrier
    ds_read_b128 v[40:43], v5 offset:8192
    ds_read_b64_tr_b16 v[28:29], v4 offset:0
    ds_read_b64_tr_b16 v[30:31], v4 offset:1024
    s_waitcnt lgkmcnt(6)
    v_mfma_f32_32x32x16_bf16 v[80:95], v[32:35], v[44:47], v[80:95]
    ds_read_b128 v[44:47], v5 offset:10240
    ds_read_b64_tr_b16 v[32:33], v4 offset:2048
    ds_read_b64_tr_b16 v[34:35], v4 offset:3072
    v_add_u32 v49, 8192, v48
    s_waitcnt lgkmcnt(6)
    v_mfma_f32_32x32x16_bf16 v[80:95], v[24:27], v[36:39], v[80:95]
    ds_read_b128 v[36:39], v5 offset:12288
    ds_read_b64_tr_b16 v[24:25], v4 offset:4096
    ds_read_b64_tr_b16 v[26:27], v4 offset:5120
    s_lshl_b32 s11, s28, 16
    s_lshl_b32 s47, s31, 14
    s_add_u32 s11, s11, s47
    s_lshl_b32 s47, s29, 7
    s_add_u32 s11, s11, s47
    s_waitcnt lgkmcnt(6)
    v_mfma_f32_32x32x16_bf16 v[80:95], v[28:31], v[40:43], v[80:95]
    ds_read_b128 v[40:43], v5 offset:14336
    ds_read_b64_tr_b16 v[28:29], v4 offset:6144
    ds_read_b64_tr_b16 v[30:31], v4 offset:7168
    v_sub_f32 v50, 1.0, v14
    s_waitcnt lgkmcnt(6)
    v_mfma_f32_32x32x16_bf16 v[80:95], v[32:35], v[44:47], v[80:95]
    s_barrier
    ds_read_b128 v[44:47], v5 offset:0
    ds_read_b64_tr_b16 v[32:33], v3 offset:24576
    ds_read_b64_tr_b16 v[34:35], v3 offset:25600
    v_mul_f32_e64 v64, v14, v64
    s_waitcnt lgkmcnt(6)
    v_mfma_f32_32x32x16_bf16 v[80:95], v[24:27], v[36:39], v[80:95]
    ds_read_b128 v[36:39], v5 offset:2048
    ds_read_b64_tr_b16 v[24:25], v3 offset:26624
    ds_read_b64_tr_b16 v[26:27], v3 offset:27648
    v_mul_f32 v65, v14, v65
    s_waitcnt lgkmcnt(6)
    v_mfma_f32_32x32x16_bf16 v[80:95], v[28:31], v[40:43], v[80:95]
    ds_read_b128 v[40:43], v5 offset:4096
    ds_read_b64_tr_b16 v[28:29], v3 offset:28672
    ds_read_b64_tr_b16 v[30:31], v3 offset:29696
    v_mul_f32 v66, v14, v66
    s_waitcnt lgkmcnt(6)
    v_mfma_f32_32x32x16_bf16 v[80:95], v[32:35], v[44:47], v[80:95]
    ds_read_b128 v[44:47], v5 offset:6144
    ds_read_b64_tr_b16 v[32:33], v3 offset:30720
    ds_read_b64_tr_b16 v[34:35], v3 offset:31744
    v_mul_f32 v67, v14, v67
    s_waitcnt lgkmcnt(6)
    v_mfma_f32_32x32x16_bf16 v[80:95], v[24:27], v[36:39], v[80:95]
    s_barrier
    ds_read_b128 v[36:39], v10 offset:8192
    ds_read_b64_tr_b16 v[24:25], v4 offset:16384
    ds_read_b64_tr_b16 v[26:27], v4 offset:17408
    s_waitcnt lgkmcnt(6)
    v_mfma_f32_32x32x16_bf16 v[80:95], v[28:31], v[40:43], v[80:95]
    ds_read_b128 v[40:43], v10 offset:10240
    ds_read_b64_tr_b16 v[28:29], v4 offset:18432
    ds_read_b64_tr_b16 v[30:31], v4 offset:19456
    v_mul_f32 v68, v14, v68
    s_waitcnt lgkmcnt(6)
    v_mfma_f32_32x32x16_bf16 v[80:95], v[32:35], v[44:47], v[80:95]
    ds_read_b128 v[44:47], v10 offset:12288
    ds_read_b64_tr_b16 v[32:33], v4 offset:20480
    ds_read_b64_tr_b16 v[34:35], v4 offset:21504
    v_mul_f32 v69, v14, v69
    s_waitcnt lgkmcnt(6)
    v_mfma_f32_32x32x16_bf16 v[80:95], v[24:27], v[36:39], v[80:95]
    ds_read_b128 v[36:39], v10 offset:14336
    ds_read_b64_tr_b16 v[24:25], v4 offset:22528
    ds_read_b64_tr_b16 v[26:27], v4 offset:23552
    v_mul_f32 v70, v14, v70
    s_waitcnt lgkmcnt(6)
    v_mfma_f32_32x32x16_bf16 v[80:95], v[28:31], v[40:43], v[80:95]
    s_barrier
    ds_read_b128 v[40:43], v5 offset:16384
    ds_read_b64_tr_b16 v[28:29], v4 offset:24576
    ds_read_b64_tr_b16 v[30:31], v4 offset:25600
    v_mul_f32_e64 v71, v14, v71
    s_waitcnt lgkmcnt(6)
    v_mfma_f32_32x32x16_bf16 v[80:95], v[32:35], v[44:47], v[80:95]
    ds_read_b128 v[44:47], v5 offset:18432
    ds_read_b64_tr_b16 v[32:33], v4 offset:26624
    ds_read_b64_tr_b16 v[34:35], v4 offset:27648
    v_mul_f32 v72, v14, v72
    s_waitcnt lgkmcnt(6)
    v_mfma_f32_32x32x16_bf16 v[80:95], v[24:27], v[36:39], v[80:95]
    ds_read_b128 v[36:39], v5 offset:20480
    ds_read_b64_tr_b16 v[24:25], v4 offset:28672
    ds_read_b64_tr_b16 v[26:27], v4 offset:29696
    v_mul_f32 v73, v14, v73
    s_waitcnt lgkmcnt(6)
    v_mfma_f32_32x32x16_bf16 v[80:95], v[28:31], v[40:43], v[80:95]
    ds_read_b128 v[40:43], v5 offset:22528
    ds_read_b64_tr_b16 v[28:29], v4 offset:30720
    ds_read_b64_tr_b16 v[30:31], v4 offset:31744
    s_waitcnt lgkmcnt(6)
    v_mfma_f32_32x32x16_bf16 v[80:95], v[32:35], v[44:47], v[80:95]
    s_barrier
    ds_read_b128 v[44:47], v5 offset:32768
    ds_read_b64_tr_b16 v[32:33], v4 offset:32768
    ds_read_b64_tr_b16 v[34:35], v4 offset:33792
    v_mul_f32 v74, v14, v74
    s_waitcnt lgkmcnt(6)
    v_mfma_f32_32x32x16_bf16 v[80:95], v[24:27], v[36:39], v[80:95]
    ds_read_b128 v[36:39], v5 offset:34816
    ds_read_b64_tr_b16 v[24:25], v4 offset:34816
    ds_read_b64_tr_b16 v[26:27], v4 offset:35840
    v_mul_f32 v75, v14, v75
    s_waitcnt lgkmcnt(6)
    v_mfma_f32_32x32x16_bf16 v[80:95], v[28:31], v[40:43], v[80:95]
    ds_read_b128 v[40:43], v5 offset:36864
    ds_read_b64_tr_b16 v[28:29], v4 offset:36864
    ds_read_b64_tr_b16 v[30:31], v4 offset:37888
    v_mul_f32 v76, v14, v76
    s_waitcnt lgkmcnt(6)
    v_mfma_f32_32x32x16_bf16 v[80:95], v[32:35], v[44:47], v[80:95]
    ds_read_b128 v[44:47], v5 offset:38912
    ds_read_b64_tr_b16 v[32:33], v4 offset:38912
    ds_read_b64_tr_b16 v[34:35], v4 offset:39936
    v_mul_f32 v77, v14, v77
    s_waitcnt lgkmcnt(6)
    v_mfma_f32_32x32x16_bf16 v[80:95], v[24:27], v[36:39], v[80:95]
    s_barrier
    ds_read_b128 v[36:39], v5 offset:40960
    ds_read_b64_tr_b16 v[24:25], v4 offset:40960
    ds_read_b64_tr_b16 v[26:27], v4 offset:41984
    v_mul_f32_e64 v78, v14, v78
    s_waitcnt lgkmcnt(6)
    v_mfma_f32_32x32x16_bf16 v[80:95], v[28:31], v[40:43], v[80:95]
    ds_read_b128 v[40:43], v5 offset:43008
    ds_read_b64_tr_b16 v[28:29], v4 offset:43008
    ds_read_b64_tr_b16 v[30:31], v4 offset:44032
    v_mul_f32 v79, v14, v79
    s_waitcnt lgkmcnt(6)
    v_mfma_f32_32x32x16_bf16 v[80:95], v[32:35], v[44:47], v[80:95]
    ds_read_b128 v[44:47], v5 offset:45056
    ds_read_b64_tr_b16 v[32:33], v4 offset:45056
    ds_read_b64_tr_b16 v[34:35], v4 offset:46080
    s_waitcnt lgkmcnt(6)
    v_mfma_f32_32x32x16_bf16 v[80:95], v[24:27], v[36:39], v[80:95]
    ds_read_b128 v[36:39], v5 offset:47104
    ds_read_b64_tr_b16 v[24:25], v4 offset:47104
    ds_read_b64_tr_b16 v[26:27], v4 offset:48128
    s_waitcnt lgkmcnt(6)
    v_mfma_f32_32x32x16_bf16 v[80:95], v[28:31], v[40:43], v[80:95]
    s_barrier
    ds_read_b128 v[40:43], v5 offset:49152
    ds_read_b64_tr_b16 v[28:29], v3 offset:57344
    ds_read_b64_tr_b16 v[30:31], v3 offset:58368
    s_waitcnt lgkmcnt(6)
    v_mfma_f32_32x32x16_bf16 v[80:95], v[32:35], v[44:47], v[80:95]
    ds_read_b128 v[44:47], v5 offset:51200
    ds_read_b64_tr_b16 v[32:33], v3 offset:59392
    ds_read_b64_tr_b16 v[34:35], v3 offset:60416
    s_waitcnt lgkmcnt(6)
    v_mfma_f32_32x32x16_bf16 v[80:95], v[24:27], v[36:39], v[80:95]
    ds_read_b128 v[36:39], v5 offset:53248
    ds_read_b64_tr_b16 v[24:25], v3 offset:61440
    ds_read_b64_tr_b16 v[26:27], v3 offset:62464
    s_waitcnt lgkmcnt(6)
    v_mfma_f32_32x32x16_bf16 v[80:95], v[28:31], v[40:43], v[80:95]
    ds_read_b128 v[40:43], v5 offset:55296
    ds_read_b64_tr_b16 v[28:29], v3 offset:63488
    ds_read_b64_tr_b16 v[30:31], v3 offset:64512
    s_waitcnt lgkmcnt(6)
    v_mfma_f32_32x32x16_bf16 v[80:95], v[32:35], v[44:47], v[80:95]
    s_barrier
    ds_read_b128 v[44:47], v5 offset:8192
    ds_read_b64_tr_b16 v[32:33], v4 offset:0
    ds_read_b64_tr_b16 v[34:35], v4 offset:1024
    s_waitcnt lgkmcnt(6)
    v_mfma_f32_32x32x16_bf16 v[80:95], v[24:27], v[36:39], v[80:95]
    ds_read_b128 v[36:39], v5 offset:10240
    ds_read_b64_tr_b16 v[24:25], v4 offset:2048
    ds_read_b64_tr_b16 v[26:27], v4 offset:3072
    s_waitcnt lgkmcnt(6)
    v_mfma_f32_32x32x16_bf16 v[80:95], v[28:31], v[40:43], v[80:95]
    ds_read_b128 v[40:43], v5 offset:12288
    ds_read_b64_tr_b16 v[28:29], v4 offset:4096
    ds_read_b64_tr_b16 v[30:31], v4 offset:5120
    s_waitcnt lgkmcnt(6)
    v_mfma_f32_32x32x16_bf16 v[80:95], v[32:35], v[44:47], v[80:95]
    ds_read_b128 v[44:47], v5 offset:14336
    ds_read_b64_tr_b16 v[32:33], v4 offset:6144
    ds_read_b64_tr_b16 v[34:35], v4 offset:7168
    s_waitcnt lgkmcnt(6)
    v_mfma_f32_32x32x16_bf16 v[80:95], v[24:27], v[36:39], v[80:95]
    s_barrier
    ds_read_b128 v[36:39], v5 offset:0
    ds_read_b64_tr_b16 v[24:25], v3 offset:24576
    ds_read_b64_tr_b16 v[26:27], v3 offset:25600
    s_waitcnt lgkmcnt(6)
    v_mfma_f32_32x32x16_bf16 v[80:95], v[28:31], v[40:43], v[80:95]
    ds_read_b128 v[40:43], v5 offset:2048
    ds_read_b64_tr_b16 v[28:29], v3 offset:26624
    ds_read_b64_tr_b16 v[30:31], v3 offset:27648
    s_waitcnt lgkmcnt(6)
    v_mfma_f32_32x32x16_bf16 v[80:95], v[32:35], v[44:47], v[80:95]
    ds_read_b128 v[44:47], v5 offset:4096
    ds_read_b64_tr_b16 v[32:33], v3 offset:28672
    ds_read_b64_tr_b16 v[34:35], v3 offset:29696
    s_waitcnt lgkmcnt(6)
    v_mfma_f32_32x32x16_bf16 v[80:95], v[24:27], v[36:39], v[80:95]
    ds_read_b128 v[36:39], v5 offset:6144
    ds_read_b64_tr_b16 v[24:25], v3 offset:30720
    ds_read_b64_tr_b16 v[26:27], v3 offset:31744
    s_waitcnt lgkmcnt(6)
    v_mfma_f32_32x32x16_bf16 v[80:95], v[28:31], v[40:43], v[80:95]
    s_barrier
    ds_read_b128 v[40:43], v10 offset:8192
    ds_read_b64_tr_b16 v[28:29], v4 offset:16384
    ds_read_b64_tr_b16 v[30:31], v4 offset:17408
    s_waitcnt lgkmcnt(6)
    v_mfma_f32_32x32x16_bf16 v[80:95], v[32:35], v[44:47], v[80:95]
    ds_read_b128 v[44:47], v10 offset:10240
    ds_read_b64_tr_b16 v[32:33], v4 offset:18432
    ds_read_b64_tr_b16 v[34:35], v4 offset:19456
    s_waitcnt lgkmcnt(6)
    v_mfma_f32_32x32x16_bf16 v[80:95], v[24:27], v[36:39], v[80:95]
    ds_read_b128 v[36:39], v10 offset:12288
    ds_read_b64_tr_b16 v[24:25], v4 offset:20480
    ds_read_b64_tr_b16 v[26:27], v4 offset:21504
    s_waitcnt lgkmcnt(6)
    v_mfma_f32_32x32x16_bf16 v[80:95], v[28:31], v[40:43], v[80:95]
    ds_read_b128 v[40:43], v10 offset:14336
    ds_read_b64_tr_b16 v[28:29], v4 offset:22528
    ds_read_b64_tr_b16 v[30:31], v4 offset:23552
    s_waitcnt lgkmcnt(6)
    v_mfma_f32_32x32x16_bf16 v[80:95], v[32:35], v[44:47], v[80:95]
    s_barrier
    ds_read_b128 v[44:47], v5 offset:16384
    ds_read_b64_tr_b16 v[32:33], v4 offset:24576
    ds_read_b64_tr_b16 v[34:35], v4 offset:25600
    s_waitcnt lgkmcnt(6)
    v_mfma_f32_32x32x16_bf16 v[80:95], v[24:27], v[36:39], v[80:95]
    ds_read_b128 v[36:39], v5 offset:18432
    ds_read_b64_tr_b16 v[24:25], v4 offset:26624
    ds_read_b64_tr_b16 v[26:27], v4 offset:27648
    s_waitcnt lgkmcnt(6)
    v_mfma_f32_32x32x16_bf16 v[80:95], v[28:31], v[40:43], v[80:95]
    ds_read_b128 v[40:43], v5 offset:20480
    ds_read_b64_tr_b16 v[28:29], v4 offset:28672
    ds_read_b64_tr_b16 v[30:31], v4 offset:29696
    s_waitcnt lgkmcnt(6)
    v_mfma_f32_32x32x16_bf16 v[80:95], v[32:35], v[44:47], v[80:95]
    ds_read_b128 v[44:47], v5 offset:22528
    ds_read_b64_tr_b16 v[32:33], v4 offset:30720
    ds_read_b64_tr_b16 v[34:35], v4 offset:31744
    s_waitcnt lgkmcnt(6)
    v_mfma_f32_32x32x16_bf16 v[80:95], v[24:27], v[36:39], v[80:95]
    s_barrier
    ds_read_b128 v[36:39], v5 offset:32768
    ds_read_b64_tr_b16 v[24:25], v4 offset:32768
    ds_read_b64_tr_b16 v[26:27], v4 offset:33792
    s_waitcnt lgkmcnt(6)
    v_mfma_f32_32x32x16_bf16 v[80:95], v[28:31], v[40:43], v[80:95]
    ds_read_b128 v[40:43], v5 offset:34816
    ds_read_b64_tr_b16 v[28:29], v4 offset:34816
    ds_read_b64_tr_b16 v[30:31], v4 offset:35840
    s_waitcnt lgkmcnt(6)
    v_mfma_f32_32x32x16_bf16 v[80:95], v[32:35], v[44:47], v[80:95]
    ds_read_b128 v[44:47], v5 offset:36864
    ds_read_b64_tr_b16 v[32:33], v4 offset:36864
    ds_read_b64_tr_b16 v[34:35], v4 offset:37888
    s_waitcnt lgkmcnt(6)
    v_mfma_f32_32x32x16_bf16 v[80:95], v[24:27], v[36:39], v[80:95]
    ds_read_b128 v[36:39], v5 offset:38912
    ds_read_b64_tr_b16 v[24:25], v4 offset:38912
    ds_read_b64_tr_b16 v[26:27], v4 offset:39936
    s_waitcnt lgkmcnt(6)
    v_mfma_f32_32x32x16_bf16 v[80:95], v[28:31], v[40:43], v[80:95]
    s_barrier
    ds_read_b128 v[40:43], v5 offset:40960
    ds_read_b64_tr_b16 v[28:29], v4 offset:40960
    ds_read_b64_tr_b16 v[30:31], v4 offset:41984
    s_waitcnt lgkmcnt(6)
    v_mfma_f32_32x32x16_bf16 v[80:95], v[32:35], v[44:47], v[80:95]
    ds_read_b128 v[44:47], v5 offset:43008
    ds_read_b64_tr_b16 v[32:33], v4 offset:43008
    ds_read_b64_tr_b16 v[34:35], v4 offset:44032
    s_waitcnt lgkmcnt(6)
    v_mfma_f32_32x32x16_bf16 v[80:95], v[24:27], v[36:39], v[80:95]
    ds_read_b128 v[36:39], v5 offset:45056
    ds_read_b64_tr_b16 v[24:25], v4 offset:45056
    ds_read_b64_tr_b16 v[26:27], v4 offset:46080
    s_waitcnt lgkmcnt(6)
    v_mfma_f32_32x32x16_bf16 v[80:95], v[28:31], v[40:43], v[80:95]
    ds_read_b128 v[40:43], v5 offset:47104
    ds_read_b64_tr_b16 v[28:29], v4 offset:47104
    ds_read_b64_tr_b16 v[30:31], v4 offset:48128
    s_waitcnt lgkmcnt(6)
    v_mfma_f32_32x32x16_bf16 v[80:95], v[32:35], v[44:47], v[80:95]
    s_barrier
    ds_read_b128 v[44:47], v5 offset:49152
    ds_read_b64_tr_b16 v[32:33], v3 offset:57344
    ds_read_b64_tr_b16 v[34:35], v3 offset:58368
    s_waitcnt lgkmcnt(6)
    v_mfma_f32_32x32x16_bf16 v[80:95], v[24:27], v[36:39], v[80:95]
    ds_read_b128 v[36:39], v5 offset:51200
    ds_read_b64_tr_b16 v[24:25], v3 offset:59392
    ds_read_b64_tr_b16 v[26:27], v3 offset:60416
    s_waitcnt lgkmcnt(6)
    v_mfma_f32_32x32x16_bf16 v[80:95], v[28:31], v[40:43], v[80:95]
    s_waitcnt lgkmcnt(3)
    v_mfma_f32_32x32x16_bf16 v[80:95], v[32:35], v[44:47], v[80:95]
    s_waitcnt lgkmcnt(0)
    v_mfma_f32_32x32x16_bf16 v[80:95], v[24:27], v[36:39], v[80:95]
    s_nop 11
    s_nop 0
    v_pk_fma_f32 v[64:65], v[80:81], v[50:51], v[64:65] op_sel_hi:[1,0,1]
    v_pk_fma_f32 v[66:67], v[82:83], v[50:51], v[66:67] op_sel_hi:[1,0,1]
    v_pk_fma_f32 v[68:69], v[84:85], v[50:51], v[68:69] op_sel_hi:[1,0,1]
    v_pk_fma_f32 v[70:71], v[86:87], v[50:51], v[70:71] op_sel_hi:[1,0,1]
    v_pk_fma_f32 v[72:73], v[88:89], v[50:51], v[72:73] op_sel_hi:[1,0,1]
    v_pk_fma_f32 v[74:75], v[90:91], v[50:51], v[74:75] op_sel_hi:[1,0,1]
    v_pk_fma_f32 v[76:77], v[92:93], v[50:51], v[76:77] op_sel_hi:[1,0,1]
    v_pk_fma_f32 v[78:79], v[94:95], v[50:51], v[78:79] op_sel_hi:[1,0,1]
    v_cvt_pk_bf16_f32 v36, v64, v65
    v_cvt_pk_bf16_f32 v37, v66, v67
    v_cvt_pk_bf16_f32 v38, v68, v69
    v_cvt_pk_bf16_f32 v39, v70, v71
    v_cvt_pk_bf16_f32 v40, v72, v73
    v_cvt_pk_bf16_f32 v41, v74, v75
    v_cvt_pk_bf16_f32 v42, v76, v77
    v_cvt_pk_bf16_f32 v43, v78, v79
    v_permlane32_swap_b32 v36, v38
    v_permlane32_swap_b32 v37, v39
    v_permlane32_swap_b32 v40, v42
    v_permlane32_swap_b32 v41, v43
    ds_write_b128 v52, v[36:39]
    ds_write_b128 v53, v[40:43]
    s_waitcnt lgkmcnt(0)
    s_barrier
    ds_read_b128 v[56:59], v54
    ds_read_b128 v[60:63], v54 offset:1024
    s_waitcnt lgkmcnt(1)
    buffer_store_dwordx4 v[56:59], v48, s[40:43], s11 offen
    s_waitcnt lgkmcnt(0)
    buffer_store_dwordx4 v[60:63], v49, s[40:43], s11 offen
    s_endpgm
L_fb:
    s_mov_b32 s50, 0
L_fb_head:
    s_cmp_eq_u32 s50, 0
    s_cselect_b64 vcc, s[96:97], s[98:99]
    s_cmp_eq_u64 vcc, 0
    s_cbranch_scc1 L_fb_next
    s_cmp_eq_u32 s50, 0
    s_cselect_b64 vcc, -1, 0
    v_cndmask_b32 v40, v124, v120, vcc
    v_cndmask_b32 v41, v125, v121, vcc
    v_cndmask_b32 v42, v126, v122, vcc
    v_cndmask_b32 v43, v127, v123, vcc
    v_and_b32 v46, 4095, v7
    v_and_b32 v47, 4095, v9
    v_mov_b32 v19, 0x3f803f80
    s_add_u32 s47, s58, 0
    s_lshr_b32 s48, s47, 1
    s_lshl_b32 s48, s48, 17
    s_and_b32 s47, s47, 1
    s_lshl_b32 s47, s47, 12
    s_add_u32 s47, s47, s48
    s_add_u32 s47, s47, s5
    s_sub_u32 s47, s47, 524288
    s_lshl_b32 s48, s28, 17
    s_sub_u32 s48, s5, s48
    s_cmp_le_u32 s12, 0
    s_cselect_b32 s47, s47, s48
    s_cselect_b32 s48, -1, 0xe00
    s_cselect_b32 s49, -1, 0
    s_cselect_b64 vcc, -1, 0
    s_add_u32 s47, s47, s50
    v_and_b32 v44, s48, v46
    v_mov_b32 v45, 0x80000000
    v_cndmask_b32 v45, v45, v47, vcc
    v_and_b32 v164, s49, v19
    v_mov_b32 v165, v164
    v_mov_b32 v166, v164
    v_mov_b32 v167, v164
    v_mov_b32 v168, v164
    v_mov_b32 v169, v164
    v_mov_b32 v170, v164
    v_mov_b32 v171, v164
    buffer_load_dwordx4 v[128:131], v44, s[36:39], s47 offen sc1
    s_mov_b64 exec, s[54:55]
    buffer_load_dwordx4 v[164:167], v45, s[36:39], s47 offen sc1
    buffer_load_dwordx4 v[168:171], v45, s[36:39], s47 offen offset:512 sc1
    s_mov_b64 exec, -1
    s_add_u32 s47, s58, 1
    s_lshr_b32 s48, s47, 1
    s_lshl_b32 s48, s48, 17
    s_and_b32 s47, s47, 1
    s_lshl_b32 s47, s47, 12
    s_add_u32 s47, s47, s48
    s_add_u32 s47, s47, s5
    s_sub_u32 s47, s47, 524288
    s_lshl_b32 s48, s28, 17
    s_sub_u32 s48, s5, s48
    s_cmp_le_u32 s12, 1
    s_cselect_b32 s47, s47, s48
    s_cselect_b32 s48, -1, 0xe00
    s_cselect_b32 s49, -1, 0
    s_cselect_b64 vcc, -1, 0
    s_add_u32 s47, s47, s50
    v_and_b32 v44, s48, v46
    v_mov_b32 v45, 0x80000000
    v_cndmask_b32 v45, v45, v47, vcc
    v_and_b32 v172, s49, v19
    v_mov_b32 v173, v172
    v_mov_b32 v174, v172
    v_mov_b32 v175, v172
    v_mov_b32 v176, v172
    v_mov_b32 v177, v172
    v_mov_b32 v178, v172
    v_mov_b32 v179, v172
    buffer_load_dwordx4 v[132:135], v44, s[36:39], s47 offen sc1
    s_mov_b64 exec, s[54:55]
    buffer_load_dwordx4 v[172:175], v45, s[36:39], s47 offen sc1
    buffer_load_dwordx4 v[176:179], v45, s[36:39], s47 offen offset:512 sc1
    s_mov_b64 exec, -1
    s_add_u32 s47, s58, 2
    s_lshr_b32 s48, s47, 1
    s_lshl_b32 s48, s48, 17
    s_and_b32 s47, s47, 1
    s_lshl_b32 s47, s47, 12
    s_add_u32 s47, s47, s48
    s_add_u32 s47, s47, s5
    s_sub_u32 s47, s47, 524288
    s_lshl_b32 s48, s28, 17
    s_sub_u32 s48, s5, s48
    s_cmp_le_u32 s12, 2
    s_cselect_b32 s47, s47, s48
    s_cselect_b32 s48, -1, 0xe00
    s_cselect_b32 s49, -1, 0
    s_cselect_b64 vcc, -1, 0
    s_add_u32 s47, s47, s50
    v_and_b32 v44, s48, v46
    v_mov_b32 v45, 0x80000000
    v_cndmask_b32 v45, v45, v47, vcc
    v_and_b32 v180, s49, v19
    v_mov_b32 v181, v180
    v_mov_b32 v182, v180
    v_mov_b32 v183, v180
    v_mov_b32 v184, v180
    v_mov_b32 v185, v180
    v_mov_b32 v186, v180
    v_mov_b32 v187, v180
    buffer_load_dwordx4 v[136:139], v44, s[36:39], s47 offen sc1
    s_mov_b64 exec, s[54:55]
    buffer_load_dwordx4 v[180:183], v45, s[36:39], s47 offen sc1
    buffer_load_dwordx4 v[184:187], v45, s[36:39], s47 offen offset:512 sc1
    s_mov_b64 exec, -1
    s_add_u32 s47, s58, 3
    s_lshr_b32 s48, s47, 1
    s_lshl_b32 s48, s48, 17
    s_and_b32 s47, s47, 1
    s_lshl_b32 s47, s47, 12
    s_add_u32 s47, s47, s48
    s_add_u32 s47, s47, s5
    s_sub_u32 s47, s47, 524288
    s_lshl_b32 s48, s28, 17
    s_sub_u32 s48, s5, s48
    s_cmp_le_u32 s12, 3
    s_cselect_b32 s47, s47, s48
    s_cselect_b32 s48, -1, 0xe00
    s_cselect_b32 s49, -1, 0
    s_cselect_b64 vcc, -1, 0
    s_add_u32 s47, s47, s50
    v_and_b32 v44, s48, v46
    v_mov_b32 v45, 0x80000000
    v_cndmask_b32 v45, v45, v47, vcc
    v_and_b32 v188, s49, v19
    v_mov_b32 v189, v188
    v_mov_b32 v190, v188
    v_mov_b32 v191, v188
    v_mov_b32 v192, v188
    v_mov_b32 v193, v188
    v_mov_b32 v194, v188
    v_mov_b32 v195, v188
    buffer_load_dwordx4 v[140:143], v44, s[36:39], s47 offen sc1
    s_mov_b64 exec, s[54:55]
    buffer_load_dwordx4 v[188:191], v45, s[36:39], s47 offen sc1
    buffer_load_dwordx4 v[192:195], v45, s[36:39], s47 offen offset:512 sc1
    s_mov_b64 exec, -1
    s_add_u32 s47, s58, 4
    s_lshr_b32 s48, s47, 1
    s_lshl_b32 s48, s48, 17
    s_and_b32 s47, s47, 1
    s_lshl_b32 s47, s47, 12
    s_add_u32 s47, s47, s48
    s_add_u32 s47, s47, s5
    s_sub_u32 s47, s47, 524288
    s_lshl_b32 s48, s28, 17
    s_sub_u32 s48, s5, s48
    s_cmp_le_u32 s12, 4
    s_cselect_b32 s47, s47, s48
    s_cselect_b32 s48, -1, 0xe00
    s_cselect_b32 s49, -1, 0
    s_cselect_b64 vcc, -1, 0
    s_add_u32 s47, s47, s50
    v_and_b32 v44, s48, v46
    v_mov_b32 v45, 0x80000000
    v_cndmask_b32 v45, v45, v47, vcc
    v_and_b32 v196, s49, v19
    v_mov_b32 v197, v196
    v_mov_b32 v198, v196
    v_mov_b32 v199, v196
    v_mov_b32 v200, v196
    v_mov_b32 v201, v196
    v_mov_b32 v202, v196
    v_mov_b32 v203, v196
    buffer_load_dwordx4 v[144:147], v44, s[36:39], s47 offen sc1
    s_mov_b64 exec, s[54:55]
    buffer_load_dwordx4 v[196:199], v45, s[36:39], s47 offen sc1
    buffer_load_dwordx4 v[200:203], v45, s[36:39], s47 offen offset:512 sc1
    s_mov_b64 exec, -1
    s_add_u32 s47, s58, 5
    s_lshr_b32 s48, s47, 1
    s_lshl_b32 s48, s48, 17
    s_and_b32 s47, s47, 1
    s_lshl_b32 s47, s47, 12
    s_add_u32 s47, s47, s48
    s_add_u32 s47, s47, s5
    s_sub_u32 s47, s47, 524288
    s_lshl_b32 s48, s28, 17
    s_sub_u32 s48, s5, s48
    s_cmp_le_u32 s12, 5
    s_cselect_b32 s47, s47, s48
    s_cselect_b32 s48, -1, 0xe00
    s_cselect_b32 s49, -1, 0
    s_cselect_b64 vcc, -1, 0
    s_add_u32 s47, s47, s50
    v_and_b32 v44, s48, v46
    v_mov_b32 v45, 0x80000000
    v_cndmask_b32 v45, v45, v47, vcc
    v_and_b32 v204, s49, v19
    v_mov_b32 v205, v204
    v_mov_b32 v206, v204
    v_mov_b32 v207, v204
    v_mov_b32 v208, v204
    v_mov_b32 v209, v204
    v_mov_b32 v210, v204
    v_mov_b32 v211, v204
    buffer_load_dwordx4 v[148:151], v44, s[36:39], s47 offen sc1
    s_mov_b64 exec, s[54:55]
    buffer_load_dwordx4 v[204:207], v45, s[36:39], s47 offen sc1
    buffer_load_dwordx4 v[208:211], v45, s[36:39], s47 offen offset:512 sc1
    s_mov_b64 exec, -1
    s_add_u32 s47, s58, 6
    s_lshr_b32 s48, s47, 1
    s_lshl_b32 s48, s48, 17
    s_and_b32 s47, s47, 1
    s_lshl_b32 s47, s47, 12
    s_add_u32 s47, s47, s48
    s_add_u32 s47, s47, s5
    s_sub_u32 s47, s47, 524288
    s_lshl_b32 s48, s28, 17
    s_sub_u32 s48, s5, s48
    s_cmp_le_u32 s12, 6
    s_cselect_b32 s47, s47, s48
    s_cselect_b32 s48, -1, 0xe00
    s_cselect_b32 s49, -1, 0
    s_cselect_b64 vcc, -1, 0
    s_add_u32 s47, s47, s50
    v_and_b32 v44, s48, v46
    v_mov_b32 v45, 0x80000000
    v_cndmask_b32 v45, v45, v47, vcc
    v_and_b32 v212, s49, v19
    v_mov_b32 v213, v212
    v_mov_b32 v214, v212
    v_mov_b32 v215, v212
    v_mov_b32 v216, v212
    v_mov_b32 v217, v212
    v_mov_b32 v218, v212
    v_mov_b32 v219, v212
    buffer_load_dwordx4 v[152:155], v44, s[36:39], s47 offen sc1
    s_mov_b64 exec, s[54:55]
    buffer_load_dwordx4 v[212:215], v45, s[36:39], s47 offen sc1
    buffer_load_dwordx4 v[216:219], v45, s[36:39], s47 offen offset:512 sc1
    s_mov_b64 exec, -1
    s_add_u32 s47, s58, 7
    s_lshr_b32 s48, s47, 1
    s_lshl_b32 s48, s48, 17
    s_and_b32 s47, s47, 1
    s_lshl_b32 s47, s47, 12
    s_add_u32 s47, s47, s48
    s_add_u32 s47, s47, s5
    s_sub_u32 s47, s47, 524288
    s_lshl_b32 s48, s28, 17
    s_sub_u32 s48, s5, s48
    s_cmp_le_u32 s12, 7
    s_cselect_b32 s47, s47, s48
    s_cselect_b32 s48, -1, 0xe00
    s_cselect_b32 s49, -1, 0
    s_cselect_b64 vcc, -1, 0
    s_add_u32 s47, s47, s50
    v_and_b32 v44, s48, v46
    v_mov_b32 v45, 0x80000000
    v_cndmask_b32 v45, v45, v47, vcc
    v_and_b32 v220, s49, v19
    v_mov_b32 v221, v220
    v_mov_b32 v222, v220
    v_mov_b32 v223, v220
    v_mov_b32 v224, v220
    v_mov_b32 v225, v220
    v_mov_b32 v226, v220
    v_mov_b32 v227, v220
    buffer_load_dwordx4 v[156:159], v44, s[36:39], s47 offen sc1
    s_mov_b64 exec, s[54:55]
    buffer_load_dwordx4 v[220:223], v45, s[36:39], s47 offen sc1
    buffer_load_dwordx4 v[224:227], v45, s[36:39], s47 offen offset:512 sc1
    s_mov_b64 exec, -1
    s_add_u32 s47, s58, 8
    s_lshr_b32 s48, s47, 1
    s_lshl_b32 s48, s48, 17
    s_and_b32 s47, s47, 1
    s_lshl_b32 s47, s47, 12
    s_add_u32 s47, s47, s48
    s_add_u32 s47, s47, s5
    s_sub_u32 s47, s47, 524288
    s_lshl_b32 s48, s28, 17
    s_sub_u32 s48, s5, s48
    s_cmp_le_u32 s12, 8
    s_cselect_b32 s47, s47, s48
    s_cselect_b32 s48, -1, 0xe00
    s_cselect_b32 s49, -1, 0
    s_cselect_b64 vcc, -1, 0
    s_add_u32 s47, s47, s50
    v_and_b32 v44, s48, v46
    v_mov_b32 v45, 0x80000000
    v_cndmask_b32 v45, v45, v47, vcc
    v_and_b32 v228, s49, v19
    v_mov_b32 v229, v228
    v_mov_b32 v230, v228
    v_mov_b32 v231, v228
    v_mov_b32 v232, v228
    v_mov_b32 v233, v228
    v_mov_b32 v234, v228
    v_mov_b32 v235, v228
    buffer_load_dwordx4 v[160:163], v44, s[36:39], s47 offen sc1
    s_mov_b64 exec, s[54:55]
    buffer_load_dwordx4 v[228:231], v45, s[36:39], s47 offen sc1
    buffer_load_dwordx4 v[232:235], v45, s[36:39], s47 offen offset:512 sc1
    s_mov_b64 exec, -1
    s_waitcnt vmcnt(0)
    v_mfma_f32_32x32x16_bf16 v[64:79], v[128:131], v[40:43], 0
    v_mfma_f32_32x32x16_bf16 v[236:251], v[160:163], v[40:43], 0
    s_nop 11
    v_cndmask_b32 v64, v236, v64, s[60:61]
    v_cndmask_b32 v65, v237, v65, s[62:63]
    v_cndmask_b32 v66, v238, v66, s[64:65]
    v_cndmask_b32 v67, v239, v67, s[66:67]
    v_cndmask_b32 v68, v240, v68, s[68:69]
    v_cndmask_b32 v69, v241, v69, s[70:71]
    v_cndmask_b32 v70, v242, v70, s[72:73]
    v_cndmask_b32 v71, v243, v71, s[74:75]
    v_cndmask_b32 v72, v244, v72, s[76:77]
    v_cndmask_b32 v73, v245, v73, s[78:79]
    v_cndmask_b32 v74, v246, v74, s[80:81]
    v_cndmask_b32 v75, v247, v75, s[82:83]
    v_cndmask_b32 v76, v248, v76, s[84:85]
    v_cndmask_b32 v77, v249, v77, s[86:87]
    v_cndmask_b32 v78, v250, v78, s[88:89]
    v_cndmask_b32 v79, v251, v79, s[90:91]
    v_max_f32_e64 v16, v64, v65
    v_max3_f32 v16, v66, v67, v16
    v_max3_f32 v16, v68, v69, v16
    v_max3_f32 v16, v70, v71, v16
    v_max3_f32 v16, v72, v73, v16
    v_max3_f32 v16, v74, v75, v16
    v_max3_f32 v16, v76, v77, v16
    v_max3_f32 v16, v78, v79, v16
    v_mfma_f32_32x32x16_bf16 v[236:251], v[132:135], v[40:43], 0
    s_nop 11
    s_nop 0
    v_max3_f32 v16, v236, v237, v16
    v_max3_f32 v16, v238, v239, v16
    v_max3_f32 v16, v240, v241, v16
    v_max3_f32 v16, v242, v243, v16
    v_max3_f32 v16, v244, v245, v16
    v_max3_f32 v16, v246, v247, v16
    v_max3_f32 v16, v248, v249, v16
    v_max3_f32 v16, v250, v251, v16
    v_mfma_f32_32x32x16_bf16 v[236:251], v[136:139], v[40:43], 0
    s_nop 11
    s_nop 0
    v_max3_f32 v16, v236, v237, v16
    v_max3_f32 v16, v238, v239, v16
    v_max3_f32 v16, v240, v241, v16
    v_max3_f32 v16, v242, v243, v16
    v_max3_f32 v16, v244, v245, v16
    v_max3_f32 v16, v246, v247, v16
    v_max3_f32 v16, v248, v249, v16
    v_max3_f32 v16, v250, v251, v16
    v_mfma_f32_32x32x16_bf16 v[236:251], v[140:143], v[40:43], 0
    s_nop 11
    s_nop 0
    v_max3_f32 v16, v236, v237, v16
    v_max3_f32 v16, v238, v239, v16
    v_max3_f32 v16, v240, v241, v16
    v_max3_f32 v16, v242, v243, v16
    v_max3_f32 v16, v244, v245, v16
    v_max3_f32 v16, v246, v247, v16
    v_max3_f32 v16, v248, v249, v16
    v_max3_f32 v16, v250, v251, v16
    v_mfma_f32_32x32x16_bf16 v[236:251], v[144:147], v[40:43], 0
    s_nop 11
    s_nop 0
    v_max3_f32 v16, v236, v237, v16
    v_max3_f32 v16, v238, v239, v16
    v_max3_f32 v16, v240, v241, v16
    v_max3_f32 v16, v242, v243, v16
    v_max3_f32 v16, v244, v245, v16
    v_max3_f32 v16, v246, v247, v16
    v_max3_f32 v16, v248, v249, v16
    v_max3_f32 v16, v250, v251, v16
    v_mfma_f32_32x32x16_bf16 v[236:251], v[148:151], v[40:43], 0
    s_nop 11
    s_nop 0
    v_max3_f32 v16, v236, v237, v16
    v_max3_f32 v16, v238, v239, v16
    v_max3_f32 v16, v240, v241, v16
    v_max3_f32 v16, v242, v243, v16
    v_max3_f32 v16, v244, v245, v16
    v_max3_f32 v16, v246, v247, v16
    v_max3_f32 v16, v248, v249, v16
    v_max3_f32 v16, v250, v251, v16
    v_mfma_f32_32x32x16_bf16 v[236:251], v[152:155], v[40:43], 0
    s_nop 11
    s_nop 0
    v_max3_f32 v16, v236, v237, v16
    v_max3_f32 v16, v238, v239, v16
    v_max3_f32 v16, v240, v241, v16
    v_max3_f32 v16, v242, v243, v16
    v_max3_f32 v16, v244, v245, v16
    v_max3_f32 v16, v246, v247, v16
    v_max3_f32 v16, v248, v249, v16
    v_max3_f32 v16, v250, v251, v16
    v_mfma_f32_32x32x16_bf16 v[236:251], v[156:159], v[40:43], 0
    s_nop 11
    s_nop 0
    v_max3_f32 v16, v236, v237, v16
    v_max3_f32 v16, v238, v239, v16
    v_max3_f32 v16, v240, v241, v16
    v_max3_f32 v16, v242, v243, v16
    v_max3_f32 v16, v244, v245, v16
    v_max3_f32 v16, v246, v247, v16
    v_max3_f32 v16, v248, v249, v16
    v_max3_f32 v16, v250, v251, v16
    v_mov_b32 v17, v16
    s_nop 1
    v_permlane32_swap_b32 v16, v17
    v_min_f32_e64 v24, -v16, -v17
    v_mov_b32 v25, v24
    v_mov_b32 v26, v24
    v_mov_b32 v27, v24
    v_mov_b32 v28, v24
    v_mov_b32 v29, v24
    v_mov_b32 v30, v24
    v_mov_b32 v31, v24
    v_mov_b32 v32, v24
    v_mov_b32 v33, v24
    v_mov_b32 v34, v24
    v_mov_b32 v35, v24
    v_mov_b32 v36, v24
    v_mov_b32 v37, v24
    v_mov_b32 v38, v24
    v_mov_b32 v39, v24
    v_add_f32 v64, v64, v24
    v_add_f32 v65, v65, v24
    v_add_f32 v66, v66, v24
    v_add_f32 v67, v67, v24
    v_add_f32 v68, v68, v24
    v_add_f32 v69, v69, v24
    v_add_f32 v70, v70, v24
    v_add_f32 v71, v71, v24
    v_add_f32 v72, v72, v24
    v_add_f32 v73, v73, v24
    v_add_f32 v74, v74, v24
    v_add_f32 v75, v75, v24
    v_add_f32 v76, v76, v24
    v_add_f32 v77, v77, v24
    v_add_f32 v78, v78, v24
    v_add_f32 v79, v79, v24
    v_exp_f32 v64, v64
    v_exp_f32 v65, v65
    v_exp_f32 v66, v66
    v_exp_f32 v67, v67
    v_exp_f32 v68, v68
    v_exp_f32 v69, v69
    v_exp_f32 v70, v70
    v_exp_f32 v71, v71
    v_exp_f32 v72, v72
    v_exp_f32 v73, v73
    v_exp_f32 v74, v74
    v_exp_f32 v75, v75
    v_exp_f32 v76, v76
    v_exp_f32 v77, v77
    v_exp_f32 v78, v78
    v_exp_f32 v79, v79
    v_cvt_pk_bf16_f32 v64, v64, v65
    v_cvt_pk_bf16_f32 v65, v66, v67
    v_cvt_pk_bf16_f32 v66, v68, v69
    v_cvt_pk_bf16_f32 v67, v70, v71
    v_cvt_pk_bf16_f32 v68, v72, v73
    v_cvt_pk_bf16_f32 v69, v74, v75
    v_cvt_pk_bf16_f32 v70, v76, v77
    v_cvt_pk_bf16_f32 v71, v78, v79
    v_and_b32 v72, v64, v20
    v_and_b32 v73, v65, v21
    v_and_b32 v74, v66, v22
    v_and_b32 v75, v67, v23
    v_and_b32 v76, v68, v252
    v_and_b32 v77, v69, v253
    v_and_b32 v78, v70, v254
    v_and_b32 v79, v71, v255
    v_xor_b32 v64, v64, v72
    v_xor_b32 v65, v65, v73
    v_xor_b32 v66, v66, v74
    v_xor_b32 v67, v67, v75
    v_xor_b32 v68, v68, v76
    v_xor_b32 v69, v69, v77
    v_xor_b32 v70, v70, v78
    v_xor_b32 v71, v71, v79
    v_mfma_f32_32x32x16_bf16 v[48:63], v[164:167], v[72:75], 0
    v_mfma_f32_32x32x16_bf16 v[48:63], v[168:171], v[76:79], v[48:63]
    v_mfma_f32_32x32x16_bf16 v[48:63], v[228:231], v[64:67], v[48:63]
    v_mfma_f32_32x32x16_bf16 v[48:63], v[232:235], v[68:71], v[48:63]
    v_mfma_f32_32x32x16_bf16 v[236:251], v[132:135], v[40:43], v[24:39]
    s_nop 11
    v_exp_f32 v236, v236
    v_exp_f32 v237, v237
    v_exp_f32 v238, v238
    v_exp_f32 v239, v239
    v_exp_f32 v240, v240
    v_exp_f32 v241, v241
    v_exp_f32 v242, v242
    v_exp_f32 v243, v243
    v_exp_f32 v244, v244
    v_exp_f32 v245, v245
    v_exp_f32 v246, v246
    v_exp_f32 v247, v247
    v_exp_f32 v248, v248
    v_exp_f32 v249, v249
    v_exp_f32 v250, v250
    v_exp_f32_e64 v251, v251
    v_cvt_pk_bf16_f32 v236, v236, v237
    v_cvt_pk_bf16_f32 v237, v238, v239
    v_cvt_pk_bf16_f32 v238, v240, v241
    v_cvt_pk_bf16_f32 v239, v242, v243
    v_cvt_pk_bf16_f32 v240, v244, v245
    v_cvt_pk_bf16_f32 v241, v246, v247
    v_cvt_pk_bf16_f32 v242, v248, v249
    v_cvt_pk_bf16_f32 v243, v250, v251
    v_mfma_f32_32x32x16_bf16 v[48:63], v[172:175], v[236:239], v[48:63]
    s_nop 0
    v_mfma_f32_32x32x16_bf16 v[48:63], v[176:179], v[240:243], v[48:63]
    v_mfma_f32_32x32x16_bf16 v[236:251], v[136:139], v[40:43], v[24:39]
    s_nop 11
    v_exp_f32 v236, v236
    v_exp_f32 v237, v237
    v_exp_f32 v238, v238
    v_exp_f32 v239, v239
    v_exp_f32 v240, v240
    v_exp_f32 v241, v241
    v_exp_f32 v242, v242
    v_exp_f32 v243, v243
    v_exp_f32 v244, v244
    v_exp_f32 v245, v245
    v_exp_f32 v246, v246
    v_exp_f32 v247, v247
    v_exp_f32 v248, v248
    v_exp_f32 v249, v249
    v_exp_f32 v250, v250
    v_exp_f32 v251, v251
    v_cvt_pk_bf16_f32 v236, v236, v237
    v_cvt_pk_bf16_f32 v237, v238, v239
    v_cvt_pk_bf16_f32 v238, v240, v241
    v_cvt_pk_bf16_f32 v239, v242, v243
    v_cvt_pk_bf16_f32 v240, v244, v245
    v_cvt_pk_bf16_f32 v241, v246, v247
    v_cvt_pk_bf16_f32 v242, v248, v249
    v_cvt_pk_bf16_f32 v243, v250, v251
    v_mfma_f32_32x32x16_bf16 v[48:63], v[180:183], v[236:239], v[48:63]
    s_nop 0
    v_mfma_f32_32x32x16_bf16 v[48:63], v[184:187], v[240:243], v[48:63]
    v_mfma_f32_32x32x16_bf16 v[236:251], v[140:143], v[40:43], v[24:39]
    s_nop 11
    v_exp_f32 v236, v236
    v_exp_f32 v237, v237
    v_exp_f32 v238, v238
    v_exp_f32 v239, v239
    v_exp_f32 v240, v240
    v_exp_f32 v241, v241
    v_exp_f32 v242, v242
    v_exp_f32 v243, v243
    v_exp_f32 v244, v244
    v_exp_f32 v245, v245
    v_exp_f32 v246, v246
    v_exp_f32 v247, v247
    v_exp_f32 v248, v248
    v_exp_f32 v249, v249
    v_exp_f32 v250, v250
    v_exp_f32 v251, v251
    v_cvt_pk_bf16_f32 v236, v236, v237
    v_cvt_pk_bf16_f32 v237, v238, v239
    v_cvt_pk_bf16_f32 v238, v240, v241
    v_cvt_pk_bf16_f32 v239, v242, v243
    v_cvt_pk_bf16_f32 v240, v244, v245
    v_cvt_pk_bf16_f32 v241, v246, v247
    v_cvt_pk_bf16_f32 v242, v248, v249
    v_cvt_pk_bf16_f32 v243, v250, v251
    v_mfma_f32_32x32x16_bf16 v[48:63], v[188:191], v[236:239], v[48:63]
    s_nop 0
    v_mfma_f32_32x32x16_bf16 v[48:63], v[192:195], v[240:243], v[48:63]
    v_mfma_f32_32x32x16_bf16 v[236:251], v[144:147], v[40:43], v[24:39]
    s_nop 11
    v_exp_f32 v236, v236
    v_exp_f32 v237, v237
    v_exp_f32 v238, v238
    v_exp_f32 v239, v239
    v_exp_f32 v240, v240
    v_exp_f32 v241, v241
    v_exp_f32 v242, v242
    v_exp_f32 v243, v243
    v_exp_f32 v244, v244
    v_exp_f32 v245, v245
    v_exp_f32 v246, v246
    v_exp_f32 v247, v247
    v_exp_f32 v248, v248
    v_exp_f32 v249, v249
    v_exp_f32 v250, v250
    v_exp_f32 v251, v251
    v_cvt_pk_bf16_f32 v236, v236, v237
    v_cvt_pk_bf16_f32 v237, v238, v239
    v_cvt_pk_bf16_f32 v238, v240, v241
    v_cvt_pk_bf16_f32 v239, v242, v243
    v_cvt_pk_bf16_f32 v240, v244, v245
    v_cvt_pk_bf16_f32 v241, v246, v247
    v_cvt_pk_bf16_f32 v242, v248, v249
    v_cvt_pk_bf16_f32 v243, v250, v251
    v_mfma_f32_32x32x16_bf16 v[48:63], v[196:199], v[236:239], v[48:63]
    s_nop 0
    v_mfma_f32_32x32x16_bf16 v[48:63], v[200:203], v[240:243], v[48:63]
    v_mfma_f32_32x32x16_bf16 v[236:251], v[148:151], v[40:43], v[24:39]
    s_nop 11
    v_exp_f32 v236, v236
    v_exp_f32 v237, v237
    v_exp_f32 v238, v238
    v_exp_f32 v239, v239
    v_exp_f32 v240, v240
    v_exp_f32 v241, v241
    v_exp_f32 v242, v242
    v_exp_f32 v243, v243
    v_exp_f32 v244, v244
    v_exp_f32 v245, v245
    v_exp_f32 v246, v246
    v_exp_f32 v247, v247
    v_exp_f32 v248, v248
    v_exp_f32 v249, v249
    v_exp_f32 v250, v250
    v_exp_f32 v251, v251
    v_cvt_pk_bf16_f32 v236, v236, v237
    v_cvt_pk_bf16_f32 v237, v238, v239
    v_cvt_pk_bf16_f32 v238, v240, v241
    v_cvt_pk_bf16_f32 v239, v242, v243
    v_cvt_pk_bf16_f32 v240, v244, v245
    v_cvt_pk_bf16_f32 v241, v246, v247
    v_cvt_pk_bf16_f32 v242, v248, v249
    v_cvt_pk_bf16_f32 v243, v250, v251
    v_mfma_f32_32x32x16_bf16 v[48:63], v[204:207], v[236:239], v[48:63]
    s_nop 0
    v_mfma_f32_32x32x16_bf16 v[48:63], v[208:211], v[240:243], v[48:63]
    v_mfma_f32_32x32x16_bf16 v[236:251], v[152:155], v[40:43], v[24:39]
    s_nop 11
    v_exp_f32 v236, v236
    v_exp_f32 v237, v237
    v_exp_f32 v238, v238
    v_exp_f32 v239, v239
    v_exp_f32 v240, v240
    v_exp_f32 v241, v241
    v_exp_f32 v242, v242
    v_exp_f32 v243, v243
    v_exp_f32 v244, v244
    v_exp_f32 v245, v245
    v_exp_f32 v246, v246
    v_exp_f32 v247, v247
    v_exp_f32 v248, v248
    v_exp_f32 v249, v249
    v_exp_f32 v250, v250
    v_exp_f32 v251, v251
    v_cvt_pk_bf16_f32 v236, v236, v237
    v_cvt_pk_bf16_f32 v237, v238, v239
    v_cvt_pk_bf16_f32 v238, v240, v241
    v_cvt_pk_bf16_f32 v239, v242, v243
    v_cvt_pk_bf16_f32 v240, v244, v245
    v_cvt_pk_bf16_f32 v241, v246, v247
    v_cvt_pk_bf16_f32 v242, v248, v249
    v_cvt_pk_bf16_f32 v243, v250, v251
    v_mfma_f32_32x32x16_bf16 v[48:63], v[212:215], v[236:239], v[48:63]
    s_nop 0
    v_mfma_f32_32x32x16_bf16 v[48:63], v[216:219], v[240:243], v[48:63]
    v_mfma_f32_32x32x16_bf16 v[236:251], v[156:159], v[40:43], v[24:39]
    s_nop 11
    v_exp_f32 v236, v236
    v_exp_f32 v237, v237
    v_exp_f32 v238, v238
    v_exp_f32 v239, v239
    v_exp_f32 v240, v240
    v_exp_f32 v241, v241
    v_exp_f32 v242, v242
    v_exp_f32 v243, v243
    v_exp_f32 v244, v244
    v_exp_f32 v245, v245
    v_exp_f32 v246, v246
    v_exp_f32 v247, v247
    v_exp_f32 v248, v248
    v_exp_f32 v249, v249
    v_exp_f32 v250, v250
    v_exp_f32 v251, v251
    v_cvt_pk_bf16_f32 v236, v236, v237
    v_cvt_pk_bf16_f32 v237, v238, v239
    v_cvt_pk_bf16_f32 v238, v240, v241
    v_cvt_pk_bf16_f32 v239, v242, v243
    v_cvt_pk_bf16_f32 v240, v244, v245
    v_cvt_pk_bf16_f32 v241, v246, v247
    v_cvt_pk_bf16_f32 v242, v248, v249
    v_cvt_pk_bf16_f32 v243, v250, v251
    v_mfma_f32_32x32x16_bf16 v[48:63], v[220:223], v[236:239], v[48:63]
    s_nop 0
    v_mfma_f32_32x32x16_bf16 v[48:63], v[224:227], v[240:243], v[48:63]
    s_nop 11
    v_rcp_f32 v57, v56
    s_nop 0
    v_mul_f32 v48, v48, v57
    v_mul_f32 v49, v49, v57
    v_mul_f32 v50, v50, v57
    v_mul_f32 v51, v51, v57
    v_mul_f32 v52, v52, v57
    v_mul_f32 v53, v53, v57
    v_mul_f32 v54, v54, v57
    v_mul_f32 v55, v55, v57
    v_cvt_pk_bf16_f32 v96, v48, v49
    v_cvt_pk_bf16_f32 v97, v50, v51
    v_cvt_pk_bf16_f32 v98, v52, v53
    v_cvt_pk_bf16_f32 v99, v54, v55
    s_lshr_b32 s47, s50, 2
    s_add_u32 s47, s47, s9
    buffer_store_dwordx4 v[96:99], v5, s[36:39], s47 offen sc1
    s_waitcnt vmcnt(0)
L_fb_next:
    s_add_u32 s50, s50, 8192
    s_cmp_eq_u32 s50, 8192
    s_cbranch_scc1 L_fb_head
    s_nop 7
    s_branch L_fb_done
L_last:
.section .rodata,"a"
.p2align 6
.amdhsa_kernel gated_mix__sliding_block__mixer_s_mlp__prompt_kernel
  .amdhsa_next_free_vgpr 256
  .amdhsa_next_free_sgpr 102
  .amdhsa_accum_offset 256
  .amdhsa_group_segment_fixed_size 0
  .amdhsa_kernarg_size 96
  .amdhsa_user_sgpr_count 2
  .amdhsa_user_sgpr_kernarg_segment_ptr 1
  .amdhsa_system_sgpr_workgroup_id_x 1
.end_amdhsa_kernel
```
